```python
import torch

def _softmax(x, axis=-1):
    return torch.softmax(x, dim=axis)

def _gelu(x):
    return torch.nn.functional.gelu(x, approximate='tanh')

def _silu(x):
    return torch.nn.functional.silu(x)

def _sigmoid(x):
    return torch.sigmoid(x)

def _layernorm(x, axis=-1, eps=1e-05):
    m = x.mean(dim=axis, keepdim=True)
    v = x.var(dim=axis, keepdim=True, unbiased=False)
    return (x - m) / torch.sqrt(v + eps)

def _scatter_add(tgt, idx, src, axis=0):
    return tgt.clone().index_add_(axis, idx, src)

def _segment_sum(src, seg, n):
    out = torch.zeros((n,) + src.shape[1:], dtype=src.dtype)
    return out.index_add_(0, seg, src)

def _pad(x, pw):
    flat = tuple((v for pair in reversed(pw) for v in pair))
    return torch.nn.functional.pad(x, flat)
kernel_name = 'sequential_preLN__memory_aug_recurrent_mem_tr__glu_gated_geglu__prompt'

def setup_inputs():

    _w = lambda a: (lambda t: t.to(torch.bfloat16) if t.is_floating_point() else t)(torch.as_tensor(a))

    def _A_setup():
        B, S, Dm = (1, 2048, 512)
        H, Dh = (32, 128)
        M, seg = (8, 32)
        seg = min(seg, S)
        S = S // seg * seg
        return {'x': _w((lambda *s: torch.randn(*s, dtype=torch.bfloat16) * 0.05)(B, S, Dm)), 'mem0': _w((lambda *s: torch.randn(*s, dtype=torch.bfloat16) * 0.2)(B, M, Dm)), 'Wq': _w((lambda *s: torch.randn(*s, dtype=torch.bfloat16) * 1.6)(Dm, H, Dh) * Dm ** (-0.5)), 'Wk': _w((lambda *s: torch.randn(*s, dtype=torch.bfloat16) * 1.6)(Dm, H, Dh) * Dm ** (-0.5)), 'Wv': _w((lambda *s: torch.randn(*s, dtype=torch.bfloat16) * 0.2)(Dm, H, Dh) * Dm ** (-0.5)), 'Wo': _w((lambda *s: torch.randn(*s, dtype=torch.bfloat16) * 0.2)(H, Dh, Dm) * (H * Dh) ** (-0.5)), 'seg_len': seg}
    _A_in = _A_setup()

    def _B_setup():
        B, S, Dm, Df = (1, 2048, 512, 1792)
        return {'x': _w((lambda *s: torch.randn(*s, dtype=torch.bfloat16) * 0.05)(B, S, Dm)), 'w_gate': _w((lambda *s: torch.randn(*s, dtype=torch.bfloat16) * 0.4)(Dm, Df) * Dm ** (-0.5)), 'w_up': _w((lambda *s: torch.randn(*s, dtype=torch.bfloat16) * 0.4)(Dm, Df) * Dm ** (-0.5)), 'w_down': _w((lambda *s: torch.randn(*s, dtype=torch.bfloat16) * 0.4)(Df, Dm) * Df ** (-0.5))}
    _B_in = _B_setup()
    return {'A_x': _A_in['x'], 'A_mem0': _A_in['mem0'], 'A_Wq': _A_in['Wq'], 'A_Wk': _A_in['Wk'], 'A_Wv': _A_in['Wv'], 'A_Wo': _A_in['Wo'], 'A_seg_len': _A_in['seg_len'], 'B_x': _B_in['x'], 'B_w_gate': _B_in['w_gate'], 'B_w_up': _B_in['w_up'], 'B_w_down': _B_in['w_down']}

def reference(A_x, A_mem0, A_Wq, A_Wk, A_Wv, A_Wo, A_seg_len, B_x, B_w_gate, B_w_up, B_w_down):

    def _A_ref(x, mem0, Wq, Wk, Wv, Wo, seg_len):
        B, S, Dm = x.shape
        H, Dh = (Wq.shape[1], Wq.shape[2])
        M = mem0.shape[1]
        scale = Dh ** (-0.5)
        n_seg = S // seg_len
        L = M + seg_len
        idx = torch.arange(L)
        mask = (idx[:, None] < M) | (idx[:, None] >= idx[None, :])
        mem = mem0
        outs = []
        for s in range(n_seg):
            xs = x[:, s * seg_len:(s + 1) * seg_len, :].clone()
            h = torch.concatenate([mem, xs], axis=1)
            q = torch.einsum('btd,dhe->bhte', h, Wq)
            k = torch.einsum('btd,dhe->bhte', h, Wk)
            v = torch.einsum('btd,dhe->bhte', h, Wv)
            scores = torch.einsum('bhqe,bhke->bhqk', q, k) * scale
            scores = torch.where(mask[None, None], scores, -1000000000.0)
            p = _softmax(scores, axis=-1)
            o = torch.einsum('bhqk,bhke->bhqe', p, v)
            o = torch.einsum('bhte,hed->btd', o, Wo)
            mem = o[:, :M, :].clone()
            outs.append(o[:, M:, :])
        return torch.concatenate(outs, axis=1)

    def _B_ref(x, w_gate, w_up, w_down):
        g = torch.einsum('bsd,df->bsf', x, w_gate)
        u = torch.einsum('bsd,df->bsf', x, w_up)
        h = _gelu(g) * u
        return torch.einsum('bsf,fd->bsd', h, w_down)
    x = A_x
    h = x + _A_ref(_layernorm(x, axis=-1), A_mem0, A_Wq, A_Wk, A_Wv, A_Wo, A_seg_len)
    h2 = h + _B_ref(_layernorm(h, axis=-1), B_w_gate, B_w_up, B_w_down)
    return h2
```

```asm
; @launch grid=(256,1,1) block=(256,1,1) lds=163840
.amdgcn_target "amdgcn-amd-amdhsa--gfx950"
.text
.globl sequential_preLN__memory_aug_recurrent_mem_tr__glu_gated_geglu__prompt_kernel
.p2align 8
.type sequential_preLN__memory_aug_recurrent_mem_tr__glu_gated_geglu__prompt_kernel,@function
sequential_preLN__memory_aug_recurrent_mem_tr__glu_gated_geglu__prompt_kernel:
    s_cmp_ge_u32 s2, 256
    s_cbranch_scc1 L_exit
    s_mov_b32 s96, 4000000
    s_load_dwordx4 s[40:43], s[0:1], 96
    s_load_dwordx16 s[16:31], s[0:1], 0
    s_load_dwordx8 s[32:39], s[0:1], 64
    s_getreg_b32 s12, hwreg(HW_REG_XCC_ID, 0, 3)
    s_lshl_b32 s12, s12, 2
    s_lshr_b32 s12, 0x73620541, s12
    s_and_b32 s12, s12, 7
    v_lshrrev_b32 v1, 6, v0
    v_lshlrev_b32 v2, 4, v0
    v_readfirstlane_b32 s13, v1
    v_mov_b32 v4, -1
    v_mov_b32 v5, -1
    v_mov_b32 v6, -1
    v_mov_b32 v7, -1
    s_lshl_b32 s3, s12, 4
    s_add_u32 s3, s3, 128
    s_cmp_eq_u32 s12, 0
    s_cselect_b32 s3, 0, s3
    v_mov_b32 v3, s3
    v_mov_b32 v8, 1
    v_mov_b32 v9, 32760
    s_lshl_b32 s3, s2, 12
    s_add_u32 s3, s3, 65011712
    s_waitcnt lgkmcnt(0)
    s_cmp_lg_u32 s13, 0
    s_cbranch_scc1 L_notick
    s_mov_b64 exec, 1
    global_atomic_add v10, v3, v8, s[40:41] sc0 sc1
    s_mov_b64 exec, -1
L_notick:
    s_mov_b32 s4, s42
    s_and_b32 s5, s43, 0xffff
    s_mov_b32 s6, 268435456
    s_mov_b32 s7, 0x20000
    buffer_store_dwordx4 v[4:7], v2, s[4:7], s3 offen sc1
    s_add_u32 s3, s3, 1048576
    buffer_store_dwordx4 v[4:7], v2, s[4:7], s3 offen sc1
    s_waitcnt vmcnt(0)
    s_cmp_lg_u32 s13, 0
    s_cbranch_scc1 L_notick2
    s_mov_b64 exec, 1
    ds_write_b32 v9, v10
    s_mov_b64 exec, -1
    s_waitcnt lgkmcnt(0)
L_notick2:
    s_barrier
    ds_read_b32 v10, v9
    s_cmp_lg_u32 s13, 1
    s_cbranch_scc1 L_noready
    v_mov_b32 v3, 64
    s_mov_b64 exec, 1
    global_atomic_add v3, v8, s[40:41] sc1
    s_mov_b64 exec, -1
L_noready:
    s_waitcnt lgkmcnt(0)
    v_readfirstlane_b32 s14, v10
    s_barrier
    s_cmp_lt_u32 s14, 32
    s_cbranch_scc1 L_placed
    v_mov_b32 v11, v0
L_rdyo:
    v_mov_b32 v0, 64
    global_load_dword v0, v0, s[40:41] sc1
    s_waitcnt vmcnt(0)
    v_cmp_gt_u32 vcc, 0x100, v0
    s_cbranch_vccz L_rdyoko
    s_sub_u32 s96, s96, 1
    s_cbranch_scc0 L_rdyo
    s_branch L_abort
L_rdyoko:
    v_mov_b32 v0, v11
    s_cmp_lg_u32 s13, 0
    s_cbranch_scc1 L_noovf
    v_mov_b32 v3, 96
    s_mov_b64 exec, 1
    global_atomic_add v10, v3, v8, s[40:41] sc0 sc1
    s_waitcnt vmcnt(0)
    ds_write_b32 v9, v10
    s_mov_b64 exec, -1
    s_waitcnt lgkmcnt(0)
L_noovf:
    s_barrier
    ds_read_b32 v10, v9
    v_and_b32_e64 v3, 7, v0
    v_lshlrev_b32 v4, 4, v3
    v_add_u32 v4, 128, v4
    v_cmp_eq_u32 vcc, 0, v3
    s_nop 1
    v_cndmask_b32 v4, v4, v3, vcc
    global_load_dword v4, v4, s[40:41] sc1
    s_waitcnt vmcnt(0) lgkmcnt(0)
    v_readfirstlane_b32 s67, v10
    s_barrier
    v_readlane_b32 s3, v4, 0
    s_mov_b32 s12, 0
    s_min_u32 s3, s3, 32
    s_add_u32 s14, s3, s67
    s_cmp_lt_u32 s14, 32
    s_cbranch_scc1 L_placed
    s_sub_u32 s67, s14, 32
    v_readlane_b32 s3, v4, 1
    s_mov_b32 s12, 1
    s_min_u32 s3, s3, 32
    s_add_u32 s14, s3, s67
    s_cmp_lt_u32 s14, 32
    s_cbranch_scc1 L_placed
    s_sub_u32 s67, s14, 32
    v_readlane_b32 s3, v4, 2
    s_mov_b32 s12, 2
    s_min_u32 s3, s3, 32
    s_add_u32 s14, s3, s67
    s_cmp_lt_u32 s14, 32
    s_cbranch_scc1 L_placed
    s_sub_u32 s67, s14, 32
    v_readlane_b32 s3, v4, 3
    s_mov_b32 s12, 3
    s_min_u32 s3, s3, 32
    s_add_u32 s14, s3, s67
    s_cmp_lt_u32 s14, 32
    s_cbranch_scc1 L_placed
    s_sub_u32 s67, s14, 32
    v_readlane_b32 s3, v4, 4
    s_mov_b32 s12, 4
    s_min_u32 s3, s3, 32
    s_add_u32 s14, s3, s67
    s_cmp_lt_u32 s14, 32
    s_cbranch_scc1 L_placed
    s_sub_u32 s67, s14, 32
    v_readlane_b32 s3, v4, 5
    s_mov_b32 s12, 5
    s_min_u32 s3, s3, 32
    s_add_u32 s14, s3, s67
    s_cmp_lt_u32 s14, 32
    s_cbranch_scc1 L_placed
    s_sub_u32 s67, s14, 32
    v_readlane_b32 s3, v4, 6
    s_mov_b32 s12, 6
    s_min_u32 s3, s3, 32
    s_add_u32 s14, s3, s67
    s_cmp_lt_u32 s14, 32
    s_cbranch_scc1 L_placed
    s_sub_u32 s67, s14, 32
    v_readlane_b32 s3, v4, 7
    s_mov_b32 s12, 7
    s_min_u32 s3, s3, 32
    s_add_u32 s14, s3, s67
    s_cmp_lt_u32 s14, 32
    s_cbranch_scc1 L_placed
    s_sub_u32 s67, s14, 32
    s_branch L_exit
L_placed:
    s_cmp_eq_u32 s12, 0
    s_cbranch_scc1 L_chain
    s_cmp_le_u32 s12, 3
    s_cbranch_scc1 L_qkv
    s_cmp_ge_u32 s12, 6
    s_cbranch_scc1 L_post
    s_sub_u32 s44, s12, 4
    v_and_b32 v8, 63, v0
    s_mov_b32 s8, s16
    s_and_b32 s9, s17, 0xffff
    s_mov_b32 s10, 2097152
    s_mov_b32 s11, 0x20000
    s_lshl_b32 s46, s14, 1
    s_add_u32 s46, s46, s44
    s_lshl_b32 s49, s46, 15
    s_lshl_b32 s47, s13, 13
    s_add_u32 s47, s47, s49
    v_and_b32 v9, 7, v8
    v_lshrrev_b32 v10, 3, v8
    v_lshlrev_b32 v11, 10, v9
    v_lshl_add_u32 v11, v10, 4, v11
    buffer_load_dwordx4 v[16:19], v11, s[8:11], s47 offen offset:0
    buffer_load_dwordx4 v[20:23], v11, s[8:11], s47 offen offset:128
    buffer_load_dwordx4 v[24:27], v11, s[8:11], s47 offen offset:256
    buffer_load_dwordx4 v[28:31], v11, s[8:11], s47 offen offset:384
    buffer_load_dwordx4 v[32:35], v11, s[8:11], s47 offen offset:512
    buffer_load_dwordx4 v[36:39], v11, s[8:11], s47 offen offset:640
    buffer_load_dwordx4 v[40:43], v11, s[8:11], s47 offen offset:768
    buffer_load_dwordx4 v[44:47], v11, s[8:11], s47 offen offset:896
    s_waitcnt vmcnt(0)
    v_lshlrev_b32 v48, 16, v16
    v_and_b32 v49, 0xffff0000, v16
    v_lshlrev_b32 v50, 16, v17
    v_and_b32 v51, 0xffff0000, v17
    v_lshlrev_b32 v52, 16, v18
    v_and_b32 v53, 0xffff0000, v18
    v_lshlrev_b32 v54, 16, v19
    v_and_b32 v55, 0xffff0000, v19
    v_lshlrev_b32 v56, 16, v20
    v_and_b32 v57, 0xffff0000, v20
    v_lshlrev_b32 v58, 16, v21
    v_and_b32 v59, 0xffff0000, v21
    v_lshlrev_b32 v60, 16, v22
    v_and_b32 v61, 0xffff0000, v22
    v_lshlrev_b32 v62, 16, v23
    v_and_b32 v63, 0xffff0000, v23
    v_lshlrev_b32 v64, 16, v24
    v_and_b32 v65, 0xffff0000, v24
    v_lshlrev_b32 v66, 16, v25
    v_and_b32 v67, 0xffff0000, v25
    v_lshlrev_b32 v68, 16, v26
    v_and_b32 v69, 0xffff0000, v26
    v_lshlrev_b32 v70, 16, v27
    v_and_b32 v71, 0xffff0000, v27
    v_lshlrev_b32 v72, 16, v28
    v_and_b32 v73, 0xffff0000, v28
    v_lshlrev_b32 v74, 16, v29
    v_and_b32 v75, 0xffff0000, v29
    v_lshlrev_b32 v76, 16, v30
    v_and_b32 v77, 0xffff0000, v30
    v_lshlrev_b32 v78, 16, v31
    v_and_b32 v79, 0xffff0000, v31
    v_lshlrev_b32 v80, 16, v32
    v_and_b32 v81, 0xffff0000, v32
    v_lshlrev_b32 v82, 16, v33
    v_and_b32 v83, 0xffff0000, v33
    v_lshlrev_b32 v84, 16, v34
    v_and_b32 v85, 0xffff0000, v34
    v_lshlrev_b32 v86, 16, v35
    v_and_b32 v87, 0xffff0000, v35
    v_lshlrev_b32 v88, 16, v36
    v_and_b32 v89, 0xffff0000, v36
    v_lshlrev_b32 v90, 16, v37
    v_and_b32 v91, 0xffff0000, v37
    v_lshlrev_b32 v92, 16, v38
    v_and_b32 v93, 0xffff0000, v38
    v_lshlrev_b32 v94, 16, v39
    v_and_b32 v95, 0xffff0000, v39
    v_lshlrev_b32 v96, 16, v40
    v_and_b32 v97, 0xffff0000, v40
    v_lshlrev_b32 v98, 16, v41
    v_and_b32 v99, 0xffff0000, v41
    v_lshlrev_b32 v100, 16, v42
    v_and_b32 v101, 0xffff0000, v42
    v_lshlrev_b32 v102, 16, v43
    v_and_b32 v103, 0xffff0000, v43
    v_lshlrev_b32 v104, 16, v44
    v_and_b32 v105, 0xffff0000, v44
    v_lshlrev_b32 v106, 16, v45
    v_and_b32 v107, 0xffff0000, v45
    v_lshlrev_b32 v108, 16, v46
    v_and_b32 v109, 0xffff0000, v46
    v_lshlrev_b32 v110, 16, v47
    v_and_b32 v111, 0xffff0000, v47
    v_add_f32 v12, v48, v52
    v_add_f32 v13, v49, v53
    v_add_f32 v14, v50, v54
    v_add_f32 v15, v51, v55
    v_add_f32 v12, v12, v56
    v_add_f32 v13, v13, v57
    v_add_f32 v14, v14, v58
    v_add_f32 v15, v15, v59
    v_add_f32 v12, v12, v60
    v_add_f32 v13, v13, v61
    v_add_f32 v14, v14, v62
    v_add_f32 v15, v15, v63
    v_add_f32 v12, v12, v64
    v_add_f32 v13, v13, v65
    v_add_f32 v14, v14, v66
    v_add_f32 v15, v15, v67
    v_add_f32 v12, v12, v68
    v_add_f32 v13, v13, v69
    v_add_f32 v14, v14, v70
    v_add_f32 v15, v15, v71
    v_add_f32 v12, v12, v72
    v_add_f32 v13, v13, v73
    v_add_f32 v14, v14, v74
    v_add_f32 v15, v15, v75
    v_add_f32 v12, v12, v76
    v_add_f32 v13, v13, v77
    v_add_f32 v14, v14, v78
    v_add_f32 v15, v15, v79
    v_add_f32 v12, v12, v80
    v_add_f32 v13, v13, v81
    v_add_f32 v14, v14, v82
    v_add_f32 v15, v15, v83
    v_add_f32 v12, v12, v84
    v_add_f32 v13, v13, v85
    v_add_f32 v14, v14, v86
    v_add_f32 v15, v15, v87
    v_add_f32 v12, v12, v88
    v_add_f32 v13, v13, v89
    v_add_f32 v14, v14, v90
    v_add_f32 v15, v15, v91
    v_add_f32 v12, v12, v92
    v_add_f32 v13, v13, v93
    v_add_f32 v14, v14, v94
    v_add_f32 v15, v15, v95
    v_add_f32 v12, v12, v96
    v_add_f32 v13, v13, v97
    v_add_f32 v14, v14, v98
    v_add_f32 v15, v15, v99
    v_add_f32 v12, v12, v100
    v_add_f32 v13, v13, v101
    v_add_f32 v14, v14, v102
    v_add_f32 v15, v15, v103
    v_add_f32 v12, v12, v104
    v_add_f32 v13, v13, v105
    v_add_f32 v14, v14, v106
    v_add_f32 v15, v15, v107
    v_add_f32 v12, v12, v108
    v_add_f32 v13, v13, v109
    v_add_f32 v14, v14, v110
    v_add_f32 v15, v15, v111
    v_add_f32 v12, v12, v13
    v_add_f32 v14, v14, v15
    v_add_f32_e64 v12, v12, v14
    s_nop 1
    v_add_f32_dpp v12, v12, v12 row_ror:8 row_mask:0xf bank_mask:0xf
    v_mov_b32 v13, v12
    s_nop 1
    v_permlane16_swap_b32 v12, v13
    v_add_f32 v12, v12, v13
    v_mov_b32 v13, v12
    s_nop 1
    v_permlane32_swap_b32 v12, v13
    v_add_f32 v12, v12, v13
    v_mul_f32 v12, 0x3b000000, v12
    v_sub_f32 v48, v48, v12
    v_sub_f32 v49, v49, v12
    v_sub_f32 v50, v50, v12
    v_sub_f32 v51, v51, v12
    v_sub_f32 v52, v52, v12
    v_sub_f32 v53, v53, v12
    v_sub_f32 v54, v54, v12
    v_sub_f32 v55, v55, v12
    v_sub_f32 v56, v56, v12
    v_sub_f32 v57, v57, v12
    v_sub_f32 v58, v58, v12
    v_sub_f32 v59, v59, v12
    v_sub_f32 v60, v60, v12
    v_sub_f32 v61, v61, v12
    v_sub_f32 v62, v62, v12
    v_sub_f32 v63, v63, v12
    v_sub_f32 v64, v64, v12
    v_sub_f32 v65, v65, v12
    v_sub_f32 v66, v66, v12
    v_sub_f32 v67, v67, v12
    v_sub_f32 v68, v68, v12
    v_sub_f32 v69, v69, v12
    v_sub_f32 v70, v70, v12
    v_sub_f32 v71, v71, v12
    v_sub_f32 v72, v72, v12
    v_sub_f32 v73, v73, v12
    v_sub_f32 v74, v74, v12
    v_sub_f32 v75, v75, v12
    v_sub_f32 v76, v76, v12
    v_sub_f32 v77, v77, v12
    v_sub_f32 v78, v78, v12
    v_sub_f32 v79, v79, v12
    v_sub_f32 v80, v80, v12
    v_sub_f32 v81, v81, v12
    v_sub_f32 v82, v82, v12
    v_sub_f32 v83, v83, v12
    v_sub_f32 v84, v84, v12
    v_sub_f32 v85, v85, v12
    v_sub_f32 v86, v86, v12
    v_sub_f32 v87, v87, v12
    v_sub_f32 v88, v88, v12
    v_sub_f32 v89, v89, v12
    v_sub_f32 v90, v90, v12
    v_sub_f32 v91, v91, v12
    v_sub_f32 v92, v92, v12
    v_sub_f32 v93, v93, v12
    v_sub_f32 v94, v94, v12
    v_sub_f32 v95, v95, v12
    v_sub_f32 v96, v96, v12
    v_sub_f32 v97, v97, v12
    v_sub_f32 v98, v98, v12
    v_sub_f32 v99, v99, v12
    v_sub_f32 v100, v100, v12
    v_sub_f32 v101, v101, v12
    v_sub_f32 v102, v102, v12
    v_sub_f32 v103, v103, v12
    v_sub_f32 v104, v104, v12
    v_sub_f32 v105, v105, v12
    v_sub_f32 v106, v106, v12
    v_sub_f32 v107, v107, v12
    v_sub_f32 v108, v108, v12
    v_sub_f32 v109, v109, v12
    v_sub_f32 v110, v110, v12
    v_sub_f32 v111, v111, v12
    v_mul_f32 v12, v48, v48
    v_mul_f32 v13, v49, v49
    v_mul_f32 v14, v50, v50
    v_mul_f32 v15, v51, v51
    v_fmac_f32 v12, v52, v52
    v_fmac_f32 v13, v53, v53
    v_fmac_f32 v14, v54, v54
    v_fmac_f32 v15, v55, v55
    v_fmac_f32 v12, v56, v56
    v_fmac_f32 v13, v57, v57
    v_fmac_f32 v14, v58, v58
    v_fmac_f32 v15, v59, v59
    v_fmac_f32 v12, v60, v60
    v_fmac_f32 v13, v61, v61
    v_fmac_f32 v14, v62, v62
    v_fmac_f32 v15, v63, v63
    v_fmac_f32 v12, v64, v64
    v_fmac_f32 v13, v65, v65
    v_fmac_f32 v14, v66, v66
    v_fmac_f32 v15, v67, v67
    v_fmac_f32 v12, v68, v68
    v_fmac_f32 v13, v69, v69
    v_fmac_f32 v14, v70, v70
    v_fmac_f32 v15, v71, v71
    v_fmac_f32 v12, v72, v72
    v_fmac_f32 v13, v73, v73
    v_fmac_f32 v14, v74, v74
    v_fmac_f32 v15, v75, v75
    v_fmac_f32 v12, v76, v76
    v_fmac_f32 v13, v77, v77
    v_fmac_f32 v14, v78, v78
    v_fmac_f32 v15, v79, v79
    v_fmac_f32 v12, v80, v80
    v_fmac_f32 v13, v81, v81
    v_fmac_f32 v14, v82, v82
    v_fmac_f32 v15, v83, v83
    v_fmac_f32 v12, v84, v84
    v_fmac_f32 v13, v85, v85
    v_fmac_f32 v14, v86, v86
    v_fmac_f32 v15, v87, v87
    v_fmac_f32 v12, v88, v88
    v_fmac_f32 v13, v89, v89
    v_fmac_f32 v14, v90, v90
    v_fmac_f32 v15, v91, v91
    v_fmac_f32 v12, v92, v92
    v_fmac_f32 v13, v93, v93
    v_fmac_f32 v14, v94, v94
    v_fmac_f32 v15, v95, v95
    v_fmac_f32 v12, v96, v96
    v_fmac_f32 v13, v97, v97
    v_fmac_f32 v14, v98, v98
    v_fmac_f32 v15, v99, v99
    v_fmac_f32 v12, v100, v100
    v_fmac_f32 v13, v101, v101
    v_fmac_f32 v14, v102, v102
    v_fmac_f32 v15, v103, v103
    v_fmac_f32 v12, v104, v104
    v_fmac_f32 v13, v105, v105
    v_fmac_f32 v14, v106, v106
    v_fmac_f32 v15, v107, v107
    v_fmac_f32 v12, v108, v108
    v_fmac_f32 v13, v109, v109
    v_fmac_f32 v14, v110, v110
    v_fmac_f32 v15, v111, v111
    v_add_f32 v12, v12, v13
    v_add_f32 v14, v14, v15
    v_add_f32 v12, v12, v14
    s_nop 1
    v_add_f32_dpp v12, v12, v12 row_ror:8 row_mask:0xf bank_mask:0xf
    v_mov_b32 v13, v12
    s_nop 1
    v_permlane16_swap_b32 v12, v13
    v_add_f32 v12, v12, v13
    v_mov_b32 v13, v12
    s_nop 1
    v_permlane32_swap_b32 v12, v13
    v_add_f32 v12, v12, v13
    v_mov_b32 v13, 0x3727c5ac
    v_fmac_f32 v13, 0x3b000000, v12
    v_rsq_f32 v13, v13
    s_nop 0
    v_mul_f32 v48, v48, v13
    v_mul_f32 v49, v49, v13
    v_mul_f32 v50, v50, v13
    v_mul_f32 v51, v51, v13
    v_mul_f32 v52, v52, v13
    v_mul_f32 v53, v53, v13
    v_mul_f32 v54, v54, v13
    v_mul_f32 v55, v55, v13
    v_mul_f32 v56, v56, v13
    v_mul_f32 v57, v57, v13
    v_mul_f32 v58, v58, v13
    v_mul_f32 v59, v59, v13
    v_mul_f32 v60, v60, v13
    v_mul_f32 v61, v61, v13
    v_mul_f32 v62, v62, v13
    v_mul_f32 v63, v63, v13
    v_mul_f32 v64, v64, v13
    v_mul_f32 v65, v65, v13
    v_mul_f32 v66, v66, v13
    v_mul_f32 v67, v67, v13
    v_mul_f32 v68, v68, v13
    v_mul_f32 v69, v69, v13
    v_mul_f32 v70, v70, v13
    v_mul_f32 v71, v71, v13
    v_mul_f32 v72, v72, v13
    v_mul_f32 v73, v73, v13
    v_mul_f32 v74, v74, v13
    v_mul_f32 v75, v75, v13
    v_mul_f32 v76, v76, v13
    v_mul_f32 v77, v77, v13
    v_mul_f32 v78, v78, v13
    v_mul_f32 v79, v79, v13
    v_mul_f32 v80, v80, v13
    v_mul_f32 v81, v81, v13
    v_mul_f32 v82, v82, v13
    v_mul_f32 v83, v83, v13
    v_mul_f32 v84, v84, v13
    v_mul_f32 v85, v85, v13
    v_mul_f32 v86, v86, v13
    v_mul_f32 v87, v87, v13
    v_mul_f32 v88, v88, v13
    v_mul_f32 v89, v89, v13
    v_mul_f32 v90, v90, v13
    v_mul_f32 v91, v91, v13
    v_mul_f32 v92, v92, v13
    v_mul_f32 v93, v93, v13
    v_mul_f32 v94, v94, v13
    v_mul_f32 v95, v95, v13
    v_mul_f32 v96, v96, v13
    v_mul_f32 v97, v97, v13
    v_mul_f32 v98, v98, v13
    v_mul_f32 v99, v99, v13
    v_mul_f32 v100, v100, v13
    v_mul_f32 v101, v101, v13
    v_mul_f32 v102, v102, v13
    v_mul_f32 v103, v103, v13
    v_mul_f32 v104, v104, v13
    v_mul_f32 v105, v105, v13
    v_mul_f32 v106, v106, v13
    v_mul_f32 v107, v107, v13
    v_mul_f32 v108, v108, v13
    v_mul_f32 v109, v109, v13
    v_mul_f32 v110, v110, v13
    v_mul_f32 v111, v111, v13
    v_cvt_pk_bf16_f32 v16, v48, v49
    v_cvt_pk_bf16_f32 v17, v50, v51
    v_cvt_pk_bf16_f32 v18, v52, v53
    v_cvt_pk_bf16_f32 v19, v54, v55
    v_cvt_pk_bf16_f32 v20, v56, v57
    v_cvt_pk_bf16_f32 v21, v58, v59
    v_cvt_pk_bf16_f32 v22, v60, v61
    v_cvt_pk_bf16_f32 v23, v62, v63
    v_cvt_pk_bf16_f32 v24, v64, v65
    v_cvt_pk_bf16_f32 v25, v66, v67
    v_cvt_pk_bf16_f32 v26, v68, v69
    v_cvt_pk_bf16_f32 v27, v70, v71
    v_cvt_pk_bf16_f32 v28, v72, v73
    v_cvt_pk_bf16_f32 v29, v74, v75
    v_cvt_pk_bf16_f32 v30, v76, v77
    v_cvt_pk_bf16_f32 v31, v78, v79
    v_cvt_pk_bf16_f32 v32, v80, v81
    v_cvt_pk_bf16_f32 v33, v82, v83
    v_cvt_pk_bf16_f32 v34, v84, v85
    v_cvt_pk_bf16_f32 v35, v86, v87
    v_cvt_pk_bf16_f32 v36, v88, v89
    v_cvt_pk_bf16_f32 v37, v90, v91
    v_cvt_pk_bf16_f32 v38, v92, v93
    v_cvt_pk_bf16_f32 v39, v94, v95
    v_cvt_pk_bf16_f32 v40, v96, v97
    v_cvt_pk_bf16_f32 v41, v98, v99
    v_cvt_pk_bf16_f32 v42, v100, v101
    v_cvt_pk_bf16_f32 v43, v102, v103
    v_cvt_pk_bf16_f32 v44, v104, v105
    v_cvt_pk_bf16_f32 v45, v106, v107
    v_cvt_pk_bf16_f32 v46, v108, v109
    v_cvt_pk_bf16_f32 v47, v110, v111
    v_lshlrev_b32 v11, 9, v10
    v_lshl_add_u32 v11, v9, 4, v11
    s_lshl_b32 s47, s13, 7
    s_add_u32 s47, s47, s49
    s_add_u32 s47, s47, 60817408
    buffer_store_dwordx4 v[16:19], v11, s[4:7], s47 offen sc1
    s_add_u32 s47, s47, 4096
    buffer_store_dwordx4 v[20:23], v11, s[4:7], s47 offen sc1
    s_add_u32 s47, s47, 4096
    buffer_store_dwordx4 v[24:27], v11, s[4:7], s47 offen sc1
    s_add_u32 s47, s47, 4096
    buffer_store_dwordx4 v[28:31], v11, s[4:7], s47 offen sc1
    s_add_u32 s47, s47, 4096
    buffer_store_dwordx4 v[32:35], v11, s[4:7], s47 offen sc1
    s_add_u32 s47, s47, 4096
    buffer_store_dwordx4 v[36:39], v11, s[4:7], s47 offen sc1
    s_add_u32 s47, s47, 4096
    buffer_store_dwordx4 v[40:43], v11, s[4:7], s47 offen sc1
    s_add_u32 s47, s47, 4096
    buffer_store_dwordx4 v[44:47], v11, s[4:7], s47 offen sc1
    v_mov_b32 v9, v0
L_rdyln:
    v_mov_b32_e64 v0, 64
    global_load_dword v0, v0, s[40:41] sc1
    s_waitcnt vmcnt(0)
    v_cmp_gt_u32 vcc, 0x100, v0
    s_cbranch_vccz L_rdyokln
    s_sub_u32 s96, s96, 1
    s_cbranch_scc0 L_rdyln
    s_branch L_abort
L_rdyokln:
    v_mov_b32 v0, v9
    s_barrier
    s_cmp_lg_u32 s13, 0
    s_cbranch_scc1 L_qnoxf
    s_lshl_b32 s46, s44, 7
    s_lshl_b32 s47, s14, 2
    s_add_u32 s46, s46, s47
    s_add_u32 s46, s46, 65839104
    v_mov_b32 v12, 0
    s_mov_b64 exec, 1
    buffer_store_dword v12, v12, s[4:7], s46 offen sc1
    s_mov_b64 exec, -1
L_qnoxf:
    s_cmp_eq_u32 s12, 5
    s_cbranch_scc1 L_exit
    s_branch L_post
L_exit:
    s_endpgm
L_abort:
    v_mov_b32 v0, 100
    v_mov_b32 v1, 0xdead
    global_store_dword v0, v1, s[40:41] sc1
    s_waitcnt vmcnt(0)
    s_endpgm
L_qkv:
    s_sub_u32 s44, s12, 1
    v_and_b32 v8, 63, v0
    v_lshlrev_b32 v1, 4, v8
    v_lshrrev_b32 v12, 2, v8
    v_lshlrev_b32 v12, 13, v12
    v_and_b32_e64 v13, 3, v8
    v_lshl_add_u32 v12, v13, 4, v12
    s_lshl_b32 s46, s14, 8
    s_lshl_b32 s47, s13, 6
    s_add_u32 s46, s46, s47
    v_add_u32 v3, s46, v12
    v_lshrrev_b32 v12, 5, v8
    v_bfe_u32 v14, v8, 2, 2
    v_lshl_add_u32 v12, v12, 3, v14
    v_lshlrev_b32 v12, 6, v12
    v_and_b32_e64 v14, 1, v8
    v_lshl_add_u32 v12, v14, 5, v12
    v_bfe_u32 v14, v8, 4, 1
    v_lshl_add_u32 v12, v14, 4, v12
    v_bfe_u32 v14, v8, 1, 1
    v_lshl_add_u32 v12, v14, 3, v12
    s_lshl_b32 s48, s13, 15
    v_add_u32 v4, s48, v12
    s_cmp_eq_u32 s44, 1
    s_cselect_b64 s[8:9], s[24:25], s[22:23]
    s_cmp_eq_u32 s44, 2
    s_cselect_b64 s[8:9], s[20:21], s[8:9]
    s_and_b32 s9, s9, 0xffff
    s_mov_b32 s10, 4194304
    s_mov_b32 s11, 0x20000
    s_add_u32 m0, s48, 0
    s_mov_b32 s46, 0
    buffer_load_dwordx4 v3, s[8:11], s46 offen lds
    s_add_u32 m0, s48, 1024
    s_mov_b32 s46, 131072
    buffer_load_dwordx4 v3, s[8:11], s46 offen lds
    s_add_u32 m0, s48, 2048
    s_mov_b32 s46, 262144
    buffer_load_dwordx4 v3, s[8:11], s46 offen lds
    s_add_u32 m0, s48, 3072
    s_mov_b32 s46, 393216
    buffer_load_dwordx4 v3, s[8:11], s46 offen lds
    s_add_u32 m0, s48, 4096
    s_mov_b32 s46, 524288
    buffer_load_dwordx4 v3, s[8:11], s46 offen lds
    s_add_u32 m0, s48, 5120
    s_mov_b32 s46, 655360
    buffer_load_dwordx4 v3, s[8:11], s46 offen lds
    s_add_u32 m0, s48, 6144
    s_mov_b32 s46, 786432
    buffer_load_dwordx4 v3, s[8:11], s46 offen lds
    s_add_u32 m0, s48, 7168
    s_mov_b32 s46, 917504
    buffer_load_dwordx4 v3, s[8:11], s46 offen lds
    s_add_u32 m0, s48, 8192
    s_mov_b32 s46, 1048576
    buffer_load_dwordx4 v3, s[8:11], s46 offen lds
    s_add_u32 m0, s48, 9216
    s_mov_b32 s46, 1179648
    buffer_load_dwordx4 v3, s[8:11], s46 offen lds
    s_add_u32 m0, s48, 10240
    s_mov_b32 s46, 1310720
    buffer_load_dwordx4 v3, s[8:11], s46 offen lds
    s_add_u32 m0, s48, 11264
    s_mov_b32 s46, 1441792
    buffer_load_dwordx4 v3, s[8:11], s46 offen lds
    s_add_u32 m0, s48, 12288
    s_mov_b32 s46, 1572864
    buffer_load_dwordx4 v3, s[8:11], s46 offen lds
    s_add_u32 m0, s48, 13312
    s_mov_b32 s46, 1703936
    buffer_load_dwordx4 v3, s[8:11], s46 offen lds
    s_add_u32 m0, s48, 14336
    s_mov_b32 s46, 1835008
    buffer_load_dwordx4 v3, s[8:11], s46 offen lds
    s_add_u32 m0, s48, 15360
    s_mov_b32 s46, 1966080
    buffer_load_dwordx4 v3, s[8:11], s46 offen lds
    s_add_u32 m0, s48, 16384
    s_mov_b32 s46, 2097152
    buffer_load_dwordx4 v3, s[8:11], s46 offen lds
    s_add_u32 m0, s48, 17408
    s_mov_b32 s46, 2228224
    buffer_load_dwordx4 v3, s[8:11], s46 offen lds
    s_add_u32 m0, s48, 18432
    s_mov_b32 s46, 2359296
    buffer_load_dwordx4 v3, s[8:11], s46 offen lds
    s_add_u32 m0, s48, 19456
    s_mov_b32 s46, 2490368
    buffer_load_dwordx4 v3, s[8:11], s46 offen lds
    s_add_u32 m0, s48, 20480
    s_mov_b32 s46, 2621440
    buffer_load_dwordx4 v3, s[8:11], s46 offen lds
    s_add_u32 m0, s48, 21504
    s_mov_b32 s46, 2752512
    buffer_load_dwordx4 v3, s[8:11], s46 offen lds
    s_add_u32 m0, s48, 22528
    s_mov_b32 s46, 2883584
    buffer_load_dwordx4 v3, s[8:11], s46 offen lds
    s_add_u32 m0, s48, 23552
    s_mov_b32 s46, 3014656
    buffer_load_dwordx4 v3, s[8:11], s46 offen lds
    s_add_u32 m0, s48, 24576
    s_mov_b32 s46, 3145728
    buffer_load_dwordx4 v3, s[8:11], s46 offen lds
    s_add_u32 m0, s48, 25600
    s_mov_b32 s46, 3276800
    buffer_load_dwordx4 v3, s[8:11], s46 offen lds
    s_add_u32 m0, s48, 26624
    s_mov_b32 s46, 3407872
    buffer_load_dwordx4 v3, s[8:11], s46 offen lds
    s_add_u32 m0, s48, 27648
    s_mov_b32 s46, 3538944
    buffer_load_dwordx4 v3, s[8:11], s46 offen lds
    s_add_u32 m0, s48, 28672
    s_mov_b32 s46, 3670016
    buffer_load_dwordx4 v3, s[8:11], s46 offen lds
    s_add_u32 m0, s48, 29696
    s_mov_b32 s46, 3801088
    buffer_load_dwordx4 v3, s[8:11], s46 offen lds
    s_add_u32 m0, s48, 30720
    s_mov_b32 s46, 3932160
    buffer_load_dwordx4 v3, s[8:11], s46 offen lds
    s_add_u32 m0, s48, 31744
    s_mov_b32 s46, 4063232
    buffer_load_dwordx4 v3, s[8:11], s46 offen lds
    v_mov_b32_e64 v14, 64
    global_load_dword v14, v14, s[40:41] sc1
    s_waitcnt vmcnt(29)
    ds_read_b64_tr_b16 v[128:129], v4 offset:0
    ds_read_b64_tr_b16 v[130:131], v4 offset:256
    ds_read_b64_tr_b16 v[132:133], v4 offset:1024
    ds_read_b64_tr_b16 v[134:135], v4 offset:1280
    ds_read_b64_tr_b16 v[136:137], v4 offset:2048
    ds_read_b64_tr_b16 v[138:139], v4 offset:2304
    ds_read_b64_tr_b16 v[140:141], v4 offset:3072
    ds_read_b64_tr_b16 v[142:143], v4 offset:3328
    s_waitcnt lgkmcnt(0)
    s_waitcnt vmcnt(25)
    ds_read_b64_tr_b16 v[144:145], v4 offset:4096
    ds_read_b64_tr_b16 v[146:147], v4 offset:4352
    ds_read_b64_tr_b16 v[148:149], v4 offset:5120
    ds_read_b64_tr_b16 v[150:151], v4 offset:5376
    ds_read_b64_tr_b16 v[152:153], v4 offset:6144
    ds_read_b64_tr_b16 v[154:155], v4 offset:6400
    ds_read_b64_tr_b16 v[156:157], v4 offset:7168
    ds_read_b64_tr_b16 v[158:159], v4 offset:7424
    s_waitcnt lgkmcnt(0)
    s_waitcnt vmcnt(21)
    ds_read_b64_tr_b16 v[160:161], v4 offset:8192
    ds_read_b64_tr_b16 v[162:163], v4 offset:8448
    ds_read_b64_tr_b16 v[164:165], v4 offset:9216
    ds_read_b64_tr_b16 v[166:167], v4 offset:9472
    ds_read_b64_tr_b16 v[168:169], v4 offset:10240
    ds_read_b64_tr_b16 v[170:171], v4 offset:10496
    ds_read_b64_tr_b16 v[172:173], v4 offset:11264
    ds_read_b64_tr_b16 v[174:175], v4 offset:11520
    s_waitcnt lgkmcnt(0)
    s_waitcnt vmcnt(17)
    ds_read_b64_tr_b16 v[176:177], v4 offset:12288
    ds_read_b64_tr_b16 v[178:179], v4 offset:12544
    ds_read_b64_tr_b16 v[180:181], v4 offset:13312
    ds_read_b64_tr_b16 v[182:183], v4 offset:13568
    ds_read_b64_tr_b16 v[184:185], v4 offset:14336
    ds_read_b64_tr_b16 v[186:187], v4 offset:14592
    ds_read_b64_tr_b16 v[188:189], v4 offset:15360
    ds_read_b64_tr_b16 v[190:191], v4 offset:15616
    s_waitcnt lgkmcnt(0)
    s_waitcnt vmcnt(13)
    ds_read_b64_tr_b16 v[192:193], v4 offset:16384
    ds_read_b64_tr_b16 v[194:195], v4 offset:16640
    ds_read_b64_tr_b16 v[196:197], v4 offset:17408
    ds_read_b64_tr_b16 v[198:199], v4 offset:17664
    ds_read_b64_tr_b16 v[200:201], v4 offset:18432
    ds_read_b64_tr_b16 v[202:203], v4 offset:18688
    ds_read_b64_tr_b16 v[204:205], v4 offset:19456
    ds_read_b64_tr_b16 v[206:207], v4 offset:19712
    s_waitcnt lgkmcnt(0)
    s_waitcnt vmcnt(9)
    ds_read_b64_tr_b16 v[208:209], v4 offset:20480
    ds_read_b64_tr_b16 v[210:211], v4 offset:20736
    ds_read_b64_tr_b16 v[212:213], v4 offset:21504
    ds_read_b64_tr_b16 v[214:215], v4 offset:21760
    ds_read_b64_tr_b16 v[216:217], v4 offset:22528
    ds_read_b64_tr_b16 v[218:219], v4 offset:22784
    ds_read_b64_tr_b16 v[220:221], v4 offset:23552
    ds_read_b64_tr_b16 v[222:223], v4 offset:23808
    s_waitcnt lgkmcnt(0)
    s_waitcnt vmcnt(5)
    ds_read_b64_tr_b16 v[224:225], v4 offset:24576
    ds_read_b64_tr_b16 v[226:227], v4 offset:24832
    ds_read_b64_tr_b16 v[228:229], v4 offset:25600
    ds_read_b64_tr_b16 v[230:231], v4 offset:25856
    ds_read_b64_tr_b16 v[232:233], v4 offset:26624
    ds_read_b64_tr_b16 v[234:235], v4 offset:26880
    ds_read_b64_tr_b16 v[236:237], v4 offset:27648
    ds_read_b64_tr_b16 v[238:239], v4 offset:27904
    s_waitcnt lgkmcnt(0)
    s_waitcnt vmcnt(1)
    ds_read_b64_tr_b16 v[240:241], v4 offset:28672
    ds_read_b64_tr_b16 v[242:243], v4 offset:28928
    ds_read_b64_tr_b16 v[244:245], v4 offset:29696
    ds_read_b64_tr_b16 v[246:247], v4 offset:29952
    ds_read_b64_tr_b16 v[248:249], v4 offset:30720
    ds_read_b64_tr_b16 v[250:251], v4 offset:30976
    ds_read_b64_tr_b16 v[252:253], v4 offset:31744
    ds_read_b64_tr_b16 v[254:255], v4 offset:32000
    s_waitcnt lgkmcnt(0)
    s_waitcnt vmcnt(0)
    v_cmp_gt_u32 vcc, 0x100, v14
    s_cbranch_vccz L_qrdy
L_rdyq:
    v_mov_b32_e64 v0, 64
    global_load_dword v0, v0, s[40:41] sc1
    s_waitcnt vmcnt(0)
    v_cmp_gt_u32 vcc, 0x100, v0
    s_cbranch_vccz L_rdyokq
    s_sub_u32 s96, s96, 1
    s_cbranch_scc0 L_rdyq
    s_branch L_abort
L_rdyokq:
L_qrdy:
    v_lshrrev_b32 v12, 2, v1
    s_mov_b32 s46, 65839104
L_qxn:
    buffer_load_dword v13, v12, s[4:7], s46 offen sc1
    s_waitcnt vmcnt(0)
    v_cmp_gt_i32 vcc, 0, v13
    s_cbranch_vccz L_qxnok
    s_sub_u32 s96, s96, 1
    s_cbranch_scc0 L_qxn
    s_branch L_abort
L_qxnok:
    s_barrier
    v_lshrrev_b32 v12, 5, v8
    v_and_b32 v13, 31, v8
    v_lshlrev_b32 v12, 10, v12
    v_lshl_add_u32 v12, v13, 4, v12
    s_lshl_b32 s46, s14, 13
    s_lshl_b32 s47, s13, 11
    s_add_u32 s46, s46, s47
    v_add_u32 v2, s46, v12
    s_lshl_b32 s48, s13, 13
    s_add_u32 s49, s48, 60817408
    s_add_u32 s50, s44, 1
    s_cmp_eq_u32 s44, 2
    s_cselect_b32 s50, 0, s50
    s_lshl_b32 s50, s50, 24
    s_mov_b32 s45, 0
    s_lshl_b32 s46, s14, 7
    s_lshl_b32 s47, s44, 2
    s_add_u32 s46, s46, s47
    v_mov_b32 v5, s46
    s_mov_b32 s51, 65830912
    s_add_u32 m0, s48, 0
    s_add_u32 s46, s49, 0
    buffer_load_dwordx4 v1, s[4:7], s46 offen offset:0 sc1 lds
    buffer_load_dwordx4 v1, s[4:7], s46 offen offset:1024 sc1 lds
    buffer_load_dwordx4 v1, s[4:7], s46 offen offset:2048 sc1 lds
    buffer_load_dwordx4 v1, s[4:7], s46 offen offset:3072 sc1 lds
    s_add_u32 m0, s48, 4096
    s_add_u32 s46, s49, 4096
    buffer_load_dwordx4 v1, s[4:7], s46 offen offset:0 sc1 lds
    buffer_load_dwordx4 v1, s[4:7], s46 offen offset:1024 sc1 lds
    buffer_load_dwordx4 v1, s[4:7], s46 offen offset:2048 sc1 lds
    buffer_load_dwordx4 v1, s[4:7], s46 offen offset:3072 sc1 lds
    s_add_u32 s49, s49, 32768
    s_add_u32 m0, s48, 32768
    s_add_u32 s46, s49, 0
    buffer_load_dwordx4 v1, s[4:7], s46 offen offset:0 sc1 lds
    buffer_load_dwordx4 v1, s[4:7], s46 offen offset:1024 sc1 lds
    buffer_load_dwordx4 v1, s[4:7], s46 offen offset:2048 sc1 lds
    buffer_load_dwordx4 v1, s[4:7], s46 offen offset:3072 sc1 lds
    s_add_u32 m0, s48, 36864
    s_add_u32 s46, s49, 4096
    buffer_load_dwordx4 v1, s[4:7], s46 offen offset:0 sc1 lds
    buffer_load_dwordx4 v1, s[4:7], s46 offen offset:1024 sc1 lds
    buffer_load_dwordx4 v1, s[4:7], s46 offen offset:2048 sc1 lds
    buffer_load_dwordx4 v1, s[4:7], s46 offen offset:3072 sc1 lds
    s_add_u32 s49, s49, 32768
    v_add_u32 v7, 65536, v1
    s_waitcnt vmcnt(8)
    s_barrier
    ds_read_b128 v[64:67], v1 offset:0
    ds_read_b128 v[68:71], v1 offset:1024
    ds_read_b128 v[72:75], v1 offset:2048
    ds_read_b128 v[76:79], v1 offset:3072
    ds_read_b128 v[80:83], v1 offset:4096
    ds_read_b128 v[84:87], v1 offset:5120
    s_waitcnt lgkmcnt(5)
    v_mfma_f32_32x32x16_bf16 v[16:31], v[128:131], v[64:67], 0
    ds_read_b128 v[88:91], v1 offset:6144
    s_add_u32 m0, s48, 65536
    s_add_u32 s46, s49, 0
    buffer_load_dwordx4 v1, s[4:7], s46 offen offset:0 sc1 lds
    s_waitcnt lgkmcnt(5)
    v_mfma_f32_32x32x16_bf16 v[16:31], v[132:135], v[68:71], v[16:31]
    ds_read_b128 v[92:95], v1 offset:7168
    buffer_load_dwordx4 v1, s[4:7], s46 offen offset:1024 sc1 lds
    s_waitcnt lgkmcnt(5)
    v_mfma_f32_32x32x16_bf16 v[16:31], v[136:139], v[72:75], v[16:31]
    ds_read_b128 v[64:67], v1 offset:8192
    buffer_load_dwordx4 v1, s[4:7], s46 offen offset:2048 sc1 lds
    s_waitcnt lgkmcnt(5)
    v_mfma_f32_32x32x16_bf16 v[16:31], v[140:143], v[76:79], v[16:31]
    ds_read_b128 v[68:71], v1 offset:9216
    buffer_load_dwordx4 v1, s[4:7], s46 offen offset:3072 sc1 lds
    s_waitcnt lgkmcnt(5)
    v_mfma_f32_32x32x16_bf16 v[16:31], v[144:147], v[80:83], v[16:31]
    ds_read_b128 v[72:75], v1 offset:10240
    s_add_u32 m0, s48, 69632
    s_add_u32 s46, s49, 4096
    buffer_load_dwordx4 v1, s[4:7], s46 offen offset:0 sc1 lds
    s_waitcnt lgkmcnt(5)
    v_mfma_f32_32x32x16_bf16 v[16:31], v[148:151], v[84:87], v[16:31]
    ds_read_b128 v[76:79], v1 offset:11264
    s_waitcnt lgkmcnt(5)
    v_mfma_f32_32x32x16_bf16 v[16:31], v[152:155], v[88:91], v[16:31]
    ds_read_b128 v[80:83], v1 offset:12288
    buffer_load_dwordx4 v1, s[4:7], s46 offen offset:1024 sc1 lds
    s_waitcnt lgkmcnt(5)
    v_mfma_f32_32x32x16_bf16 v[16:31], v[156:159], v[92:95], v[16:31]
    ds_read_b128 v[84:87], v1 offset:13312
    s_waitcnt lgkmcnt(5)
    v_mfma_f32_32x32x16_bf16 v[16:31], v[160:163], v[64:67], v[16:31]
    ds_read_b128 v[88:91], v1 offset:14336
    buffer_load_dwordx4 v1, s[4:7], s46 offen offset:2048 sc1 lds
    s_waitcnt lgkmcnt(5)
    v_mfma_f32_32x32x16_bf16 v[16:31], v[164:167], v[68:71], v[16:31]
    ds_read_b128 v[92:95], v1 offset:15360
    s_waitcnt lgkmcnt(5)
    v_mfma_f32_32x32x16_bf16 v[16:31], v[168:171], v[72:75], v[16:31]
    ds_read_b128 v[64:67], v1 offset:16384
    buffer_load_dwordx4 v1, s[4:7], s46 offen offset:3072 sc1 lds
    s_add_u32 s49, s49, 32768
    s_waitcnt lgkmcnt(5)
    v_mfma_f32_32x32x16_bf16 v[16:31], v[172:175], v[76:79], v[16:31]
    ds_read_b128 v[68:71], v1 offset:17408
    s_waitcnt lgkmcnt(5)
    v_mfma_f32_32x32x16_bf16 v[16:31], v[176:179], v[80:83], v[16:31]
    ds_read_b128 v[72:75], v1 offset:18432
    s_waitcnt lgkmcnt(5)
    v_mfma_f32_32x32x16_bf16 v[16:31], v[180:183], v[84:87], v[16:31]
    ds_read_b128 v[76:79], v1 offset:19456
    s_waitcnt lgkmcnt(5)
    v_mfma_f32_32x32x16_bf16 v[16:31], v[184:187], v[88:91], v[16:31]
    ds_read_b128 v[80:83], v1 offset:20480
    s_waitcnt lgkmcnt(5)
    v_mfma_f32_32x32x16_bf16 v[16:31], v[188:191], v[92:95], v[16:31]
    ds_read_b128 v[84:87], v1 offset:21504
    s_waitcnt lgkmcnt(5)
    v_mfma_f32_32x32x16_bf16 v[16:31], v[192:195], v[64:67], v[16:31]
    ds_read_b128 v[88:91], v1 offset:22528
    s_waitcnt lgkmcnt(5)
    v_mfma_f32_32x32x16_bf16 v[16:31], v[196:199], v[68:71], v[16:31]
    ds_read_b128 v[92:95], v1 offset:23552
    s_waitcnt lgkmcnt(5)
    v_mfma_f32_32x32x16_bf16 v[16:31], v[200:203], v[72:75], v[16:31]
    ds_read_b128 v[64:67], v1 offset:24576
    s_waitcnt lgkmcnt(5)
    v_mfma_f32_32x32x16_bf16 v[16:31], v[204:207], v[76:79], v[16:31]
    ds_read_b128 v[68:71], v1 offset:25600
    s_waitcnt lgkmcnt(5)
    v_mfma_f32_32x32x16_bf16 v[16:31], v[208:211], v[80:83], v[16:31]
    ds_read_b128 v[72:75], v1 offset:26624
    s_waitcnt lgkmcnt(5)
    v_mfma_f32_32x32x16_bf16 v[16:31], v[212:215], v[84:87], v[16:31]
    ds_read_b128 v[76:79], v1 offset:27648
    s_waitcnt lgkmcnt(5)
    v_mfma_f32_32x32x16_bf16 v[16:31], v[216:219], v[88:91], v[16:31]
    ds_read_b128 v[80:83], v1 offset:28672
    s_waitcnt lgkmcnt(5)
    v_mfma_f32_32x32x16_bf16 v[16:31], v[220:223], v[92:95], v[16:31]
    ds_read_b128 v[84:87], v1 offset:29696
    s_waitcnt lgkmcnt(5)
    v_mfma_f32_32x32x16_bf16 v[16:31], v[224:227], v[64:67], v[16:31]
    ds_read_b128 v[88:91], v1 offset:30720
    s_waitcnt lgkmcnt(5)
    v_mfma_f32_32x32x16_bf16 v[16:31], v[228:231], v[68:71], v[16:31]
    s_waitcnt vmcnt(8)
    s_barrier
    ds_read_b128 v[92:95], v1 offset:31744
    s_waitcnt lgkmcnt(5)
    v_mfma_f32_32x32x16_bf16 v[16:31], v[232:235], v[72:75], v[16:31]
    ds_read_b128 v[64:67], v1 offset:32768
    s_waitcnt lgkmcnt(5)
    v_mfma_f32_32x32x16_bf16 v[16:31], v[236:239], v[76:79], v[16:31]
    ds_read_b128 v[68:71], v1 offset:33792
    s_cmp_lg_u32 s13, 0
    s_cbranch_scc1 L_qnf01
    s_sub_u32 s46, s45, 2
    s_max_i32 s46, s46, -1
    v_mov_b32 v6, s46
    s_mov_b64 exec, 1
    buffer_store_dword v6, v5, s[4:7], s51 offen sc1
    s_mov_b64 exec, -1
L_qnf01:
    s_waitcnt lgkmcnt(5)
    v_mfma_f32_32x32x16_bf16 v[16:31], v[240:243], v[80:83], v[16:31]
    ds_read_b128 v[72:75], v1 offset:34816
    s_waitcnt lgkmcnt(5)
    v_mfma_f32_32x32x16_bf16 v[16:31], v[244:247], v[84:87], v[16:31]
    ds_read_b128 v[76:79], v1 offset:35840
    s_waitcnt lgkmcnt(5)
    v_mfma_f32_32x32x16_bf16 v[16:31], v[248:251], v[88:91], v[16:31]
    ds_read_b128 v[80:83], v1 offset:36864
    s_waitcnt lgkmcnt(5)
    v_mfma_f32_32x32x16_bf16 v[16:31], v[252:255], v[92:95], v[16:31]
    ds_read_b128 v[84:87], v1 offset:37888
    s_add_u32 s45, s45, 1
    s_branch L_qloop1
L_qloop:
    s_waitcnt lgkmcnt(5)
    v_mfma_f32_32x32x16_bf16 v[16:31], v[128:131], v[64:67], 0
    ds_read_b128 v[88:91], v1 offset:6144
    s_waitcnt lgkmcnt(5)
    v_mfma_f32_32x32x16_bf16 v[16:31], v[132:135], v[68:71], v[16:31]
    ds_read_b128 v[92:95], v1 offset:7168
    v_cvt_pk_bf16_f32 v96, v32, v33
    v_cvt_pk_bf16_f32 v97, v34, v35
    v_cvt_pk_bf16_f32 v98, v36, v37
    v_cvt_pk_bf16_f32 v99, v38, v39
    s_waitcnt lgkmcnt(5)
    v_mfma_f32_32x32x16_bf16 v[16:31], v[136:139], v[72:75], v[16:31]
    ds_read_b128 v[64:67], v1 offset:8192
    buffer_store_dwordx4 v[96:99], v2, s[4:7], s50 offen offset:0 sc1
    v_cvt_pk_bf16_f32 v100, v40, v41
    v_cvt_pk_bf16_f32 v101, v42, v43
    s_waitcnt lgkmcnt(5)
    v_mfma_f32_32x32x16_bf16 v[16:31], v[140:143], v[76:79], v[16:31]
    ds_read_b128 v[68:71], v1 offset:9216
    v_cvt_pk_bf16_f32 v102, v44, v45
    v_cvt_pk_bf16_f32 v103, v46, v47
    buffer_store_dwordx4 v[100:103], v2, s[4:7], s50 offen offset:512 sc1
    s_add_u32 s50, s50, 262144
    s_waitcnt lgkmcnt(5)
    v_mfma_f32_32x32x16_bf16 v[16:31], v[144:147], v[80:83], v[16:31]
    ds_read_b128 v[72:75], v1 offset:10240
    s_add_u32 m0, s48, 65536
    s_add_u32 s46, s49, 0
    buffer_load_dwordx4 v1, s[4:7], s46 offen offset:0 sc1 lds
    s_waitcnt lgkmcnt(5)
    v_mfma_f32_32x32x16_bf16 v[16:31], v[148:151], v[84:87], v[16:31]
    ds_read_b128 v[76:79], v1 offset:11264
    s_waitcnt lgkmcnt(5)
    v_mfma_f32_32x32x16_bf16 v[16:31], v[152:155], v[88:91], v[16:31]
    ds_read_b128 v[80:83], v1 offset:12288
    buffer_load_dwordx4 v1, s[4:7], s46 offen offset:1024 sc1 lds
    s_waitcnt lgkmcnt(5)
    v_mfma_f32_32x32x16_bf16 v[16:31], v[156:159], v[92:95], v[16:31]
    ds_read_b128 v[84:87], v1 offset:13312
    s_waitcnt lgkmcnt(5)
    v_mfma_f32_32x32x16_bf16 v[16:31], v[160:163], v[64:67], v[16:31]
    ds_read_b128 v[88:91], v1 offset:14336
    buffer_load_dwordx4 v1, s[4:7], s46 offen offset:2048 sc1 lds
    s_waitcnt lgkmcnt(5)
    v_mfma_f32_32x32x16_bf16 v[16:31], v[164:167], v[68:71], v[16:31]
    ds_read_b128 v[92:95], v1 offset:15360
    s_waitcnt lgkmcnt(5)
    v_mfma_f32_32x32x16_bf16 v[16:31], v[168:171], v[72:75], v[16:31]
    ds_read_b128 v[64:67], v1 offset:16384
    buffer_load_dwordx4 v1, s[4:7], s46 offen offset:3072 sc1 lds
    s_waitcnt lgkmcnt(5)
    v_mfma_f32_32x32x16_bf16 v[16:31], v[172:175], v[76:79], v[16:31]
    ds_read_b128 v[68:71], v1 offset:17408
    s_waitcnt lgkmcnt(5)
    v_mfma_f32_32x32x16_bf16 v[16:31], v[176:179], v[80:83], v[16:31]
    ds_read_b128 v[72:75], v1 offset:18432
    s_add_u32 m0, s48, 69632
    s_add_u32 s46, s49, 4096
    buffer_load_dwordx4 v1, s[4:7], s46 offen offset:0 sc1 lds
    s_waitcnt lgkmcnt(5)
    v_mfma_f32_32x32x16_bf16 v[16:31], v[180:183], v[84:87], v[16:31]
    ds_read_b128 v[76:79], v1 offset:19456
    s_waitcnt lgkmcnt(5)
    v_mfma_f32_32x32x16_bf16 v[16:31], v[184:187], v[88:91], v[16:31]
    ds_read_b128 v[80:83], v1 offset:20480
    buffer_load_dwordx4 v1, s[4:7], s46 offen offset:1024 sc1 lds
    s_waitcnt lgkmcnt(5)
    v_mfma_f32_32x32x16_bf16 v[16:31], v[188:191], v[92:95], v[16:31]
    ds_read_b128 v[84:87], v1 offset:21504
    s_waitcnt lgkmcnt(5)
    v_mfma_f32_32x32x16_bf16 v[16:31], v[192:195], v[64:67], v[16:31]
    ds_read_b128 v[88:91], v1 offset:22528
    buffer_load_dwordx4 v1, s[4:7], s46 offen offset:2048 sc1 lds
    s_waitcnt lgkmcnt(5)
    v_mfma_f32_32x32x16_bf16 v[16:31], v[196:199], v[68:71], v[16:31]
    ds_read_b128 v[92:95], v1 offset:23552
    s_waitcnt lgkmcnt(5)
    v_mfma_f32_32x32x16_bf16 v[16:31], v[200:203], v[72:75], v[16:31]
    ds_read_b128 v[64:67], v1 offset:24576
    buffer_load_dwordx4 v1, s[4:7], s46 offen offset:3072 sc1 lds
    s_add_u32 s49, s49, 32768
    s_waitcnt lgkmcnt(5)
    v_mfma_f32_32x32x16_bf16 v[16:31], v[204:207], v[76:79], v[16:31]
    ds_read_b128 v[68:71], v1 offset:25600
    s_waitcnt lgkmcnt(5)
    v_mfma_f32_32x32x16_bf16 v[16:31], v[208:211], v[80:83], v[16:31]
    ds_read_b128 v[72:75], v1 offset:26624
    s_waitcnt lgkmcnt(5)
    v_mfma_f32_32x32x16_bf16 v[16:31], v[212:215], v[84:87], v[16:31]
    ds_read_b128 v[76:79], v1 offset:27648
    s_waitcnt lgkmcnt(5)
    v_mfma_f32_32x32x16_bf16 v[16:31], v[216:219], v[88:91], v[16:31]
    ds_read_b128 v[80:83], v1 offset:28672
    s_waitcnt lgkmcnt(5)
    v_mfma_f32_32x32x16_bf16 v[16:31], v[220:223], v[92:95], v[16:31]
    ds_read_b128 v[84:87], v1 offset:29696
    s_waitcnt lgkmcnt(5)
    v_mfma_f32_32x32x16_bf16 v[16:31], v[224:227], v[64:67], v[16:31]
    ds_read_b128 v[88:91], v1 offset:30720
    s_waitcnt lgkmcnt(5)
    v_mfma_f32_32x32x16_bf16 v[16:31], v[228:231], v[68:71], v[16:31]
    s_waitcnt vmcnt(10)
    s_barrier
    ds_read_b128 v[92:95], v1 offset:31744
    s_waitcnt lgkmcnt(5)
    v_mfma_f32_32x32x16_bf16 v[16:31], v[232:235], v[72:75], v[16:31]
    ds_read_b128 v[64:67], v1 offset:32768
    s_waitcnt lgkmcnt(5)
    v_mfma_f32_32x32x16_bf16 v[16:31], v[236:239], v[76:79], v[16:31]
    ds_read_b128 v[68:71], v1 offset:33792
    s_cmp_lg_u32 s13, 0
    s_cbranch_scc1 L_qnf00
    s_sub_u32 s46, s45, 2
    s_max_i32 s46, s46, -1
    v_mov_b32 v6, s46
    s_mov_b64 exec, 1
    buffer_store_dword v6, v5, s[4:7], s51 offen sc1
    s_mov_b64 exec, -1
L_qnf00:
    s_waitcnt lgkmcnt(5)
    v_mfma_f32_32x32x16_bf16 v[16:31], v[240:243], v[80:83], v[16:31]
    ds_read_b128 v[72:75], v1 offset:34816
    s_waitcnt lgkmcnt(5)
    v_mfma_f32_32x32x16_bf16 v[16:31], v[244:247], v[84:87], v[16:31]
    ds_read_b128 v[76:79], v1 offset:35840
    s_waitcnt lgkmcnt(5)
    v_mfma_f32_32x32x16_bf16 v[16:31], v[248:251], v[88:91], v[16:31]
    ds_read_b128 v[80:83], v1 offset:36864
    s_waitcnt lgkmcnt(5)
    v_mfma_f32_32x32x16_bf16 v[16:31], v[252:255], v[92:95], v[16:31]
    ds_read_b128 v[84:87], v1 offset:37888
    s_add_u32 s45, s45, 1
L_qloop1:
    s_waitcnt lgkmcnt(5)
    v_mfma_f32_32x32x16_bf16 v[32:47], v[128:131], v[64:67], 0
    ds_read_b128 v[88:91], v1 offset:38912
    s_waitcnt lgkmcnt(5)
    v_mfma_f32_32x32x16_bf16 v[32:47], v[132:135], v[68:71], v[32:47]
    ds_read_b128 v[92:95], v1 offset:39936
    v_cvt_pk_bf16_f32 v96, v16, v17
    v_cvt_pk_bf16_f32 v97, v18, v19
    v_cvt_pk_bf16_f32 v98, v20, v21
    v_cvt_pk_bf16_f32 v99, v22, v23
    s_waitcnt lgkmcnt(5)
    v_mfma_f32_32x32x16_bf16 v[32:47], v[136:139], v[72:75], v[32:47]
    ds_read_b128 v[64:67], v1 offset:40960
    buffer_store_dwordx4 v[96:99], v2, s[4:7], s50 offen offset:0 sc1
    v_cvt_pk_bf16_f32 v100, v24, v25
    v_cvt_pk_bf16_f32 v101, v26, v27
    s_waitcnt lgkmcnt(5)
    v_mfma_f32_32x32x16_bf16 v[32:47], v[140:143], v[76:79], v[32:47]
    ds_read_b128 v[68:71], v1 offset:41984
    v_cvt_pk_bf16_f32 v102, v28, v29
    v_cvt_pk_bf16_f32 v103, v30, v31
    buffer_store_dwordx4 v[100:103], v2, s[4:7], s50 offen offset:512 sc1
    s_add_u32 s50, s50, 262144
    s_waitcnt lgkmcnt(5)
    v_mfma_f32_32x32x16_bf16 v[32:47], v[144:147], v[80:83], v[32:47]
    ds_read_b128 v[72:75], v1 offset:43008
    s_add_u32 m0, s48, 98304
    s_add_u32 s46, s49, 0
    buffer_load_dwordx4 v1, s[4:7], s46 offen offset:0 sc1 lds
    s_waitcnt lgkmcnt(5)
    v_mfma_f32_32x32x16_bf16 v[32:47], v[148:151], v[84:87], v[32:47]
    ds_read_b128 v[76:79], v1 offset:44032
    s_waitcnt lgkmcnt(5)
    v_mfma_f32_32x32x16_bf16 v[32:47], v[152:155], v[88:91], v[32:47]
    ds_read_b128 v[80:83], v1 offset:45056
    buffer_load_dwordx4 v1, s[4:7], s46 offen offset:1024 sc1 lds
    s_waitcnt lgkmcnt(5)
    v_mfma_f32_32x32x16_bf16 v[32:47], v[156:159], v[92:95], v[32:47]
    ds_read_b128 v[84:87], v1 offset:46080
    s_waitcnt lgkmcnt(5)
    v_mfma_f32_32x32x16_bf16 v[32:47], v[160:163], v[64:67], v[32:47]
    ds_read_b128 v[88:91], v1 offset:47104
    buffer_load_dwordx4 v1, s[4:7], s46 offen offset:2048 sc1 lds
    s_waitcnt lgkmcnt(5)
    v_mfma_f32_32x32x16_bf16 v[32:47], v[164:167], v[68:71], v[32:47]
    ds_read_b128 v[92:95], v1 offset:48128
    s_waitcnt lgkmcnt(5)
    v_mfma_f32_32x32x16_bf16 v[32:47], v[168:171], v[72:75], v[32:47]
    ds_read_b128 v[64:67], v1 offset:49152
    buffer_load_dwordx4 v1, s[4:7], s46 offen offset:3072 sc1 lds
    s_waitcnt lgkmcnt(5)
    v_mfma_f32_32x32x16_bf16 v[32:47], v[172:175], v[76:79], v[32:47]
    ds_read_b128 v[68:71], v1 offset:50176
    s_waitcnt lgkmcnt(5)
    v_mfma_f32_32x32x16_bf16 v[32:47], v[176:179], v[80:83], v[32:47]
    ds_read_b128 v[72:75], v1 offset:51200
    s_add_u32 m0, s48, 102400
    s_add_u32 s46, s49, 4096
    buffer_load_dwordx4 v1, s[4:7], s46 offen offset:0 sc1 lds
    s_waitcnt lgkmcnt(5)
    v_mfma_f32_32x32x16_bf16 v[32:47], v[180:183], v[84:87], v[32:47]
    ds_read_b128 v[76:79], v1 offset:52224
    s_waitcnt lgkmcnt(5)
    v_mfma_f32_32x32x16_bf16 v[32:47], v[184:187], v[88:91], v[32:47]
    ds_read_b128 v[80:83], v1 offset:53248
    buffer_load_dwordx4 v1, s[4:7], s46 offen offset:1024 sc1 lds
    s_waitcnt lgkmcnt(5)
    v_mfma_f32_32x32x16_bf16 v[32:47], v[188:191], v[92:95], v[32:47]
    ds_read_b128 v[84:87], v1 offset:54272
    s_waitcnt lgkmcnt(5)
    v_mfma_f32_32x32x16_bf16 v[32:47], v[192:195], v[64:67], v[32:47]
    ds_read_b128 v[88:91], v1 offset:55296
    buffer_load_dwordx4 v1, s[4:7], s46 offen offset:2048 sc1 lds
    s_waitcnt lgkmcnt(5)
    v_mfma_f32_32x32x16_bf16 v[32:47], v[196:199], v[68:71], v[32:47]
    ds_read_b128 v[92:95], v1 offset:56320
    s_waitcnt lgkmcnt(5)
    v_mfma_f32_32x32x16_bf16 v[32:47], v[200:203], v[72:75], v[32:47]
    ds_read_b128 v[64:67], v1 offset:57344
    buffer_load_dwordx4 v1, s[4:7], s46 offen offset:3072 sc1 lds
    s_add_u32 s49, s49, 32768
    s_waitcnt lgkmcnt(5)
    v_mfma_f32_32x32x16_bf16 v[32:47], v[204:207], v[76:79], v[32:47]
    ds_read_b128 v[68:71], v1 offset:58368
    s_waitcnt lgkmcnt(5)
    v_mfma_f32_32x32x16_bf16 v[32:47], v[208:211], v[80:83], v[32:47]
    ds_read_b128 v[72:75], v1 offset:59392
    s_waitcnt lgkmcnt(5)
    v_mfma_f32_32x32x16_bf16 v[32:47], v[212:215], v[84:87], v[32:47]
    ds_read_b128 v[76:79], v1 offset:60416
    s_waitcnt lgkmcnt(5)
    v_mfma_f32_32x32x16_bf16 v[32:47], v[216:219], v[88:91], v[32:47]
    ds_read_b128 v[80:83], v1 offset:61440
    s_waitcnt lgkmcnt(5)
    v_mfma_f32_32x32x16_bf16 v[32:47], v[220:223], v[92:95], v[32:47]
    ds_read_b128 v[84:87], v1 offset:62464
    s_waitcnt lgkmcnt(5)
    v_mfma_f32_32x32x16_bf16 v[32:47], v[224:227], v[64:67], v[32:47]
    ds_read_b128 v[88:91], v1 offset:63488
    s_waitcnt lgkmcnt(5)
    v_mfma_f32_32x32x16_bf16 v[32:47], v[228:231], v[68:71], v[32:47]
    s_waitcnt vmcnt(10)
    s_barrier
    ds_read_b128 v[92:95], v1 offset:64512
    s_waitcnt lgkmcnt(5)
    v_mfma_f32_32x32x16_bf16 v[32:47], v[232:235], v[72:75], v[32:47]
    ds_read_b128 v[64:67], v7 offset:0
    s_waitcnt lgkmcnt(5)
    v_mfma_f32_32x32x16_bf16 v[32:47], v[236:239], v[76:79], v[32:47]
    ds_read_b128 v[68:71], v7 offset:1024
    s_cmp_lg_u32 s13, 0
    s_cbranch_scc1 L_qnf10
    s_sub_u32 s46, s45, 2
    s_max_i32 s46, s46, -1
    v_mov_b32_e64 v6, s46
    s_mov_b64 exec, 1
    buffer_store_dword v6, v5, s[4:7], s51 offen sc1
    s_mov_b64 exec, -1
L_qnf10:
    s_waitcnt lgkmcnt(5)
    v_mfma_f32_32x32x16_bf16 v[32:47], v[240:243], v[80:83], v[32:47]
    ds_read_b128 v[72:75], v7 offset:2048
    s_waitcnt lgkmcnt(5)
    v_mfma_f32_32x32x16_bf16 v[32:47], v[244:247], v[84:87], v[32:47]
    ds_read_b128 v[76:79], v7 offset:3072
    s_waitcnt lgkmcnt(5)
    v_mfma_f32_32x32x16_bf16 v[32:47], v[248:251], v[88:91], v[32:47]
    ds_read_b128 v[80:83], v7 offset:4096
    s_waitcnt lgkmcnt(5)
    v_mfma_f32_32x32x16_bf16 v[32:47], v[252:255], v[92:95], v[32:47]
    ds_read_b128 v[84:87], v7 offset:5120
    s_add_u32 s45, s45, 1
    s_waitcnt lgkmcnt(5)
    v_mfma_f32_32x32x16_bf16 v[16:31], v[128:131], v[64:67], 0
    ds_read_b128 v[88:91], v7 offset:6144
    s_waitcnt lgkmcnt(5)
    v_mfma_f32_32x32x16_bf16 v[16:31], v[132:135], v[68:71], v[16:31]
    ds_read_b128 v[92:95], v7 offset:7168
    v_cvt_pk_bf16_f32 v96, v32, v33
    v_cvt_pk_bf16_f32 v97, v34, v35
    v_cvt_pk_bf16_f32 v98, v36, v37
    v_cvt_pk_bf16_f32 v99, v38, v39
    s_waitcnt lgkmcnt(5)
    v_mfma_f32_32x32x16_bf16 v[16:31], v[136:139], v[72:75], v[16:31]
    ds_read_b128 v[64:67], v7 offset:8192
    buffer_store_dwordx4 v[96:99], v2, s[4:7], s50 offen offset:0 sc1
    v_cvt_pk_bf16_f32 v100, v40, v41
    v_cvt_pk_bf16_f32 v101, v42, v43
    s_waitcnt lgkmcnt(5)
    v_mfma_f32_32x32x16_bf16 v[16:31], v[140:143], v[76:79], v[16:31]
    ds_read_b128 v[68:71], v7 offset:9216
    v_cvt_pk_bf16_f32 v102, v44, v45
    v_cvt_pk_bf16_f32 v103, v46, v47
    buffer_store_dwordx4 v[100:103], v2, s[4:7], s50 offen offset:512 sc1
    s_add_u32 s50, s50, 262144
    s_waitcnt lgkmcnt(5)
    v_mfma_f32_32x32x16_bf16 v[16:31], v[144:147], v[80:83], v[16:31]
    ds_read_b128 v[72:75], v7 offset:10240
    s_add_u32 m0, s48, 0
    s_add_u32 s46, s49, 0
    buffer_load_dwordx4 v1, s[4:7], s46 offen offset:0 sc1 lds
    s_waitcnt lgkmcnt(5)
    v_mfma_f32_32x32x16_bf16 v[16:31], v[148:151], v[84:87], v[16:31]
    ds_read_b128 v[76:79], v7 offset:11264
    s_waitcnt lgkmcnt(5)
    v_mfma_f32_32x32x16_bf16 v[16:31], v[152:155], v[88:91], v[16:31]
    ds_read_b128 v[80:83], v7 offset:12288
    buffer_load_dwordx4 v1, s[4:7], s46 offen offset:1024 sc1 lds
    s_waitcnt lgkmcnt(5)
    v_mfma_f32_32x32x16_bf16 v[16:31], v[156:159], v[92:95], v[16:31]
    ds_read_b128 v[84:87], v7 offset:13312
    s_waitcnt lgkmcnt(5)
    v_mfma_f32_32x32x16_bf16 v[16:31], v[160:163], v[64:67], v[16:31]
    ds_read_b128 v[88:91], v7 offset:14336
    buffer_load_dwordx4 v1, s[4:7], s46 offen offset:2048 sc1 lds
    s_waitcnt lgkmcnt(5)
    v_mfma_f32_32x32x16_bf16 v[16:31], v[164:167], v[68:71], v[16:31]
    ds_read_b128 v[92:95], v7 offset:15360
    s_waitcnt lgkmcnt(5)
    v_mfma_f32_32x32x16_bf16 v[16:31], v[168:171], v[72:75], v[16:31]
    ds_read_b128 v[64:67], v7 offset:16384
    buffer_load_dwordx4 v1, s[4:7], s46 offen offset:3072 sc1 lds
    s_waitcnt lgkmcnt(5)
    v_mfma_f32_32x32x16_bf16 v[16:31], v[172:175], v[76:79], v[16:31]
    ds_read_b128 v[68:71], v7 offset:17408
    s_waitcnt lgkmcnt(5)
    v_mfma_f32_32x32x16_bf16 v[16:31], v[176:179], v[80:83], v[16:31]
    ds_read_b128 v[72:75], v7 offset:18432
    s_add_u32 m0, s48, 4096
    s_add_u32 s46, s49, 4096
    buffer_load_dwordx4 v1, s[4:7], s46 offen offset:0 sc1 lds
    s_waitcnt lgkmcnt(5)
    v_mfma_f32_32x32x16_bf16 v[16:31], v[180:183], v[84:87], v[16:31]
    ds_read_b128 v[76:79], v7 offset:19456
    s_waitcnt lgkmcnt(5)
    v_mfma_f32_32x32x16_bf16 v[16:31], v[184:187], v[88:91], v[16:31]
    ds_read_b128 v[80:83], v7 offset:20480
    buffer_load_dwordx4 v1, s[4:7], s46 offen offset:1024 sc1 lds
    s_waitcnt lgkmcnt(5)
    v_mfma_f32_32x32x16_bf16 v[16:31], v[188:191], v[92:95], v[16:31]
    ds_read_b128 v[84:87], v7 offset:21504
    s_waitcnt lgkmcnt(5)
    v_mfma_f32_32x32x16_bf16 v[16:31], v[192:195], v[64:67], v[16:31]
    ds_read_b128 v[88:91], v7 offset:22528
    buffer_load_dwordx4 v1, s[4:7], s46 offen offset:2048 sc1 lds
    s_waitcnt lgkmcnt(5)
    v_mfma_f32_32x32x16_bf16 v[16:31], v[196:199], v[68:71], v[16:31]
    ds_read_b128 v[92:95], v7 offset:23552
    s_waitcnt lgkmcnt(5)
    v_mfma_f32_32x32x16_bf16 v[16:31], v[200:203], v[72:75], v[16:31]
    ds_read_b128 v[64:67], v7 offset:24576
    buffer_load_dwordx4 v1, s[4:7], s46 offen offset:3072 sc1 lds
    s_add_u32 s49, s49, 32768
    s_waitcnt lgkmcnt(5)
    v_mfma_f32_32x32x16_bf16 v[16:31], v[204:207], v[76:79], v[16:31]
    ds_read_b128 v[68:71], v7 offset:25600
    s_waitcnt lgkmcnt(5)
    v_mfma_f32_32x32x16_bf16 v[16:31], v[208:211], v[80:83], v[16:31]
    ds_read_b128 v[72:75], v7 offset:26624
    s_waitcnt lgkmcnt(5)
    v_mfma_f32_32x32x16_bf16 v[16:31], v[212:215], v[84:87], v[16:31]
    ds_read_b128 v[76:79], v7 offset:27648
    s_waitcnt lgkmcnt(5)
    v_mfma_f32_32x32x16_bf16 v[16:31], v[216:219], v[88:91], v[16:31]
    ds_read_b128 v[80:83], v7 offset:28672
    s_waitcnt lgkmcnt(5)
    v_mfma_f32_32x32x16_bf16 v[16:31], v[220:223], v[92:95], v[16:31]
    ds_read_b128 v[84:87], v7 offset:29696
    s_waitcnt lgkmcnt(5)
    v_mfma_f32_32x32x16_bf16 v[16:31], v[224:227], v[64:67], v[16:31]
    ds_read_b128 v[88:91], v7 offset:30720
    s_waitcnt lgkmcnt(5)
    v_mfma_f32_32x32x16_bf16 v[16:31], v[228:231], v[68:71], v[16:31]
    s_waitcnt vmcnt(10)
    s_barrier
    ds_read_b128 v[92:95], v7 offset:31744
    s_waitcnt lgkmcnt(5)
    v_mfma_f32_32x32x16_bf16 v[16:31], v[232:235], v[72:75], v[16:31]
    ds_read_b128 v[64:67], v7 offset:32768
    s_waitcnt lgkmcnt(5)
    v_mfma_f32_32x32x16_bf16 v[16:31], v[236:239], v[76:79], v[16:31]
    ds_read_b128 v[68:71], v7 offset:33792
    s_cmp_lg_u32 s13, 0
    s_cbranch_scc1 L_qnf20
    s_sub_u32 s46, s45, 2
    s_max_i32 s46, s46, -1
    v_mov_b32 v6, s46
    s_mov_b64 exec, 1
    buffer_store_dword v6, v5, s[4:7], s51 offen sc1
    s_mov_b64 exec, -1
L_qnf20:
    s_waitcnt lgkmcnt(5)
    v_mfma_f32_32x32x16_bf16 v[16:31], v[240:243], v[80:83], v[16:31]
    ds_read_b128 v[72:75], v7 offset:34816
    s_waitcnt lgkmcnt(5)
    v_mfma_f32_32x32x16_bf16 v[16:31], v[244:247], v[84:87], v[16:31]
    ds_read_b128 v[76:79], v7 offset:35840
    s_waitcnt lgkmcnt(5)
    v_mfma_f32_32x32x16_bf16 v[16:31], v[248:251], v[88:91], v[16:31]
    ds_read_b128 v[80:83], v7 offset:36864
    s_waitcnt lgkmcnt(5)
    v_mfma_f32_32x32x16_bf16 v[16:31], v[252:255], v[92:95], v[16:31]
    ds_read_b128 v[84:87], v7 offset:37888
    s_add_u32 s45, s45, 1
    s_waitcnt lgkmcnt(5)
    v_mfma_f32_32x32x16_bf16 v[32:47], v[128:131], v[64:67], 0
    ds_read_b128 v[88:91], v7 offset:38912
    s_waitcnt lgkmcnt(5)
    v_mfma_f32_32x32x16_bf16 v[32:47], v[132:135], v[68:71], v[32:47]
    ds_read_b128 v[92:95], v7 offset:39936
    v_cvt_pk_bf16_f32 v96, v16, v17
    v_cvt_pk_bf16_f32 v97, v18, v19
    v_cvt_pk_bf16_f32 v98, v20, v21
    v_cvt_pk_bf16_f32 v99, v22, v23
    s_waitcnt lgkmcnt(5)
    v_mfma_f32_32x32x16_bf16 v[32:47], v[136:139], v[72:75], v[32:47]
    ds_read_b128 v[64:67], v7 offset:40960
    buffer_store_dwordx4 v[96:99], v2, s[4:7], s50 offen offset:0 sc1
    v_cvt_pk_bf16_f32 v100, v24, v25
    v_cvt_pk_bf16_f32 v101, v26, v27
    s_waitcnt lgkmcnt(5)
    v_mfma_f32_32x32x16_bf16 v[32:47], v[140:143], v[76:79], v[32:47]
    ds_read_b128 v[68:71], v7 offset:41984
    v_cvt_pk_bf16_f32 v102, v28, v29
    v_cvt_pk_bf16_f32 v103, v30, v31
    buffer_store_dwordx4 v[100:103], v2, s[4:7], s50 offen offset:512 sc1
    s_add_u32 s50, s50, 262144
    s_waitcnt lgkmcnt(5)
    v_mfma_f32_32x32x16_bf16 v[32:47], v[144:147], v[80:83], v[32:47]
    ds_read_b128 v[72:75], v7 offset:43008
    s_add_u32 m0, s48, 32768
    s_add_u32 s46, s49, 0
    buffer_load_dwordx4 v1, s[4:7], s46 offen offset:0 sc1 lds
    s_waitcnt lgkmcnt(5)
    v_mfma_f32_32x32x16_bf16 v[32:47], v[148:151], v[84:87], v[32:47]
    ds_read_b128 v[76:79], v7 offset:44032
    s_waitcnt lgkmcnt(5)
    v_mfma_f32_32x32x16_bf16 v[32:47], v[152:155], v[88:91], v[32:47]
    ds_read_b128 v[80:83], v7 offset:45056
    buffer_load_dwordx4 v1, s[4:7], s46 offen offset:1024 sc1 lds
    s_waitcnt lgkmcnt(5)
    v_mfma_f32_32x32x16_bf16 v[32:47], v[156:159], v[92:95], v[32:47]
    ds_read_b128 v[84:87], v7 offset:46080
    s_waitcnt lgkmcnt(5)
    v_mfma_f32_32x32x16_bf16 v[32:47], v[160:163], v[64:67], v[32:47]
    ds_read_b128 v[88:91], v7 offset:47104
    buffer_load_dwordx4 v1, s[4:7], s46 offen offset:2048 sc1 lds
    s_waitcnt lgkmcnt(5)
    v_mfma_f32_32x32x16_bf16 v[32:47], v[164:167], v[68:71], v[32:47]
    ds_read_b128 v[92:95], v7 offset:48128
    s_waitcnt lgkmcnt(5)
    v_mfma_f32_32x32x16_bf16 v[32:47], v[168:171], v[72:75], v[32:47]
    ds_read_b128 v[64:67], v7 offset:49152
    buffer_load_dwordx4 v1, s[4:7], s46 offen offset:3072 sc1 lds
    s_waitcnt lgkmcnt(5)
    v_mfma_f32_32x32x16_bf16 v[32:47], v[172:175], v[76:79], v[32:47]
    ds_read_b128 v[68:71], v7 offset:50176
    s_waitcnt lgkmcnt(5)
    v_mfma_f32_32x32x16_bf16 v[32:47], v[176:179], v[80:83], v[32:47]
    ds_read_b128 v[72:75], v7 offset:51200
    s_add_u32 m0, s48, 36864
    s_add_u32 s46, s49, 4096
    buffer_load_dwordx4 v1, s[4:7], s46 offen offset:0 sc1 lds
    s_waitcnt lgkmcnt(5)
    v_mfma_f32_32x32x16_bf16 v[32:47], v[180:183], v[84:87], v[32:47]
    ds_read_b128 v[76:79], v7 offset:52224
    s_waitcnt lgkmcnt(5)
    v_mfma_f32_32x32x16_bf16 v[32:47], v[184:187], v[88:91], v[32:47]
    ds_read_b128 v[80:83], v7 offset:53248
    buffer_load_dwordx4 v1, s[4:7], s46 offen offset:1024 sc1 lds
    s_waitcnt lgkmcnt(5)
    v_mfma_f32_32x32x16_bf16 v[32:47], v[188:191], v[92:95], v[32:47]
    ds_read_b128 v[84:87], v7 offset:54272
    s_waitcnt lgkmcnt(5)
    v_mfma_f32_32x32x16_bf16 v[32:47], v[192:195], v[64:67], v[32:47]
    ds_read_b128 v[88:91], v7 offset:55296
    buffer_load_dwordx4 v1, s[4:7], s46 offen offset:2048 sc1 lds
    s_waitcnt lgkmcnt(5)
    v_mfma_f32_32x32x16_bf16 v[32:47], v[196:199], v[68:71], v[32:47]
    ds_read_b128 v[92:95], v7 offset:56320
    s_waitcnt lgkmcnt(5)
    v_mfma_f32_32x32x16_bf16 v[32:47], v[200:203], v[72:75], v[32:47]
    ds_read_b128 v[64:67], v7 offset:57344
    buffer_load_dwordx4 v1, s[4:7], s46 offen offset:3072 sc1 lds
    s_add_u32 s49, s49, 32768
    s_waitcnt lgkmcnt(5)
    v_mfma_f32_32x32x16_bf16 v[32:47], v[204:207], v[76:79], v[32:47]
    ds_read_b128 v[68:71], v7 offset:58368
    s_waitcnt lgkmcnt(5)
    v_mfma_f32_32x32x16_bf16 v[32:47], v[208:211], v[80:83], v[32:47]
    ds_read_b128 v[72:75], v7 offset:59392
    s_waitcnt lgkmcnt(5)
    v_mfma_f32_32x32x16_bf16 v[32:47], v[212:215], v[84:87], v[32:47]
    ds_read_b128 v[76:79], v7 offset:60416
    s_waitcnt lgkmcnt(5)
    v_mfma_f32_32x32x16_bf16 v[32:47], v[216:219], v[88:91], v[32:47]
    ds_read_b128 v[80:83], v7 offset:61440
    s_waitcnt lgkmcnt(5)
    v_mfma_f32_32x32x16_bf16 v[32:47], v[220:223], v[92:95], v[32:47]
    ds_read_b128 v[84:87], v7 offset:62464
    s_waitcnt lgkmcnt(5)
    v_mfma_f32_32x32x16_bf16 v[32:47], v[224:227], v[64:67], v[32:47]
    ds_read_b128 v[88:91], v7 offset:63488
    s_waitcnt lgkmcnt(5)
    v_mfma_f32_32x32x16_bf16 v[32:47], v[228:231], v[68:71], v[32:47]
    s_waitcnt vmcnt(10)
    s_barrier
    ds_read_b128 v[92:95], v7 offset:64512
    s_waitcnt lgkmcnt(5)
    v_mfma_f32_32x32x16_bf16 v[32:47], v[232:235], v[72:75], v[32:47]
    ds_read_b128 v[64:67], v1 offset:0
    s_waitcnt lgkmcnt(5)
    v_mfma_f32_32x32x16_bf16 v[32:47], v[236:239], v[76:79], v[32:47]
    ds_read_b128 v[68:71], v1 offset:1024
    s_cmp_lg_u32 s13, 0
    s_cbranch_scc1 L_qnf30
    s_sub_u32 s46, s45, 2
    s_max_i32 s46, s46, -1
    v_mov_b32_e64 v6, s46
    s_mov_b64 exec, 1
    buffer_store_dword v6, v5, s[4:7], s51 offen sc1
    s_mov_b64 exec, -1
L_qnf30:
    s_waitcnt lgkmcnt(5)
    v_mfma_f32_32x32x16_bf16 v[32:47], v[240:243], v[80:83], v[32:47]
    ds_read_b128 v[72:75], v1 offset:2048
    s_waitcnt lgkmcnt(5)
    v_mfma_f32_32x32x16_bf16 v[32:47], v[244:247], v[84:87], v[32:47]
    ds_read_b128 v[76:79], v1 offset:3072
    s_waitcnt lgkmcnt(5)
    v_mfma_f32_32x32x16_bf16 v[32:47], v[248:251], v[88:91], v[32:47]
    ds_read_b128 v[80:83], v1 offset:4096
    s_waitcnt lgkmcnt(5)
    v_mfma_f32_32x32x16_bf16 v[32:47], v[252:255], v[92:95], v[32:47]
    ds_read_b128 v[84:87], v1 offset:5120
    s_add_u32 s45, s45, 1
    s_cmp_lt_u32 s45, 64
    s_cbranch_scc1 L_qloop
    s_waitcnt lgkmcnt(0)
    s_nop 9
    v_cvt_pk_bf16_f32 v96, v32, v33
    v_cvt_pk_bf16_f32 v97, v34, v35
    v_cvt_pk_bf16_f32 v98, v36, v37
    v_cvt_pk_bf16_f32 v99, v38, v39
    buffer_store_dwordx4 v[96:99], v2, s[4:7], s50 offen offset:0 sc1
    v_cvt_pk_bf16_f32 v100, v40, v41
    v_cvt_pk_bf16_f32 v101, v42, v43
    v_cvt_pk_bf16_f32 v102, v44, v45
    v_cvt_pk_bf16_f32 v103, v46, v47
    buffer_store_dwordx4 v[100:103], v2, s[4:7], s50 offen offset:512 sc1
    s_add_u32 s50, s50, 262144
    s_waitcnt vmcnt(0)
    s_barrier
    s_cmp_lg_u32 s13, 0
    s_cbranch_scc1 L_qnfend
    s_sub_u32 s46, s45, 1
    s_max_i32 s46, s46, -1
    v_mov_b32 v6, s46
    s_mov_b64 exec, 1
    buffer_store_dword v6, v5, s[4:7], s51 offen sc1
    s_mov_b64 exec, -1
L_qnfend:
    v_mbcnt_lo_u32_b32 v0, -1, 0
    v_mbcnt_hi_u32_b32 v0, -1, v0
    s_branch L_post
L_post:
    v_and_b32 v24, 63, v0
    v_lshlrev_b32 v1, 4, v24
    s_min_u32 s53, s14, 27
    v_lshrrev_b32 v14, 1, v24
    v_mul_u32_u24 v14, 3584, v14
    v_and_b32_e64 v15, 1, v24
    v_lshl_add_u32 v14, v15, 4, v14
    s_lshl_b32 s46, s53, 7
    s_lshl_b32 s47, s13, 5
    s_add_u32 s46, s46, s47
    v_add_u32 v29, s46, v14
    v_lshrrev_b32 v14, 5, v24
    v_bfe_u32 v15, v24, 2, 2
    v_lshl_add_u32 v14, v14, 3, v15
    v_lshlrev_b32 v14, 5, v14
    v_bfe_u32 v15, v24, 4, 1
    v_lshl_add_u32 v14, v15, 11, v14
    v_and_b32_e64 v15, 1, v24
    v_lshl_add_u32 v14, v15, 4, v14
    v_bfe_u32 v15, v24, 1, 1
    v_lshl_add_u32 v14, v15, 3, v14
    s_lshl_b32 s52, s13, 15
    v_add_u32 v30, s52, v14
    s_mov_b32 s8, s32
    s_and_b32 s9, s33, 0xffff
    s_mov_b32 s10, 1835008
    s_mov_b32 s11, 0x20000
    s_mov_b32 s56, s34
    s_and_b32 s57, s35, 0xffff
    s_mov_b32 s58, 1835008
    s_mov_b32 s59, 0x20000
    s_add_u32 m0, s52, 0
    s_mov_b32 s46, 0
    buffer_load_dwordx4 v29, s[8:11], s46 offen lds
    s_add_u32 m0, s52, 1024
    s_mov_b32 s46, 114688
    buffer_load_dwordx4 v29, s[8:11], s46 offen lds
    s_add_u32 m0, s52, 2048
    s_mov_b32 s46, 0
    buffer_load_dwordx4 v29, s[56:59], s46 offen lds
    s_add_u32 m0, s52, 3072
    s_mov_b32 s46, 114688
    buffer_load_dwordx4 v29, s[56:59], s46 offen lds
    s_add_u32 m0, s52, 4096
    s_mov_b32 s46, 229376
    buffer_load_dwordx4 v29, s[8:11], s46 offen lds
    s_add_u32 m0, s52, 5120
    s_mov_b32 s46, 344064
    buffer_load_dwordx4 v29, s[8:11], s46 offen lds
    s_add_u32 m0, s52, 6144
    s_mov_b32 s46, 229376
    buffer_load_dwordx4 v29, s[56:59], s46 offen lds
    s_add_u32 m0, s52, 7168
    s_mov_b32 s46, 344064
    buffer_load_dwordx4 v29, s[56:59], s46 offen lds
    s_add_u32 m0, s52, 8192
    s_mov_b32 s46, 458752
    buffer_load_dwordx4 v29, s[8:11], s46 offen lds
    s_add_u32 m0, s52, 9216
    s_mov_b32 s46, 573440
    buffer_load_dwordx4 v29, s[8:11], s46 offen lds
    s_add_u32 m0, s52, 10240
    s_mov_b32 s46, 458752
    buffer_load_dwordx4 v29, s[56:59], s46 offen lds
    s_add_u32 m0, s52, 11264
    s_mov_b32 s46, 573440
    buffer_load_dwordx4 v29, s[56:59], s46 offen lds
    s_add_u32 m0, s52, 12288
    s_mov_b32 s46, 688128
    buffer_load_dwordx4 v29, s[8:11], s46 offen lds
    s_add_u32 m0, s52, 13312
    s_mov_b32 s46, 802816
    buffer_load_dwordx4 v29, s[8:11], s46 offen lds
    s_add_u32 m0, s52, 14336
    s_mov_b32 s46, 688128
    buffer_load_dwordx4 v29, s[56:59], s46 offen lds
    s_add_u32 m0, s52, 15360
    s_mov_b32 s46, 802816
    buffer_load_dwordx4 v29, s[56:59], s46 offen lds
    s_add_u32 m0, s52, 16384
    s_mov_b32 s46, 917504
    buffer_load_dwordx4 v29, s[8:11], s46 offen lds
    s_add_u32 m0, s52, 17408
    s_mov_b32 s46, 1032192
    buffer_load_dwordx4 v29, s[8:11], s46 offen lds
    s_add_u32 m0, s52, 18432
    s_mov_b32 s46, 917504
    buffer_load_dwordx4 v29, s[56:59], s46 offen lds
    s_add_u32 m0, s52, 19456
    s_mov_b32 s46, 1032192
    buffer_load_dwordx4 v29, s[56:59], s46 offen lds
    s_add_u32 m0, s52, 20480
    s_mov_b32 s46, 1146880
    buffer_load_dwordx4 v29, s[8:11], s46 offen lds
    s_add_u32 m0, s52, 21504
    s_mov_b32 s46, 1261568
    buffer_load_dwordx4 v29, s[8:11], s46 offen lds
    s_add_u32 m0, s52, 22528
    s_mov_b32 s46, 1146880
    buffer_load_dwordx4 v29, s[56:59], s46 offen lds
    s_add_u32 m0, s52, 23552
    s_mov_b32 s46, 1261568
    buffer_load_dwordx4 v29, s[56:59], s46 offen lds
    s_add_u32 m0, s52, 24576
    s_mov_b32 s46, 1376256
    buffer_load_dwordx4 v29, s[8:11], s46 offen lds
    s_add_u32 m0, s52, 25600
    s_mov_b32 s46, 1490944
    buffer_load_dwordx4 v29, s[8:11], s46 offen lds
    s_add_u32 m0, s52, 26624
    s_mov_b32 s46, 1376256
    buffer_load_dwordx4 v29, s[56:59], s46 offen lds
    s_add_u32 m0, s52, 27648
    s_mov_b32 s46, 1490944
    buffer_load_dwordx4 v29, s[56:59], s46 offen lds
    s_add_u32 m0, s52, 28672
    s_mov_b32 s46, 1605632
    buffer_load_dwordx4 v29, s[8:11], s46 offen lds
    s_add_u32 m0, s52, 29696
    s_mov_b32 s46, 1720320
    buffer_load_dwordx4 v29, s[8:11], s46 offen lds
    s_add_u32 m0, s52, 30720
    s_mov_b32 s46, 1605632
    buffer_load_dwordx4 v29, s[56:59], s46 offen lds
    s_add_u32 m0, s52, 31744
    s_mov_b32 s46, 1720320
    buffer_load_dwordx4 v29, s[56:59], s46 offen lds
    v_lshrrev_b32 v14, 4, v24
    v_lshlrev_b32 v14, 13, v14
    v_and_b32 v15, 15, v24
    v_lshl_add_u32 v14, v15, 4, v14
    s_lshl_b32 s46, s13, 8
    v_add_u32 v14, s46, v14
    s_mov_b32 s47, 0x05040100
    s_mov_b32 s48, 0x07060302
    s_lshl_b32 s52, s14, 17
    s_lshl_b32 s53, s53, 16
    s_mov_b32 s8, s26
    s_and_b32 s9, s27, 0xffff
    s_mov_b32 s10, 4194304
    s_mov_b32 s11, 0x20000
    s_mov_b32 s56, s36
    s_and_b32 s57, s37, 0xffff
    s_mov_b32 s58, 1835008
    s_mov_b32 s59, 0x20000
    s_add_u32 s46, s52, 0
    buffer_load_dwordx4 v[32:35], v14, s[8:11], s46 offen
    s_add_u32 s46, s52, 1024
    buffer_load_dwordx4 v[36:39], v14, s[8:11], s46 offen
    s_add_u32 s46, s52, 2048
    buffer_load_dwordx4 v[40:43], v14, s[8:11], s46 offen
    s_add_u32 s46, s52, 3072
    buffer_load_dwordx4 v[44:47], v14, s[8:11], s46 offen
    s_add_u32 s46, s52, 4096
    buffer_load_dwordx4 v[48:51], v14, s[8:11], s46 offen
    s_add_u32 s46, s52, 5120
    buffer_load_dwordx4 v[52:55], v14, s[8:11], s46 offen
    s_add_u32 s46, s52, 6144
    buffer_load_dwordx4 v[56:59], v14, s[8:11], s46 offen
    s_add_u32 s46, s52, 7168
    buffer_load_dwordx4 v[60:63], v14, s[8:11], s46 offen
    s_add_u32 s46, s52, 32768
    buffer_load_dwordx4 v[64:67], v14, s[8:11], s46 offen
    s_add_u32 s46, s52, 33792
    buffer_load_dwordx4 v[68:71], v14, s[8:11], s46 offen
    s_add_u32 s46, s52, 34816
    buffer_load_dwordx4 v[72:75], v14, s[8:11], s46 offen
    s_add_u32 s46, s52, 35840
    buffer_load_dwordx4 v[76:79], v14, s[8:11], s46 offen
    s_add_u32 s46, s52, 36864
    buffer_load_dwordx4 v[80:83], v14, s[8:11], s46 offen
    s_add_u32 s46, s52, 37888
    buffer_load_dwordx4 v[84:87], v14, s[8:11], s46 offen
    s_add_u32 s46, s52, 38912
    buffer_load_dwordx4 v[88:91], v14, s[8:11], s46 offen
    s_add_u32 s46, s52, 39936
    buffer_load_dwordx4 v[92:95], v14, s[8:11], s46 offen
    s_add_u32 s46, s52, 65536
    buffer_load_dwordx4 v[96:99], v14, s[8:11], s46 offen
    s_add_u32 s46, s52, 66560
    buffer_load_dwordx4 v[100:103], v14, s[8:11], s46 offen
    s_add_u32 s46, s52, 67584
    buffer_load_dwordx4 v[104:107], v14, s[8:11], s46 offen
    s_add_u32 s46, s52, 68608
    buffer_load_dwordx4 v[108:111], v14, s[8:11], s46 offen
    s_add_u32 s46, s52, 69632
    buffer_load_dwordx4 v[112:115], v14, s[8:11], s46 offen
    s_add_u32 s46, s52, 70656
    buffer_load_dwordx4 v[116:119], v14, s[8:11], s46 offen
    s_add_u32 s46, s52, 71680
    buffer_load_dwordx4 v[120:123], v14, s[8:11], s46 offen
    s_add_u32 s46, s52, 72704
    buffer_load_dwordx4 v[124:127], v14, s[8:11], s46 offen
    s_waitcnt vmcnt(52)
    ds_read_b64_tr_b16 a[128:129], v30 offset:0
    ds_read_b64_tr_b16 a[130:131], v30 offset:128
    ds_read_b64_tr_b16 a[132:133], v30 offset:512
    ds_read_b64_tr_b16 a[134:135], v30 offset:640
    ds_read_b64_tr_b16 a[136:137], v30 offset:1024
    ds_read_b64_tr_b16 a[138:139], v30 offset:1152
    ds_read_b64_tr_b16 a[140:141], v30 offset:1536
    ds_read_b64_tr_b16 a[142:143], v30 offset:1664
    s_waitcnt lgkmcnt(0)
    s_waitcnt vmcnt(48)
    ds_read_b64_tr_b16 a[144:145], v30 offset:4096
    ds_read_b64_tr_b16 a[146:147], v30 offset:4224
    ds_read_b64_tr_b16 a[148:149], v30 offset:4608
    ds_read_b64_tr_b16 a[150:151], v30 offset:4736
    ds_read_b64_tr_b16 a[152:153], v30 offset:5120
    ds_read_b64_tr_b16 a[154:155], v30 offset:5248
    ds_read_b64_tr_b16 a[156:157], v30 offset:5632
    ds_read_b64_tr_b16 a[158:159], v30 offset:5760
    s_waitcnt lgkmcnt(0)
    s_add_u32 s46, s52, 98304
    buffer_load_dwordx4 v[128:131], v14, s[8:11], s46 offen
    s_add_u32 s46, s52, 99328
    buffer_load_dwordx4 v[132:135], v14, s[8:11], s46 offen
    s_add_u32 s46, s52, 100352
    buffer_load_dwordx4 v[136:139], v14, s[8:11], s46 offen
    s_add_u32 s46, s52, 101376
    buffer_load_dwordx4 v[140:143], v14, s[8:11], s46 offen
    s_add_u32 s46, s52, 102400
    buffer_load_dwordx4 v[144:147], v14, s[8:11], s46 offen
    s_add_u32 s46, s52, 103424
    buffer_load_dwordx4 v[148:151], v14, s[8:11], s46 offen
    s_add_u32 s46, s52, 104448
    buffer_load_dwordx4 v[152:155], v14, s[8:11], s46 offen
    s_add_u32 s46, s52, 105472
    buffer_load_dwordx4 v[156:159], v14, s[8:11], s46 offen
    s_waitcnt vmcnt(52)
    ds_read_b64_tr_b16 a[160:161], v30 offset:8192
    ds_read_b64_tr_b16 a[162:163], v30 offset:8320
    ds_read_b64_tr_b16 a[164:165], v30 offset:8704
    ds_read_b64_tr_b16 a[166:167], v30 offset:8832
    ds_read_b64_tr_b16 a[168:169], v30 offset:9216
    ds_read_b64_tr_b16 a[170:171], v30 offset:9344
    ds_read_b64_tr_b16 a[172:173], v30 offset:9728
    ds_read_b64_tr_b16 a[174:175], v30 offset:9856
    s_waitcnt lgkmcnt(0)
    s_waitcnt vmcnt(48)
    ds_read_b64_tr_b16 a[176:177], v30 offset:12288
    ds_read_b64_tr_b16 a[178:179], v30 offset:12416
    ds_read_b64_tr_b16 a[180:181], v30 offset:12800
    ds_read_b64_tr_b16 a[182:183], v30 offset:12928
    ds_read_b64_tr_b16 a[184:185], v30 offset:13312
    ds_read_b64_tr_b16 a[186:187], v30 offset:13440
    ds_read_b64_tr_b16 a[188:189], v30 offset:13824
    ds_read_b64_tr_b16 a[190:191], v30 offset:13952
    s_waitcnt lgkmcnt(0)
    s_waitcnt vmcnt(44)
    ds_read_b64_tr_b16 a[192:193], v30 offset:16384
    ds_read_b64_tr_b16 a[194:195], v30 offset:16512
    ds_read_b64_tr_b16 a[196:197], v30 offset:16896
    ds_read_b64_tr_b16 a[198:199], v30 offset:17024
    ds_read_b64_tr_b16 a[200:201], v30 offset:17408
    ds_read_b64_tr_b16 a[202:203], v30 offset:17536
    ds_read_b64_tr_b16 a[204:205], v30 offset:17920
    ds_read_b64_tr_b16 a[206:207], v30 offset:18048
    s_waitcnt lgkmcnt(0)
    s_waitcnt vmcnt(40)
    ds_read_b64_tr_b16 a[208:209], v30 offset:20480
    ds_read_b64_tr_b16 a[210:211], v30 offset:20608
    ds_read_b64_tr_b16 a[212:213], v30 offset:20992
    ds_read_b64_tr_b16 a[214:215], v30 offset:21120
    ds_read_b64_tr_b16 a[216:217], v30 offset:21504
    ds_read_b64_tr_b16 a[218:219], v30 offset:21632
    ds_read_b64_tr_b16 a[220:221], v30 offset:22016
    ds_read_b64_tr_b16 a[222:223], v30 offset:22144
    s_waitcnt lgkmcnt(0)
    s_waitcnt vmcnt(36)
    ds_read_b64_tr_b16 a[224:225], v30 offset:24576
    ds_read_b64_tr_b16 a[226:227], v30 offset:24704
    ds_read_b64_tr_b16 a[228:229], v30 offset:25088
    ds_read_b64_tr_b16 a[230:231], v30 offset:25216
    ds_read_b64_tr_b16 a[232:233], v30 offset:25600
    ds_read_b64_tr_b16 a[234:235], v30 offset:25728
    ds_read_b64_tr_b16 a[236:237], v30 offset:26112
    ds_read_b64_tr_b16 a[238:239], v30 offset:26240
    s_waitcnt lgkmcnt(0)
    s_waitcnt vmcnt(32)
    ds_read_b64_tr_b16 a[240:241], v30 offset:28672
    ds_read_b64_tr_b16 a[242:243], v30 offset:28800
    ds_read_b64_tr_b16 a[244:245], v30 offset:29184
    ds_read_b64_tr_b16 a[246:247], v30 offset:29312
    ds_read_b64_tr_b16 a[248:249], v30 offset:29696
    ds_read_b64_tr_b16 a[250:251], v30 offset:29824
    ds_read_b64_tr_b16 a[252:253], v30 offset:30208
    ds_read_b64_tr_b16 a[254:255], v30 offset:30336
    s_waitcnt lgkmcnt(0)
    s_waitcnt vmcnt(24)
    v_perm_b32 v160, v36, v32, s47
    v_accvgpr_write_b32 a0, v160
    v_perm_b32 v161, v44, v40, s47
    v_accvgpr_write_b32 a1, v161
    v_perm_b32 v162, v52, v48, s47
    v_accvgpr_write_b32 a2, v162
    v_perm_b32 v163, v60, v56, s47
    v_accvgpr_write_b32 a3, v163
    v_perm_b32 v160, v36, v32, s48
    v_accvgpr_write_b32 a16, v160
    v_perm_b32 v161, v44, v40, s48
    v_accvgpr_write_b32 a17, v161
    v_perm_b32 v162, v52, v48, s48
    v_accvgpr_write_b32 a18, v162
    v_perm_b32 v163, v60, v56, s48
    v_accvgpr_write_b32 a19, v163
    v_perm_b32 v160, v37, v33, s47
    v_accvgpr_write_b32 a32, v160
    v_perm_b32 v161, v45, v41, s47
    v_accvgpr_write_b32 a33, v161
    v_perm_b32 v162, v53, v49, s47
    v_accvgpr_write_b32 a34, v162
    v_perm_b32 v163, v61, v57, s47
    v_accvgpr_write_b32 a35, v163
    v_perm_b32 v160, v37, v33, s48
    v_accvgpr_write_b32 a48, v160
    v_perm_b32 v161, v45, v41, s48
    v_accvgpr_write_b32 a49, v161
    v_perm_b32 v162, v53, v49, s48
    v_accvgpr_write_b32 a50, v162
    v_perm_b32 v163, v61, v57, s48
    v_accvgpr_write_b32 a51, v163
    v_perm_b32 v160, v38, v34, s47
    v_accvgpr_write_b32 a64, v160
    v_perm_b32 v161, v46, v42, s47
    v_accvgpr_write_b32 a65, v161
    v_perm_b32 v162, v54, v50, s47
    v_accvgpr_write_b32 a66, v162
    v_perm_b32 v163, v62, v58, s47
    v_accvgpr_write_b32 a67, v163
    v_perm_b32 v160, v38, v34, s48
    v_accvgpr_write_b32 a80, v160
    v_perm_b32 v161, v46, v42, s48
    v_accvgpr_write_b32 a81, v161
    v_perm_b32 v162, v54, v50, s48
    v_accvgpr_write_b32 a82, v162
    v_perm_b32 v163, v62, v58, s48
    v_accvgpr_write_b32 a83, v163
    v_perm_b32 v160, v39, v35, s47
    v_accvgpr_write_b32 a96, v160
    v_perm_b32 v161, v47, v43, s47
    v_accvgpr_write_b32 a97, v161
    v_perm_b32 v162, v55, v51, s47
    v_accvgpr_write_b32 a98, v162
    v_perm_b32 v163, v63, v59, s47
    v_accvgpr_write_b32 a99, v163
    v_perm_b32 v160, v39, v35, s48
    v_accvgpr_write_b32 a112, v160
    v_perm_b32 v161, v47, v43, s48
    v_accvgpr_write_b32 a113, v161
    v_perm_b32 v162, v55, v51, s48
    v_accvgpr_write_b32 a114, v162
    v_perm_b32 v163, v63, v59, s48
    v_accvgpr_write_b32 a115, v163
    s_add_u32 s46, s53, 0
    buffer_load_dwordx4 v[32:35], v14, s[56:59], s46 offen
    s_add_u32 s46, s53, 1024
    buffer_load_dwordx4 v[36:39], v14, s[56:59], s46 offen
    s_add_u32 s46, s53, 2048
    buffer_load_dwordx4 v[40:43], v14, s[56:59], s46 offen
    s_add_u32 s46, s53, 3072
    buffer_load_dwordx4 v[44:47], v14, s[56:59], s46 offen
    s_add_u32 s46, s53, 4096
    buffer_load_dwordx4 v[48:51], v14, s[56:59], s46 offen
    s_add_u32 s46, s53, 5120
    buffer_load_dwordx4 v[52:55], v14, s[56:59], s46 offen
    s_add_u32 s46, s53, 6144
    buffer_load_dwordx4 v[56:59], v14, s[56:59], s46 offen
    s_add_u32 s46, s53, 7168
    buffer_load_dwordx4 v[60:63], v14, s[56:59], s46 offen
    s_waitcnt vmcnt(24)
    v_perm_b32 v160, v68, v64, s47
    v_accvgpr_write_b32 a4, v160
    v_perm_b32 v161, v76, v72, s47
    v_accvgpr_write_b32 a5, v161
    v_perm_b32 v162, v84, v80, s47
    v_accvgpr_write_b32 a6, v162
    v_perm_b32 v163, v92, v88, s47
    v_accvgpr_write_b32 a7, v163
    v_perm_b32 v160, v68, v64, s48
    v_accvgpr_write_b32 a20, v160
    v_perm_b32 v161, v76, v72, s48
    v_accvgpr_write_b32 a21, v161
    v_perm_b32 v162, v84, v80, s48
    v_accvgpr_write_b32 a22, v162
    v_perm_b32 v163, v92, v88, s48
    v_accvgpr_write_b32 a23, v163
    v_perm_b32 v160, v69, v65, s47
    v_accvgpr_write_b32 a36, v160
    v_perm_b32 v161, v77, v73, s47
    v_accvgpr_write_b32 a37, v161
    v_perm_b32 v162, v85, v81, s47
    v_accvgpr_write_b32 a38, v162
    v_perm_b32 v163, v93, v89, s47
    v_accvgpr_write_b32 a39, v163
    v_perm_b32 v160, v69, v65, s48
    v_accvgpr_write_b32 a52, v160
    v_perm_b32 v161, v77, v73, s48
    v_accvgpr_write_b32 a53, v161
    v_perm_b32 v162, v85, v81, s48
    v_accvgpr_write_b32 a54, v162
    v_perm_b32 v163, v93, v89, s48
    v_accvgpr_write_b32 a55, v163
    v_perm_b32 v160, v70, v66, s47
    v_accvgpr_write_b32 a68, v160
    v_perm_b32 v161, v78, v74, s47
    v_accvgpr_write_b32 a69, v161
    v_perm_b32 v162, v86, v82, s47
    v_accvgpr_write_b32 a70, v162
    v_perm_b32 v163, v94, v90, s47
    v_accvgpr_write_b32 a71, v163
    v_perm_b32 v160, v70, v66, s48
    v_accvgpr_write_b32 a84, v160
    v_perm_b32 v161, v78, v74, s48
    v_accvgpr_write_b32 a85, v161
    v_perm_b32 v162, v86, v82, s48
    v_accvgpr_write_b32 a86, v162
    v_perm_b32 v163, v94, v90, s48
    v_accvgpr_write_b32 a87, v163
    v_perm_b32 v160, v71, v67, s47
    v_accvgpr_write_b32 a100, v160
    v_perm_b32 v161, v79, v75, s47
    v_accvgpr_write_b32 a101, v161
    v_perm_b32 v162, v87, v83, s47
    v_accvgpr_write_b32 a102, v162
    v_perm_b32 v163, v95, v91, s47
    v_accvgpr_write_b32 a103, v163
    v_perm_b32 v160, v71, v67, s48
    v_accvgpr_write_b32 a116, v160
    v_perm_b32 v161, v79, v75, s48
    v_accvgpr_write_b32 a117, v161
    v_perm_b32 v162, v87, v83, s48
    v_accvgpr_write_b32 a118, v162
    v_perm_b32 v163, v95, v91, s48
    v_accvgpr_write_b32 a119, v163
    s_add_u32 s46, s53, 32768
    buffer_load_dwordx4 v[64:67], v14, s[56:59], s46 offen
    s_add_u32 s46, s53, 33792
    buffer_load_dwordx4 v[68:71], v14, s[56:59], s46 offen
    s_add_u32 s46, s53, 34816
    buffer_load_dwordx4 v[72:75], v14, s[56:59], s46 offen
    s_add_u32 s46, s53, 35840
    buffer_load_dwordx4 v[76:79], v14, s[56:59], s46 offen
    s_add_u32 s46, s53, 36864
    buffer_load_dwordx4 v[80:83], v14, s[56:59], s46 offen
    s_add_u32 s46, s53, 37888
    buffer_load_dwordx4 v[84:87], v14, s[56:59], s46 offen
    s_add_u32 s46, s53, 38912
    buffer_load_dwordx4 v[88:91], v14, s[56:59], s46 offen
    s_add_u32 s46, s53, 39936
    buffer_load_dwordx4 v[92:95], v14, s[56:59], s46 offen
    s_waitcnt vmcnt(24)
    v_perm_b32 v160, v100, v96, s47
    v_accvgpr_write_b32 a8, v160
    v_perm_b32 v161, v108, v104, s47
    v_accvgpr_write_b32 a9, v161
    v_perm_b32 v162, v116, v112, s47
    v_accvgpr_write_b32 a10, v162
    v_perm_b32 v163, v124, v120, s47
    v_accvgpr_write_b32 a11, v163
    v_perm_b32 v160, v100, v96, s48
    v_accvgpr_write_b32 a24, v160
    v_perm_b32 v161, v108, v104, s48
    v_accvgpr_write_b32 a25, v161
    v_perm_b32 v162, v116, v112, s48
    v_accvgpr_write_b32 a26, v162
    v_perm_b32 v163, v124, v120, s48
    v_accvgpr_write_b32 a27, v163
    v_perm_b32 v160, v101, v97, s47
    v_accvgpr_write_b32 a40, v160
    v_perm_b32 v161, v109, v105, s47
    v_accvgpr_write_b32 a41, v161
    v_perm_b32 v162, v117, v113, s47
    v_accvgpr_write_b32 a42, v162
    v_perm_b32 v163, v125, v121, s47
    v_accvgpr_write_b32 a43, v163
    v_perm_b32 v160, v101, v97, s48
    v_accvgpr_write_b32 a56, v160
    v_perm_b32 v161, v109, v105, s48
    v_accvgpr_write_b32 a57, v161
    v_perm_b32 v162, v117, v113, s48
    v_accvgpr_write_b32 a58, v162
    v_perm_b32 v163, v125, v121, s48
    v_accvgpr_write_b32 a59, v163
    v_perm_b32 v160, v102, v98, s47
    v_accvgpr_write_b32 a72, v160
    v_perm_b32 v161, v110, v106, s47
    v_accvgpr_write_b32 a73, v161
    v_perm_b32 v162, v118, v114, s47
    v_accvgpr_write_b32 a74, v162
    v_perm_b32 v163, v126, v122, s47
    v_accvgpr_write_b32 a75, v163
    v_perm_b32 v160, v102, v98, s48
    v_accvgpr_write_b32 a88, v160
    v_perm_b32 v161, v110, v106, s48
    v_accvgpr_write_b32 a89, v161
    v_perm_b32 v162, v118, v114, s48
    v_accvgpr_write_b32 a90, v162
    v_perm_b32 v163, v126, v122, s48
    v_accvgpr_write_b32 a91, v163
    v_perm_b32 v160, v103, v99, s47
    v_accvgpr_write_b32 a104, v160
    v_perm_b32 v161, v111, v107, s47
    v_accvgpr_write_b32 a105, v161
    v_perm_b32 v162, v119, v115, s47
    v_accvgpr_write_b32 a106, v162
    v_perm_b32 v163, v127, v123, s47
    v_accvgpr_write_b32 a107, v163
    v_perm_b32 v160, v103, v99, s48
    v_accvgpr_write_b32 a120, v160
    v_perm_b32 v161, v111, v107, s48
    v_accvgpr_write_b32 a121, v161
    v_perm_b32 v162, v119, v115, s48
    v_accvgpr_write_b32 a122, v162
    v_perm_b32 v163, v127, v123, s48
    v_accvgpr_write_b32 a123, v163
    s_waitcnt vmcnt(16)
    v_perm_b32 v160, v132, v128, s47
    v_accvgpr_write_b32 a12, v160
    v_perm_b32 v161, v140, v136, s47
    v_accvgpr_write_b32 a13, v161
    v_perm_b32 v162, v148, v144, s47
    v_accvgpr_write_b32 a14, v162
    v_perm_b32 v163, v156, v152, s47
    v_accvgpr_write_b32 a15, v163
    v_perm_b32 v160, v132, v128, s48
    v_accvgpr_write_b32 a28, v160
    v_perm_b32 v161, v140, v136, s48
    v_accvgpr_write_b32 a29, v161
    v_perm_b32 v162, v148, v144, s48
    v_accvgpr_write_b32 a30, v162
    v_perm_b32 v163, v156, v152, s48
    v_accvgpr_write_b32 a31, v163
    v_perm_b32 v160, v133, v129, s47
    v_accvgpr_write_b32 a44, v160
    v_perm_b32 v161, v141, v137, s47
    v_accvgpr_write_b32 a45, v161
    v_perm_b32 v162, v149, v145, s47
    v_accvgpr_write_b32 a46, v162
    v_perm_b32 v163, v157, v153, s47
    v_accvgpr_write_b32 a47, v163
    v_perm_b32 v160, v133, v129, s48
    v_accvgpr_write_b32 a60, v160
    v_perm_b32 v161, v141, v137, s48
    v_accvgpr_write_b32 a61, v161
    v_perm_b32 v162, v149, v145, s48
    v_accvgpr_write_b32 a62, v162
    v_perm_b32 v163, v157, v153, s48
    v_accvgpr_write_b32 a63, v163
    v_perm_b32 v160, v134, v130, s47
    v_accvgpr_write_b32 a76, v160
    v_perm_b32 v161, v142, v138, s47
    v_accvgpr_write_b32 a77, v161
    v_perm_b32 v162, v150, v146, s47
    v_accvgpr_write_b32 a78, v162
    v_perm_b32 v163, v158, v154, s47
    v_accvgpr_write_b32 a79, v163
    v_perm_b32 v160, v134, v130, s48
    v_accvgpr_write_b32 a92, v160
    v_perm_b32 v161, v142, v138, s48
    v_accvgpr_write_b32 a93, v161
    v_perm_b32 v162, v150, v146, s48
    v_accvgpr_write_b32 a94, v162
    v_perm_b32 v163, v158, v154, s48
    v_accvgpr_write_b32 a95, v163
    v_perm_b32 v160, v135, v131, s47
    v_accvgpr_write_b32 a108, v160
    v_perm_b32 v161, v143, v139, s47
    v_accvgpr_write_b32 a109, v161
    v_perm_b32 v162, v151, v147, s47
    v_accvgpr_write_b32 a110, v162
    v_perm_b32 v163, v159, v155, s47
    v_accvgpr_write_b32 a111, v163
    v_perm_b32 v160, v135, v131, s48
    v_accvgpr_write_b32 a124, v160
    v_perm_b32 v161, v143, v139, s48
    v_accvgpr_write_b32 a125, v161
    v_perm_b32 v162, v151, v147, s48
    v_accvgpr_write_b32 a126, v162
    v_perm_b32 v163, v159, v155, s48
    v_accvgpr_write_b32 a127, v163
    s_waitcnt vmcnt(8)
    v_perm_b32 v192, v36, v32, s47
    v_perm_b32 v193, v44, v40, s47
    v_perm_b32 v194, v52, v48, s47
    v_perm_b32 v195, v60, v56, s47
    v_perm_b32 v200, v36, v32, s48
    v_perm_b32 v201, v44, v40, s48
    v_perm_b32 v202, v52, v48, s48
    v_perm_b32 v203, v60, v56, s48
    v_perm_b32 v208, v37, v33, s47
    v_perm_b32 v209, v45, v41, s47
    v_perm_b32 v210, v53, v49, s47
    v_perm_b32 v211, v61, v57, s47
    v_perm_b32 v216, v37, v33, s48
    v_perm_b32 v217, v45, v41, s48
    v_perm_b32 v218, v53, v49, s48
    v_perm_b32 v219, v61, v57, s48
    v_perm_b32 v224, v38, v34, s47
    v_perm_b32 v225, v46, v42, s47
    v_perm_b32 v226, v54, v50, s47
    v_perm_b32 v227, v62, v58, s47
    v_perm_b32 v232, v38, v34, s48
    v_perm_b32 v233, v46, v42, s48
    v_perm_b32 v234, v54, v50, s48
    v_perm_b32 v235, v62, v58, s48
    v_perm_b32 v240, v39, v35, s47
    v_perm_b32 v241, v47, v43, s47
    v_perm_b32 v242, v55, v51, s47
    v_perm_b32 v243, v63, v59, s47
    v_perm_b32 v248, v39, v35, s48
    v_perm_b32 v249, v47, v43, s48
    v_perm_b32 v250, v55, v51, s48
    v_perm_b32 v251, v63, v59, s48
    s_waitcnt vmcnt(0)
    v_perm_b32 v196, v68, v64, s47
    v_perm_b32 v197, v76, v72, s47
    v_perm_b32 v198, v84, v80, s47
    v_perm_b32 v199, v92, v88, s47
    v_perm_b32 v204, v68, v64, s48
    v_perm_b32 v205, v76, v72, s48
    v_perm_b32 v206, v84, v80, s48
    v_perm_b32 v207, v92, v88, s48
    v_perm_b32 v212, v69, v65, s47
    v_perm_b32 v213, v77, v73, s47
    v_perm_b32 v214, v85, v81, s47
    v_perm_b32 v215, v93, v89, s47
    v_perm_b32 v220, v69, v65, s48
    v_perm_b32 v221, v77, v73, s48
    v_perm_b32 v222, v85, v81, s48
    v_perm_b32 v223, v93, v89, s48
    v_perm_b32 v228, v70, v66, s47
    v_perm_b32 v229, v78, v74, s47
    v_perm_b32 v230, v86, v82, s47
    v_perm_b32 v231, v94, v90, s47
    v_perm_b32 v236, v70, v66, s48
    v_perm_b32 v237, v78, v74, s48
    v_perm_b32 v238, v86, v82, s48
    v_perm_b32 v239, v94, v90, s48
    v_perm_b32 v244, v71, v67, s47
    v_perm_b32 v245, v79, v75, s47
    v_perm_b32 v246, v87, v83, s47
    v_perm_b32 v247, v95, v91, s47
    v_perm_b32 v252, v71, v67, s48
    v_perm_b32 v253, v79, v75, s48
    v_perm_b32 v254, v87, v83, s48
    v_perm_b32 v255, v95, v91, s48
    v_lshrrev_b32 v25, 4, v24
    v_and_b32 v26, 15, v24
    v_lshrrev_b32 v27, 2, v26
    v_and_b32_e64 v28, 3, v24
    s_and_b32 s46, s13, 1
    s_lshr_b32 s47, s13, 1
    v_lshlrev_b32 v2, 9, v25
    v_lshl_add_u32 v2, v26, 4, v2
    s_lshl_b32 s48, s46, 8
    v_add_u32 v3, s48, v2
    v_lshrrev_b32 v14, 1, v28
    v_and_b32_e64 v15, 1, v28
    v_lshlrev_b32 v4, 10, v28
    v_lshl_add_u32 v4, v15, 5, v4
    v_lshl_add_u32 v4, v14, 7, v4
    v_lshl_add_u32 v29, v25, 3, v27
    v_lshl_add_u32 v4, v29, 3, v4
    v_lshlrev_b32 v5, 9, v14
    v_lshl_add_u32 v29, v25, 2, v27
    v_lshl_add_u32 v5, v29, 4, v5
    v_lshl_add_u32 v5, v15, 3, v5
    s_lshl_b32 s48, s47, 12
    v_add_u32 v5, s48, v5
    v_and_b32 v14, 1, v25
    v_lshrrev_b32 v15, 1, v25
    v_lshlrev_b32 v6, 10, v25
    v_lshl_add_u32 v6, v14, 5, v6
    v_lshl_add_u32 v6, v15, 7, v6
    v_lshl_add_u32 v6, v26, 3, v6
    s_lshl_b32 s48, s47, 9
    v_add_u32 v6, s48, v6
    v_lshlrev_b32 v7, 9, v15
    v_lshl_add_u32 v7, v26, 4, v7
    v_lshl_add_u32 v7, v14, 3, v7
    s_lshl_b32 s48, s47, 12
    s_lshl_b32 s53, s46, 8
    s_add_u32 s48, s48, s53
    v_add_u32 v7, s48, v7
    s_lshl_b32 s48, s46, 4
    v_add_u32 v29, s48, v26
    v_lshlrev_b32 v30, 2, v25
    v_sub_u32 v29, v29, v30
    v_mov_b32 v30, 0xf149f2ca
    v_cmp_gt_i32 vcc, 0, v29
    s_nop 1
    v_cndmask_b32 v32, 0, v30, vcc
    v_cmp_gt_i32 vcc, 1, v29
    s_nop 1
    v_cndmask_b32 v33, 0, v30, vcc
    v_cmp_gt_i32 vcc, 2, v29
    s_nop 1
    v_cndmask_b32 v34, 0, v30, vcc
    v_cmp_gt_i32 vcc, 3, v29
    s_nop 1
    v_cndmask_b32 v35, 0, v30, vcc
    v_cmp_gt_i32 vcc, 16, v29
    s_nop 1
    v_cndmask_b32 v36, 0, v30, vcc
    v_cmp_gt_i32 vcc, 17, v29
    s_nop 1
    v_cndmask_b32 v37, 0, v30, vcc
    v_cmp_gt_i32 vcc, 18, v29
    s_nop 1
    v_cndmask_b32 v38, 0, v30, vcc
    v_cmp_gt_i32 vcc, 19, v29
    s_nop 1
    v_cndmask_b32 v39, 0, v30, vcc
    v_lshlrev_b32 v29, 17, v25
    v_lshl_add_u32 v29, v26, 4, v29
    s_lshl_b32 s48, s14, 10
    s_lshl_b32 s53, s13, 8
    s_add_u32 s48, s48, s53
    v_add_u32 v8, s48, v29
    v_lshlrev_b32 v29, 10, v25
    v_lshl_add_u32 v29, v26, 4, v29
    s_lshl_b32 s48, s14, 15
    s_add_u32 s48, s48, s53
    v_add_u32 v9, s48, v29
    v_lshlrev_b32 v29, 4, v26
    v_lshl_add_u32 v29, v14, 3, v29
    s_lshl_b32 s48, s14, 10
    s_add_u32 s48, s48, s53
    v_add_u32 v10, s48, v29
    v_lshlrev_b32 v29, 9, v26
    v_lshl_add_u32 v29, v14, 3, v29
    s_lshl_b32 s48, s13, 13
    s_lshl_b32 s53, s14, 4
    s_add_u32 s48, s48, s53
    v_add_u32 v11, s48, v29
    v_and_b32 v29, 31, v24
    v_lshlrev_b32 v12, 2, v29
    s_lshl_b32 s48, s14, 7
    v_mov_b32 v29, 4096
    v_cmp_gt_u32 vcc, 12, v12
    s_nop 1
    v_cndmask_b32 v29, v29, v12, vcc
    v_add_u32 v13, s48, v29
    s_lshl_b32 s70, s13, 10
    s_and_b32 s48, s13, 1
    s_lshl_b32 s48, s48, 5
    s_add_u32 s68, s70, s48
    s_and_b32 s48, s13, 2
    s_lshl_b32 s48, s48, 6
    s_add_u32 s68, s68, s48
    s_add_u32 s68, s68, 24576
    s_lshl_b32 s48, s14, 12
    s_add_u32 s70, s70, s48
    s_mov_b32 s71, 0
    s_mov_b32 s72, 0
    v_mov_b32 v16, 0
    v_mov_b32 v29, 0x3f80
    v_cmp_eq_u32 vcc, 0, v26
    s_nop 1
    v_cndmask_b32 v16, v16, v29, vcc
    v_mov_b32 v29, 0x3f800000
    v_cmp_eq_u32 vcc, 1, v26
    s_nop 1
    v_cndmask_b32 v16, v16, v29, vcc
    v_mov_b32 v17, 0
    v_mov_b32 v29, 0x3f80
    v_cmp_eq_u32 vcc, 2, v26
    s_nop 1
    v_cndmask_b32 v17, v17, v29, vcc
    v_mov_b32 v29, 0x3f800000
    v_cmp_eq_u32 vcc, 3, v26
    s_nop 1
    v_cndmask_b32 v17, v17, v29, vcc
    v_mov_b32 v18, 0
    v_mov_b32 v29, 0x3f80
    v_cmp_eq_u32 vcc, 4, v26
    s_nop 1
    v_cndmask_b32 v18, v18, v29, vcc
    v_mov_b32 v29, 0x3f800000
    v_cmp_eq_u32 vcc, 5, v26
    s_nop 1
    v_cndmask_b32 v18, v18, v29, vcc
    v_mov_b32 v19, 0
    v_mov_b32 v29, 0x3f80
    v_cmp_eq_u32 vcc, 6, v26
    s_nop 1
    v_cndmask_b32 v19, v19, v29, vcc
    v_mov_b32 v29, 0x3f800000
    v_cmp_eq_u32 vcc, 7, v26
    s_nop 1
    v_cndmask_b32 v19, v19, v29, vcc
    v_mov_b32 v20, v32
    v_mov_b32 v21, v33
    v_mov_b32 v22, v34
    v_mov_b32 v23, v35
    v_mov_b32 v24, v36
    v_mov_b32 v25, v37
    v_mov_b32 v26, v38
    v_mov_b32 v27, v39
    s_mov_b32 s56, s38
    s_and_b32 s57, s39, 0xffff
    s_mov_b32 s58, 2097152
    s_mov_b32 s59, 0x20000
    s_mov_b32 s60, s16
    s_and_b32 s61, s17, 0xffff
    s_mov_b32 s62, 2097152
    s_mov_b32 s63, 0x20000
    s_cmp_gt_u32 s12, 5
    s_cselect_b32 s46, 1, 0
    s_sub_u32 s46, s12, s46
    s_add_u32 s64, s46, 17
    s_sub_u32 s44, s46, 4
    s_cmp_lt_u32 s12, 4
    s_cselect_b32 s44, s64, s44
    s_mul_i32 s49, s12, 4194304
    s_add_u32 s49, s49, 67108864
    s_lshl_b32 s50, s12, 9
    s_add_u32 s50, s50, 65847296
    s_mov_b32 s45, 0
    s_mov_b32 s51, 0x3e0293ee
    s_mov_b32 s54, 0xc0135761
    s_mov_b32 s55, 0xbdd2d3e8
L_rdyp:
    v_mov_b32_e64 v0, 64
    global_load_dword v0, v0, s[40:41] sc1
    s_waitcnt vmcnt(0)
    v_cmp_gt_u32 vcc, 0x100, v0
    s_cbranch_vccz L_rdyokp
    s_sub_u32 s96, s96, 1
    s_cbranch_scc0 L_rdyp
    s_branch L_abort
L_rdyokp:
    s_lshl_b32 s46, s12, 4
    s_add_u32 s46, s46, 128
    v_mov_b32_e64 v14, s46
    global_load_dword v14, v14, s[40:41] sc1
    s_waitcnt vmcnt(0)
    v_readfirstlane_b32 s69, v14
    s_barrier
    s_cmp_lt_u32 s69, 32
    s_cbranch_scc1 L_ploopX
L_ploop:
    s_add_u32 s65, s44, 3
    s_cmp_lt_u32 s65, 18
    s_cselect_b32 s65, s65, s64
    s_add_u32 s46, s44, 6
    s_cmp_ge_u32 s44, 18
    s_cselect_b32 s65, s46, s65
    s_bitcmp1_b32 s71, 0
    s_cbranch_scc1 L_fqdone
L_fq:
    s_mov_b32 s46, 65830912
    buffer_load_dword v14, v13, s[4:7], s46 offen sc1
    s_waitcnt vmcnt(0)
    v_cmp_gt_i32 vcc, s44, v14
    s_and_b32 s46, vcc_lo, 7
    s_cbranch_scc0 L_fqok
    s_sleep 8
    s_sub_u32 s96, s96, 1
    s_cbranch_scc0 L_fq
    s_branch L_abort
L_fqok:
    s_lshl_b32 s47, s44, 18
    s_lshl_b32 s48, s14, 13
    s_add_u32 s47, s47, s48
    s_lshl_b32 s48, s13, 11
    s_add_u32 s47, s47, s48
    s_add_u32 m0, s48, 0
    s_add_u32 s46, s47, 0
    buffer_load_dwordx4 v1, s[4:7], s46 offen offset:0 sc1 lds
    buffer_load_dwordx4 v1, s[4:7], s46 offen offset:1024 sc1 lds
    s_add_u32 m0, s48, 8192
    s_add_u32 s46, s47, 16777216
    buffer_load_dwordx4 v1, s[4:7], s46 offen offset:0 sc1 lds
    buffer_load_dwordx4 v1, s[4:7], s46 offen offset:1024 sc1 lds
    s_add_u32 m0, s48, 16384
    s_add_u32 s46, s47, 33554432
    buffer_load_dwordx4 v1, s[4:7], s46 offen offset:0 sc1 lds
    buffer_load_dwordx4 v1, s[4:7], s46 offen offset:1024 sc1 lds
L_fqdone:
    s_sub_u32 s53, s44, 1
    s_min_u32 s53, s53, 61
    s_cmp_ge_u32 s44, 56
    s_cselect_b32 s53, s53, s44
    s_lshr_b32 s46, s71, 1
    s_or_b32 s46, s46, s13
    s_cbranch_scc1 L_ppubw
L_ppub:
    s_mov_b32 s46, 65830912
    buffer_load_dword v14, v13, s[4:7], s46 offen sc1
    s_waitcnt vmcnt(0)
    v_readlane_b32 s48, v14, 3
    s_cmp_ge_i32 s48, s53
    s_cbranch_scc1 L_ppubw
    s_add_u32 s48, s48, 1
    s_cmp_ge_i32 s48, s53
    s_cbranch_scc1 L_pnear
    s_sleep 40
L_pnear:
    s_sleep 3
    s_sub_u32 s96, s96, 1
    s_cbranch_scc0 L_ppub
    s_branch L_abort
L_ppubw:
    s_barrier
    s_cmp_ge_u32 s44, 56
    s_cbranch_scc1 L_plast
    s_bitcmp1_b32 s71, 1
    s_cbranch_scc1 L_plast
    s_add_u32 s46, s44, 1
    s_lshl_b32 s46, s46, 17
    s_add_u32 s46, s46, s70
    s_add_u32 s46, s46, 50331648
    s_mov_b32 m0, s68
    s_nop 0
    buffer_load_dwordx4 v1, s[4:7], s46 offen sc1 lds
    s_waitcnt vmcnt(1)
    s_branch L_pgo
L_plast:
    s_bitcmp1_b32 s71, 0
    s_cbranch_scc1 L_pgo
    s_waitcnt vmcnt(0)
L_pgo:
    s_barrier
    ds_read_b128 v[64:67], v3 offset:0
    ds_read_b128 v[32:35], v2 offset:8192
    ds_read_b128 v[36:39], v2 offset:8448
    ds_read_b128 v[68:71], v3 offset:2048
    ds_read_b128 v[40:43], v2 offset:10240
    ds_read_b128 v[44:47], v2 offset:10496
    ds_read_b128 v[72:75], v3 offset:4096
    ds_read_b128 v[48:51], v2 offset:12288
    ds_read_b128 v[52:55], v2 offset:12544
    ds_read_b128 v[76:79], v3 offset:6144
    ds_read_b128 v[56:59], v2 offset:14336
    ds_read_b128 v[60:63], v2 offset:14592
    s_waitcnt lgkmcnt(9)
    v_mfma_f32_16x16x32_bf16 v[128:131], v[32:35], v[64:67], v[20:23]
    v_mfma_f32_16x16x32_bf16 v[132:135], v[36:39], v[64:67], v[24:27]
    ds_read_b64_tr_b16 v[96:97], v5 offset:16384
    ds_read_b64_tr_b16 v[98:99], v5 offset:16640
    s_waitcnt lgkmcnt(8)
    v_mfma_f32_16x16x32_bf16 v[128:131], v[40:43], v[68:71], v[128:131]
    v_mfma_f32_16x16x32_bf16 v[132:135], v[44:47], v[68:71], v[132:135]
    ds_read_b64_tr_b16 v[100:101], v5 offset:17408
    ds_read_b64_tr_b16 v[102:103], v5 offset:17664
    s_waitcnt lgkmcnt(7)
    v_mfma_f32_16x16x32_bf16 v[128:131], v[48:51], v[72:75], v[128:131]
    v_mfma_f32_16x16x32_bf16 v[132:135], v[52:55], v[72:75], v[132:135]
    ds_read_b64_tr_b16 v[104:105], v5 offset:18432
    ds_read_b64_tr_b16 v[106:107], v5 offset:18688
    s_waitcnt lgkmcnt(6)
    v_mfma_f32_16x16x32_bf16 v[128:131], v[56:59], v[76:79], v[128:131]
    v_mfma_f32_16x16x32_bf16 v[132:135], v[60:63], v[76:79], v[132:135]
    ds_read_b64_tr_b16 v[108:109], v5 offset:19456
    ds_read_b64_tr_b16 v[110:111], v5 offset:19712
    v_mov_b32 v144, 0x3f803f80
    v_mov_b32_e64 v113, 0
    v_mov_b32 v145, 0x3f803f80
    v_mov_b32_e64 v115, 0
    v_mov_b32 v146, 0x3f803f80
    v_mov_b32_e64 v117, 0
    v_mov_b32 v147, 0x3f803f80
    v_mov_b32 v119, 0
    s_cmp_lt_u32 s44, 56
    s_cbranch_scc1 L_pkm
    s_sub_u32 s46, s44, 56
    s_lshl_b32 s46, s46, 17
    s_add_u32 s46, s46, s70
    s_add_u32 s46, s46, 66060288
    v_add_u32 v15, s68, v1
L_pdir:
    buffer_load_dwordx4 v[80:83], v1, s[4:7], s46 offen sc1
    s_waitcnt vmcnt(0)
    v_max3_u32 v14, v80, v81, v82
    v_max_u32_e64 v14, v14, v83
    v_cmp_eq_u32 vcc, -1, v14
    s_cbranch_vccz L_pdirok
    s_sleep 2
    s_sub_u32 s96, s96, 1
    s_cbranch_scc0 L_pdir
    s_branch L_abort
L_pdirok:
    ds_write_b128 v15, v[80:83]
    s_waitcnt lgkmcnt(0)
L_pkm:
    s_waitcnt vmcnt(0)
    s_barrier
    ds_read_b64_tr_b16 v[80:81], v4 offset:24576
    ds_read_b64_tr_b16 v[82:83], v4 offset:24608
    ds_read_b64_tr_b16 v[84:85], v4 offset:24832
    ds_read_b64_tr_b16 v[86:87], v4 offset:24864
    ds_read_b64_tr_b16 v[88:89], v4 offset:25088
    ds_read_b64_tr_b16 v[90:91], v4 offset:25120
    ds_read_b64_tr_b16 v[92:93], v4 offset:25344
    ds_read_b64_tr_b16 v[94:95], v4 offset:25376
    ds_read_b32 v112, v6 offset:24580
    ds_read_b32 v114, v6 offset:24708
    ds_read_b32 v116, v6 offset:24836
    ds_read_b32 v118, v6 offset:24964
    s_waitcnt lgkmcnt(10)
    v_mfma_f32_16x16x32_bf16 v[136:139], v[80:83], v[64:67], 0
    s_waitcnt lgkmcnt(8)
    v_mfma_f32_16x16x32_bf16 v[136:139], v[84:87], v[68:71], v[136:139]
    s_waitcnt lgkmcnt(6)
    v_mfma_f32_16x16x32_bf16 v[136:139], v[88:91], v[72:75], v[136:139]
    s_waitcnt lgkmcnt(4)
    v_mfma_f32_16x16x32_bf16 v[136:139], v[92:95], v[76:79], v[136:139]
    v_max3_f32 v140, v128, v129, v130
    v_max3_f32 v141, v131, v132, v133
    v_max3_f32 v140, v140, v134, v135
    s_nop 4
    v_max3_f32 v141, v141, v136, v137
    v_max_f32 v138, v140, v141
    v_max_f32 v139, v140, v141
    s_nop 1
    v_permlane16_swap_b32 v138, v139
    v_max_f32 v140, v138, v139
    v_max_f32 v141, v138, v139
    s_nop 1
    v_permlane32_swap_b32 v140, v141
    v_max_f32 v138, v140, v141
    v_mul_f32 v138, s51, v138
    v_fma_f32 v128, v128, s51, -v138
    v_fma_f32 v129, v129, s51, -v138
    v_fma_f32 v130, v130, s51, -v138
    v_fma_f32 v131, v131, s51, -v138
    v_fma_f32 v132, v132, s51, -v138
    v_fma_f32 v133, v133, s51, -v138
    v_fma_f32 v134, v134, s51, -v138
    v_fma_f32 v135, v135, s51, -v138
    v_fma_f32 v136, v136, s51, -v138
    v_fma_f32 v137, v137, s51, -v138
    v_exp_f32 v128, v128
    v_exp_f32 v129, v129
    v_exp_f32 v130, v130
    v_exp_f32 v131, v131
    v_exp_f32 v132, v132
    v_exp_f32 v133, v133
    v_exp_f32 v134, v134
    v_exp_f32 v135, v135
    v_exp_f32 v136, v136
    v_exp_f32 v137, v137
    v_cvt_pk_bf16_f32 v140, v128, v129
    v_cvt_pk_bf16_f32 v141, v130, v131
    v_cvt_pk_bf16_f32 v142, v132, v133
    v_cvt_pk_bf16_f32 v143, v134, v135
    v_cvt_pk_bf16_f32 v136, v136, v137
    v_mov_b32 v137, 0
    s_waitcnt lgkmcnt(0)
    v_mfma_f32_16x16x32_bf16 v[148:151], v[144:147], v[140:143], 0
    v_mfma_f32_16x16x32_bf16 v[152:155], v[96:99], v[140:143], 0
    v_mfma_f32_16x16x32_bf16 v[156:159], v[100:103], v[140:143], 0
    v_mfma_f32_16x16x32_bf16 v[160:163], v[104:107], v[140:143], 0
    v_mfma_f32_16x16x32_bf16 v[164:167], v[108:111], v[140:143], 0
    v_mfma_f32_16x16x16_bf16 v[148:151], v[144:145], v[136:137], v[148:151]
    v_mfma_f32_16x16x16_bf16 v[152:155], v[112:113], v[136:137], v[152:155]
    v_mfma_f32_16x16x16_bf16 v[156:159], v[114:115], v[136:137], v[156:159]
    v_mfma_f32_16x16x16_bf16 v[160:163], v[116:117], v[136:137], v[160:163]
    v_mfma_f32_16x16x16_bf16 v[164:167], v[118:119], v[136:137], v[164:167]
    v_rcp_f32 v148, v148
    s_nop 0
    v_mul_f32 v152, v152, v148
    v_mul_f32 v153, v153, v148
    v_mul_f32 v154, v154, v148
    v_mul_f32 v155, v155, v148
    v_cvt_pk_bf16_f32 v152, v152, v153
    v_cvt_pk_bf16_f32 v153, v154, v155
    ds_write_b64 v7, v[152:153] offset:29696
    v_mul_f32 v156, v156, v148
    v_mul_f32 v157, v157, v148
    v_mul_f32 v158, v158, v148
    v_mul_f32 v159, v159, v148
    v_cvt_pk_bf16_f32 v156, v156, v157
    v_cvt_pk_bf16_f32 v157, v158, v159
    ds_write_b64 v7, v[156:157] offset:30720
    v_mul_f32 v160, v160, v148
    v_mul_f32 v161, v161, v148
    v_mul_f32 v162, v162, v148
    v_mul_f32 v163, v163, v148
    v_cvt_pk_bf16_f32 v160, v160, v161
    v_cvt_pk_bf16_f32 v161, v162, v163
    ds_write_b64 v7, v[160:161] offset:31744
    v_mul_f32 v164, v164, v148
    v_mul_f32 v165, v165, v148
    v_mul_f32 v166, v166, v148
    v_mul_f32 v167, v167, v148
    v_cvt_pk_bf16_f32 v164, v164, v165
    v_cvt_pk_bf16_f32 v165, v166, v167
    ds_write_b64 v7, v[164:165] offset:32768
    s_waitcnt lgkmcnt(0)
    s_barrier
    s_lshl_b32 s46, s44, 15
    buffer_load_dwordx2 v[80:81], v10, s[60:63], s46 offen
    s_mov_b32 s46, 65830912
    buffer_load_dword v0, v13, s[4:7], s46 offen sc1
    ds_read_b128 v[32:35], v2 offset:29696
    ds_read_b128 v[36:39], v2 offset:31744
    ds_read_b128 v[40:43], v2 offset:33792
    ds_read_b128 v[44:47], v2 offset:35840
    ds_read_b128 v[48:51], v2 offset:29952
    ds_read_b128 v[52:55], v2 offset:32000
    ds_read_b128 v[56:59], v2 offset:34048
    ds_read_b128 v[60:63], v2 offset:36096
    s_waitcnt lgkmcnt(7)
    v_mfma_f32_16x16x32_bf16 v[96:99], v[32:35], a[0:3], 0
    v_mfma_f32_16x16x32_bf16 v[100:103], v[32:35], a[16:19], 0
    v_mfma_f32_16x16x32_bf16 v[104:107], v[32:35], a[32:35], 0
    v_mfma_f32_16x16x32_bf16 v[108:111], v[32:35], a[48:51], 0
    v_mfma_f32_16x16x32_bf16 v[112:115], v[32:35], a[64:67], 0
    v_mfma_f32_16x16x32_bf16 v[116:119], v[32:35], a[80:83], 0
    v_mfma_f32_16x16x32_bf16 v[120:123], v[32:35], a[96:99], 0
    v_mfma_f32_16x16x32_bf16 v[124:127], v[32:35], a[112:115], 0
    s_waitcnt lgkmcnt(6)
    v_mfma_f32_16x16x32_bf16 v[96:99], v[36:39], a[4:7], v[96:99]
    v_mfma_f32_16x16x32_bf16 v[100:103], v[36:39], a[20:23], v[100:103]
    v_mfma_f32_16x16x32_bf16 v[104:107], v[36:39], a[36:39], v[104:107]
    v_mfma_f32_16x16x32_bf16 v[108:111], v[36:39], a[52:55], v[108:111]
    v_mfma_f32_16x16x32_bf16 v[112:115], v[36:39], a[68:71], v[112:115]
    v_mfma_f32_16x16x32_bf16 v[116:119], v[36:39], a[84:87], v[116:119]
    v_mfma_f32_16x16x32_bf16 v[120:123], v[36:39], a[100:103], v[120:123]
    v_mfma_f32_16x16x32_bf16 v[124:127], v[36:39], a[116:119], v[124:127]
    s_waitcnt lgkmcnt(5)
    v_mfma_f32_16x16x32_bf16 v[96:99], v[40:43], a[8:11], v[96:99]
    v_mfma_f32_16x16x32_bf16 v[100:103], v[40:43], a[24:27], v[100:103]
    v_mfma_f32_16x16x32_bf16 v[104:107], v[40:43], a[40:43], v[104:107]
    v_mfma_f32_16x16x32_bf16 v[108:111], v[40:43], a[56:59], v[108:111]
    v_mfma_f32_16x16x32_bf16 v[112:115], v[40:43], a[72:75], v[112:115]
    v_mfma_f32_16x16x32_bf16 v[116:119], v[40:43], a[88:91], v[116:119]
    v_mfma_f32_16x16x32_bf16 v[120:123], v[40:43], a[104:107], v[120:123]
    v_mfma_f32_16x16x32_bf16 v[124:127], v[40:43], a[120:123], v[124:127]
    s_waitcnt lgkmcnt(4)
    v_mfma_f32_16x16x32_bf16 v[96:99], v[44:47], a[12:15], v[96:99]
    v_mfma_f32_16x16x32_bf16 v[100:103], v[44:47], a[28:31], v[100:103]
    v_mfma_f32_16x16x32_bf16 v[104:107], v[44:47], a[44:47], v[104:107]
    v_mfma_f32_16x16x32_bf16 v[108:111], v[44:47], a[60:63], v[108:111]
    v_mfma_f32_16x16x32_bf16 v[112:115], v[44:47], a[76:79], v[112:115]
    v_mfma_f32_16x16x32_bf16 v[116:119], v[44:47], a[92:95], v[116:119]
    v_mfma_f32_16x16x32_bf16 v[120:123], v[44:47], a[108:111], v[120:123]
    v_mfma_f32_16x16x32_bf16 v[124:127], v[44:47], a[124:127], v[124:127]
    s_waitcnt lgkmcnt(3)
    v_mfma_f32_16x16x32_bf16 v[128:131], v[48:51], a[0:3], 0
    v_mfma_f32_16x16x32_bf16 v[132:135], v[48:51], a[16:19], 0
    v_cvt_pk_bf16_f32 v160, v96, v100
    v_cvt_pk_bf16_f32 v161, v104, v108
    v_mfma_f32_16x16x32_bf16 v[136:139], v[48:51], a[32:35], 0
    v_cvt_pk_bf16_f32 v162, v112, v116
    v_cvt_pk_bf16_f32 v163, v120, v124
    v_mfma_f32_16x16x32_bf16 v[140:143], v[48:51], a[48:51], 0
    s_add_u32 s46, s49, 0
    buffer_store_dwordx4 v[160:163], v8, s[4:7], s46 offen
    v_mfma_f32_16x16x32_bf16 v[144:147], v[48:51], a[64:67], 0
    v_cvt_pk_bf16_f32 v164, v97, v101
    v_cvt_pk_bf16_f32 v165, v105, v109
    v_mfma_f32_16x16x32_bf16 v[148:151], v[48:51], a[80:83], 0
    v_cvt_pk_bf16_f32 v166, v113, v117
    v_cvt_pk_bf16_f32 v167, v121, v125
    v_mfma_f32_16x16x32_bf16 v[152:155], v[48:51], a[96:99], 0
    s_add_u32 s46, s49, 32768
    buffer_store_dwordx4 v[164:167], v8, s[4:7], s46 offen
    v_mfma_f32_16x16x32_bf16 v[156:159], v[48:51], a[112:115], 0
    v_cvt_pk_bf16_f32 v168, v98, v102
    v_cvt_pk_bf16_f32 v169, v106, v110
    s_waitcnt lgkmcnt(2)
    v_mfma_f32_16x16x32_bf16 v[128:131], v[52:55], a[4:7], v[128:131]
    v_cvt_pk_bf16_f32 v170, v114, v118
    v_cvt_pk_bf16_f32 v171, v122, v126
    v_mfma_f32_16x16x32_bf16 v[132:135], v[52:55], a[20:23], v[132:135]
    s_add_u32 s46, s49, 65536
    buffer_store_dwordx4 v[168:171], v8, s[4:7], s46 offen
    v_mfma_f32_16x16x32_bf16 v[136:139], v[52:55], a[36:39], v[136:139]
    v_cvt_pk_bf16_f32 v172, v99, v103
    v_cvt_pk_bf16_f32 v173, v107, v111
    v_mfma_f32_16x16x32_bf16 v[140:143], v[52:55], a[52:55], v[140:143]
    v_cvt_pk_bf16_f32 v174, v115, v119
    v_cvt_pk_bf16_f32 v175, v123, v127
    v_mfma_f32_16x16x32_bf16 v[144:147], v[52:55], a[68:71], v[144:147]
    s_add_u32 s46, s49, 98304
    buffer_store_dwordx4 v[172:175], v8, s[4:7], s46 offen
    v_mfma_f32_16x16x32_bf16 v[148:151], v[52:55], a[84:87], v[148:151]
    v_mfma_f32_16x16x32_bf16 v[152:155], v[52:55], a[100:103], v[152:155]
    v_mfma_f32_16x16x32_bf16 v[156:159], v[52:55], a[116:119], v[156:159]
    s_waitcnt lgkmcnt(1)
    v_mfma_f32_16x16x32_bf16 v[128:131], v[56:59], a[8:11], v[128:131]
    v_mfma_f32_16x16x32_bf16 v[132:135], v[56:59], a[24:27], v[132:135]
    v_mfma_f32_16x16x32_bf16 v[136:139], v[56:59], a[40:43], v[136:139]
    v_mfma_f32_16x16x32_bf16 v[140:143], v[56:59], a[56:59], v[140:143]
    v_mfma_f32_16x16x32_bf16 v[144:147], v[56:59], a[72:75], v[144:147]
    v_mfma_f32_16x16x32_bf16 v[148:151], v[56:59], a[88:91], v[148:151]
    v_mfma_f32_16x16x32_bf16 v[152:155], v[56:59], a[104:107], v[152:155]
    v_mfma_f32_16x16x32_bf16 v[156:159], v[56:59], a[120:123], v[156:159]
    s_waitcnt lgkmcnt(0)
    v_mfma_f32_16x16x32_bf16 v[128:131], v[60:63], a[12:15], v[128:131]
    v_mfma_f32_16x16x32_bf16 v[132:135], v[60:63], a[28:31], v[132:135]
    v_mfma_f32_16x16x32_bf16 v[136:139], v[60:63], a[44:47], v[136:139]
    v_mfma_f32_16x16x32_bf16 v[140:143], v[60:63], a[60:63], v[140:143]
    v_mfma_f32_16x16x32_bf16 v[144:147], v[60:63], a[76:79], v[144:147]
    v_mfma_f32_16x16x32_bf16 v[148:151], v[60:63], a[92:95], v[148:151]
    v_mfma_f32_16x16x32_bf16 v[152:155], v[60:63], a[108:111], v[152:155]
    v_mfma_f32_16x16x32_bf16 v[156:159], v[60:63], a[124:127], v[156:159]
    s_nop 4
    v_cvt_pk_bf16_f32 v176, v128, v132
    v_cvt_pk_bf16_f32 v177, v136, v140
    v_cvt_pk_bf16_f32 v178, v144, v148
    v_cvt_pk_bf16_f32 v179, v152, v156
    s_add_u32 s46, s49, 524288
    buffer_store_dwordx4 v[176:179], v8, s[4:7], s46 offen
    v_cvt_pk_bf16_f32 v180, v129, v133
    v_cvt_pk_bf16_f32 v181, v137, v141
    v_cvt_pk_bf16_f32 v182, v145, v149
    v_cvt_pk_bf16_f32 v183, v153, v157
    s_add_u32 s46, s49, 557056
    buffer_store_dwordx4 v[180:183], v8, s[4:7], s46 offen
    v_cvt_pk_bf16_f32 v184, v130, v134
    v_cvt_pk_bf16_f32 v185, v138, v142
    v_cvt_pk_bf16_f32 v186, v146, v150
    v_cvt_pk_bf16_f32 v187, v154, v158
    s_add_u32 s46, s49, 589824
    buffer_store_dwordx4 v[184:187], v8, s[4:7], s46 offen
    v_cvt_pk_bf16_f32 v188, v131, v135
    v_cvt_pk_bf16_f32 v189, v139, v143
    v_cvt_pk_bf16_f32 v190, v147, v151
    v_cvt_pk_bf16_f32 v191, v155, v159
    s_add_u32 s46, s49, 622592
    buffer_store_dwordx4 v[188:191], v8, s[4:7], s46 offen
    s_cmp_eq_u32 s72, 0
    s_cbranch_scc1 L_pnopend
    v_min_u32 v15, 108, v12
L_awp:
    buffer_load_dword v14, v15, s[4:7], s50 offen offset:256 sc1
    s_waitcnt vmcnt(0)
    v_cmp_gt_i32 vcc, s74, v14
    s_cbranch_vccz L_awokp
    s_sub_u32 s96, s96, 1
    s_cbranch_scc0 L_awp
    s_branch L_abort
L_awokp:
    s_add_u32 s46, s49, 1048576
    buffer_load_dwordx4 v[32:35], v9, s[4:7], s46 offen sc1
    s_add_u32 s46, s46, 4096
    buffer_load_dwordx4 v[36:39], v9, s[4:7], s46 offen sc1
    s_add_u32 s46, s46, 4096
    buffer_load_dwordx4 v[40:43], v9, s[4:7], s46 offen sc1
    s_add_u32 s46, s46, 4096
    buffer_load_dwordx4 v[44:47], v9, s[4:7], s46 offen sc1
    s_add_u32 s46, s46, 4096
    buffer_load_dwordx4 v[48:51], v9, s[4:7], s46 offen sc1
    s_add_u32 s46, s46, 4096
    buffer_load_dwordx4 v[52:55], v9, s[4:7], s46 offen sc1
    s_add_u32 s46, s46, 4096
    buffer_load_dwordx4 v[56:59], v9, s[4:7], s46 offen sc1
    s_waitcnt vmcnt(6)
    v_mfma_f32_16x16x32_bf16 v[64:67], v[16:19], v[32:35], 0
    s_waitcnt vmcnt(5)
    v_mfma_f32_16x16x32_bf16 v[64:67], v[16:19], v[36:39], v[64:67]
    s_waitcnt vmcnt(4)
    v_mfma_f32_16x16x32_bf16 v[64:67], v[16:19], v[40:43], v[64:67]
    s_waitcnt vmcnt(3)
    v_mfma_f32_16x16x32_bf16 v[64:67], v[16:19], v[44:47], v[64:67]
    s_waitcnt vmcnt(2)
    v_mfma_f32_16x16x32_bf16 v[64:67], v[16:19], v[48:51], v[64:67]
    s_waitcnt vmcnt(1)
    v_mfma_f32_16x16x32_bf16 v[64:67], v[16:19], v[52:55], v[64:67]
    s_waitcnt vmcnt(0)
    v_mfma_f32_16x16x32_bf16 v[64:67], v[16:19], v[56:59], v[64:67]
    s_nop 7
    v_add_f32 v64, v64, v28
    v_add_f32 v65, v65, v29
    v_add_f32 v66, v66, v30
    v_add_f32_e64 v67, v67, v31
    v_cvt_pk_bf16_f32 v64, v64, v65
    v_cvt_pk_bf16_f32 v65, v66, v67
    s_lshl_b32 s46, s73, 15
    s_mov_b32 exec_hi, 0
    buffer_store_dwordx2 v[64:65], v10, s[56:59], s46 offen
    s_mov_b64 exec, -1
    s_mov_b32 s72, 0
L_pnopend:
    s_waitcnt vmcnt(0)
    s_barrier
    s_cmp_lg_u32 s13, 0
    s_cbranch_scc1 L_siga
    v_mov_b32 v14, s45
    s_lshl_b32 s46, s14, 2
    v_mov_b32 v15, s46
    s_mov_b64 exec, 1
    buffer_store_dword v14, v15, s[4:7], s50 offen offset:0
    s_mov_b64 exec, -1
L_siga:
    v_min_u32 v15, 124, v12
L_awa:
    buffer_load_dword v14, v15, s[4:7], s50 offen offset:0 sc1
    s_waitcnt vmcnt(0)
    v_cmp_gt_i32 vcc, s45, v14
    s_cbranch_vccz L_awoka
    s_sub_u32 s96, s96, 1
    s_cbranch_scc0 L_awa
    s_branch L_abort
L_awoka:
    s_add_u32 s46, s49, 0
    buffer_load_dwordx4 v[32:35], v9, s[4:7], s46 offen sc1
    s_add_u32 s46, s46, 4096
    buffer_load_dwordx4 v[36:39], v9, s[4:7], s46 offen sc1
    s_add_u32 s46, s46, 4096
    buffer_load_dwordx4 v[40:43], v9, s[4:7], s46 offen sc1
    s_add_u32 s46, s46, 4096
    buffer_load_dwordx4 v[44:47], v9, s[4:7], s46 offen sc1
    s_add_u32 s46, s46, 4096
    buffer_load_dwordx4 v[48:51], v9, s[4:7], s46 offen sc1
    s_add_u32 s46, s46, 4096
    buffer_load_dwordx4 v[52:55], v9, s[4:7], s46 offen sc1
    s_add_u32 s46, s46, 4096
    buffer_load_dwordx4 v[56:59], v9, s[4:7], s46 offen sc1
    s_add_u32 s46, s46, 4096
    buffer_load_dwordx4 v[60:63], v9, s[4:7], s46 offen sc1
    s_waitcnt vmcnt(7)
    v_mfma_f32_16x16x32_bf16 v[64:67], v[16:19], v[32:35], 0
    s_waitcnt vmcnt(6)
    v_mfma_f32_16x16x32_bf16 v[64:67], v[16:19], v[36:39], v[64:67]
    s_waitcnt vmcnt(5)
    v_mfma_f32_16x16x32_bf16 v[64:67], v[16:19], v[40:43], v[64:67]
    s_waitcnt vmcnt(4)
    v_mfma_f32_16x16x32_bf16 v[64:67], v[16:19], v[44:47], v[64:67]
    s_waitcnt vmcnt(3)
    v_mfma_f32_16x16x32_bf16 v[64:67], v[16:19], v[48:51], v[64:67]
    s_waitcnt vmcnt(2)
    v_mfma_f32_16x16x32_bf16 v[64:67], v[16:19], v[52:55], v[64:67]
    s_waitcnt vmcnt(1)
    v_mfma_f32_16x16x32_bf16 v[64:67], v[16:19], v[56:59], v[64:67]
    s_waitcnt vmcnt(0)
    v_mfma_f32_16x16x32_bf16 v[64:67], v[16:19], v[60:63], v[64:67]
    s_nop 7
    v_lshlrev_b32 v68, 16, v80
    v_and_b32 v69, 0xffff0000, v80
    v_lshlrev_b32 v70, 16, v81
    v_and_b32 v71, 0xffff0000, v81
    v_add_f32 v28, v64, v68
    v_add_f32 v29, v65, v69
    v_add_f32 v30, v66, v70
    v_add_f32 v31, v67, v71
    v_readfirstlane_b32 s48, v28
    s_lshl_b32 s46, s13, 4
    v_mov_b32 v14, s46
    v_subrev_f32 v68, s48, v28
    v_subrev_f32 v69, s48, v29
    v_subrev_f32 v70, s48, v30
    v_subrev_f32 v71, s48, v31
    v_add_f32 v64, v68, v69
    v_mul_f32 v65, v68, v68
    v_add_f32 v66, v70, v71
    v_fmac_f32 v65, v69, v69
    v_fmac_f32 v65, v70, v70
    v_fmac_f32 v65, v71, v71
    v_add_f32 v64, v64, v66
    v_mov_b32 v66, s48
    v_add_f32_dpp v65, v65, v65 row_ror:8 row_mask:0xf bank_mask:0xf
    v_add_f32_dpp v64, v64, v64 row_ror:8 row_mask:0xf bank_mask:0xf
    s_nop 0
    v_add_f32_dpp v65, v65, v65 row_ror:4 row_mask:0xf bank_mask:0xf
    v_add_f32_dpp v64, v64, v64 row_ror:4 row_mask:0xf bank_mask:0xf
    s_nop 0
    v_add_f32_dpp v65, v65, v65 row_ror:2 row_mask:0xf bank_mask:0xf
    v_add_f32_dpp v64, v64, v64 row_ror:2 row_mask:0xf bank_mask:0xf
    s_nop 0
    v_add_f32_dpp v65, v65, v65 row_ror:1 row_mask:0xf bank_mask:0xf
    v_add_f32_dpp v64, v64, v64 row_ror:1 row_mask:0xf bank_mask:0xf
    s_nop 0
    v_mov_b32 v69, v65
    v_mov_b32 v68, v64
    s_nop 0
    v_permlane16_swap_b32 v65, v69
    v_permlane16_swap_b32 v64, v68
    v_add_f32 v65, v65, v69
    v_add_f32_e64 v64, v64, v68
    v_mul_f32 v67, 0x3c000000, v64
    v_fma_f32 v65, -v67, v64, v65
    v_add_f32_e64 v64, v66, v67
    v_lshrrev_b32 v14, 1, v14
    s_mov_b64 exec, 1
    ds_write_b64 v14, v[64:65] offset:41984
    s_cmp_eq_u32 s13, 0
    s_cselect_b64 exec, 15, 0
    ds_write_b32 v12, v0 offset:42048
    s_mov_b64 exec, -1
    v_mov_b32_e64 v14, 0
    v_min_u32 v15, 12, v12
    s_waitcnt lgkmcnt(0)
    s_barrier
    ds_read_b32 v0, v15 offset:42048
    ds_read_b128 v[72:75], v14 offset:41984
    ds_read_b128 v[76:79], v14 offset:42000
    s_waitcnt lgkmcnt(0)
    v_add_f32 v64, v72, v74
    v_add_f32 v65, v76, v78
    v_add_f32 v64, v64, v65
    v_mul_f32 v64, 0x3e800000, v64
    v_add_f32 v65, v73, v75
    v_add_f32 v66, v77, v79
    v_add_f32 v65, v65, v66
    v_sub_f32 v72, v72, v64
    v_sub_f32 v74, v74, v64
    v_sub_f32 v76, v76, v64
    v_sub_f32 v78, v78, v64
    v_mul_f32_e64 v66, v72, v72
    v_fmac_f32 v66, v74, v74
    v_fmac_f32 v66, v76, v76
    v_fmac_f32 v66, v78, v78
    v_fmac_f32 v65, 0x43000000, v66
    v_mov_b32 v66, 0x3727c5ac
    v_fmac_f32 v66, 0x3b000000, v65
    v_rsq_f32 v66, v66
    v_sub_f32 v68, v28, v64
    v_sub_f32 v69, v29, v64
    v_sub_f32 v70, v30, v64
    v_sub_f32 v71, v31, v64
    v_mul_f32 v68, v68, v66
    v_mul_f32 v69, v69, v66
    v_mul_f32 v70, v70, v66
    v_mul_f32_e64 v71, v71, v66
    v_cvt_pk_bf16_f32 v68, v68, v69
    v_cvt_pk_bf16_f32 v69, v70, v71
    s_add_u32 s46, s49, 2097152
    s_mov_b32 exec_hi, 0
    buffer_store_dwordx2 v[68:69], v11, s[4:7], s46 offen
    s_mov_b64 exec, -1
    s_waitcnt vmcnt(0)
    s_barrier
    s_cmp_lg_u32 s13, 0
    s_cbranch_scc1 L_sigb
    v_mov_b32 v14, s45
    s_lshl_b32 s46, s14, 2
    v_mov_b32 v15, s46
    s_mov_b64 exec, 1
    buffer_store_dword v14, v15, s[4:7], s50 offen offset:128
    s_mov_b64 exec, -1
L_sigb:
    s_cmp_lt_u32 s14, 28
    s_cbranch_scc1 L_pffn
    v_cmp_gt_i32 vcc, s65, v0
    s_lshl_b32 s47, s65, 18
    s_lshl_b32 s48, s14, 13
    s_add_u32 s47, s47, s48
    s_lshl_b32 s48, s13, 11
    s_add_u32 s47, s47, s48
    s_and_b32 s46, vcc_lo, 7
    s_cselect_b32 s47, 1073741824, s47
    s_cselect_b32 s71, 0, 1
    s_add_u32 m0, s48, 0
    s_add_u32 s46, s47, 0
    buffer_load_dwordx4 v1, s[4:7], s46 offen offset:0 sc1 lds
    buffer_load_dwordx4 v1, s[4:7], s46 offen offset:1024 sc1 lds
    s_add_u32 m0, s48, 8192
    s_add_u32 s46, s47, 16777216
    buffer_load_dwordx4 v1, s[4:7], s46 offen offset:0 sc1 lds
    buffer_load_dwordx4 v1, s[4:7], s46 offen offset:1024 sc1 lds
    s_add_u32 m0, s48, 16384
    s_add_u32 s46, s47, 33554432
    buffer_load_dwordx4 v1, s[4:7], s46 offen offset:0 sc1 lds
    buffer_load_dwordx4 v1, s[4:7], s46 offen offset:1024 sc1 lds
    s_add_u32 s47, s65, 1
    s_lshl_b32 s47, s47, 17
    s_add_u32 s47, s47, s70
    s_add_u32 s47, s47, 50331648
    s_cmp_ge_u32 s65, 56
    s_cselect_b32 s46, 8, 0
    s_or_b32 s46, s46, vcc_lo
    s_and_b32 s46, s46, 15
    s_cselect_b32 s47, 1073741824, s47
    s_cselect_b32 s71, s71, 3
    s_mov_b32 m0, s68
    s_nop 0
    buffer_load_dwordx4 v1, s[4:7], s47 offen sc1 lds
    v_min_u32 v15, 124, v12
L_awn:
    buffer_load_dword v14, v15, s[4:7], s50 offen offset:128 sc1
    s_waitcnt vmcnt(0)
    v_cmp_gt_i32 vcc, s45, v14
    s_cbranch_vccz L_awokn
    s_sub_u32 s96, s96, 1
    s_cbranch_scc0 L_awn
    s_branch L_abort
L_awokn:
    s_branch L_pnoffn
L_pffn:
    v_min_u32 v15, 124, v12
L_awb:
    buffer_load_dword v14, v15, s[4:7], s50 offen offset:128 sc1
    s_waitcnt vmcnt(0)
    v_cmp_gt_i32 vcc, s45, v14
    s_cbranch_vccz L_awokb
    s_sub_u32 s96, s96, 1
    s_cbranch_scc0 L_awb
    s_branch L_abort
L_awokb:
    s_lshl_b32 s48, s13, 10
    s_add_u32 s47, s49, s48
    s_add_u32 m0, s48, 43008
    s_add_u32 s46, s47, 2097152
    buffer_load_dwordx4 v1, s[4:7], s46 offen sc1 lds
    s_add_u32 m0, s48, 47104
    s_add_u32 s46, s47, 2101248
    buffer_load_dwordx4 v1, s[4:7], s46 offen sc1 lds
    s_add_u32 m0, s48, 51200
    s_add_u32 s46, s47, 2105344
    buffer_load_dwordx4 v1, s[4:7], s46 offen sc1 lds
    s_add_u32 m0, s48, 55296
    s_add_u32 s46, s47, 2109440
    buffer_load_dwordx4 v1, s[4:7], s46 offen sc1 lds
    s_add_u32 m0, s48, 59392
    s_add_u32 s46, s47, 2113536
    buffer_load_dwordx4 v1, s[4:7], s46 offen sc1 lds
    s_add_u32 m0, s48, 63488
    s_add_u32 s46, s47, 2117632
    buffer_load_dwordx4 v1, s[4:7], s46 offen sc1 lds
    s_add_u32 m0, s48, 67584
    s_add_u32 s46, s47, 2121728
    buffer_load_dwordx4 v1, s[4:7], s46 offen sc1 lds
    s_add_u32 m0, s48, 71680
    s_add_u32 s46, s47, 2125824
    buffer_load_dwordx4 v1, s[4:7], s46 offen sc1 lds
    v_add_u32 v14, 43008, v1
    s_waitcnt vmcnt(6)
    s_barrier
    ds_read_b128 v[48:51], v14 offset:0
    ds_read_b128 v[52:55], v14 offset:1024
    ds_read_b128 v[56:59], v14 offset:2048
    ds_read_b128 v[60:63], v14 offset:3072
    ds_read_b128 v[64:67], v14 offset:4096
    ds_read_b128 v[68:71], v14 offset:5120
    s_waitcnt lgkmcnt(5)
    v_mfma_f32_32x32x16_bf16 v[32:47], a[128:131], v[48:51], 0
    v_cmp_gt_i32 vcc, s65, v0
    s_lshl_b32 s47, s65, 18
    s_lshl_b32 s48, s14, 13
    s_add_u32 s47, s47, s48
    s_lshl_b32 s48, s13, 11
    s_add_u32 s47, s47, s48
    s_and_b32 s46, vcc_lo, 7
    s_cselect_b32 s47, 1073741824, s47
    s_cselect_b32 s71, 0, 1
    s_add_u32 m0, s48, 0
    s_add_u32 s46, s47, 0
    buffer_load_dwordx4 v1, s[4:7], s46 offen offset:0 sc1 lds
    buffer_load_dwordx4 v1, s[4:7], s46 offen offset:1024 sc1 lds
    s_add_u32 m0, s48, 8192
    s_add_u32 s46, s47, 16777216
    buffer_load_dwordx4 v1, s[4:7], s46 offen offset:0 sc1 lds
    buffer_load_dwordx4 v1, s[4:7], s46 offen offset:1024 sc1 lds
    s_add_u32 m0, s48, 16384
    s_add_u32 s46, s47, 33554432
    buffer_load_dwordx4 v1, s[4:7], s46 offen offset:0 sc1 lds
    buffer_load_dwordx4 v1, s[4:7], s46 offen offset:1024 sc1 lds
    s_add_u32 s47, s65, 1
    s_lshl_b32 s47, s47, 17
    s_add_u32 s47, s47, s70
    s_add_u32 s47, s47, 50331648
    s_cmp_ge_u32 s65, 56
    s_cselect_b32 s46, 8, 0
    s_or_b32 s46, s46, vcc_lo
    s_and_b32 s46, s46, 15
    s_cselect_b32 s47, 1073741824, s47
    s_cselect_b32 s71, s71, 3
    s_mov_b32 m0, s68
    s_nop 0
    buffer_load_dwordx4 v1, s[4:7], s47 offen sc1 lds
    ds_read_b128 v[72:75], v14 offset:6144
    s_waitcnt lgkmcnt(5)
    v_mfma_f32_32x32x16_bf16 v[32:47], a[132:135], v[52:55], v[32:47]
    ds_read_b128 v[76:79], v14 offset:7168
    s_waitcnt lgkmcnt(5)
    v_mfma_f32_32x32x16_bf16 v[32:47], a[136:139], v[56:59], v[32:47]
    s_waitcnt vmcnt(11)
    s_barrier
    ds_read_b128 v[48:51], v14 offset:8192
    s_waitcnt lgkmcnt(5)
    v_mfma_f32_32x32x16_bf16 v[32:47], a[140:143], v[60:63], v[32:47]
    ds_read_b128 v[52:55], v14 offset:9216
    s_waitcnt lgkmcnt(5)
    v_mfma_f32_32x32x16_bf16 v[32:47], a[144:147], v[64:67], v[32:47]
    ds_read_b128 v[56:59], v14 offset:10240
    s_waitcnt lgkmcnt(5)
    v_mfma_f32_32x32x16_bf16 v[32:47], a[148:151], v[68:71], v[32:47]
    ds_read_b128 v[60:63], v14 offset:11264
    s_waitcnt lgkmcnt(5)
    v_mfma_f32_32x32x16_bf16 v[32:47], a[152:155], v[72:75], v[32:47]
    ds_read_b128 v[64:67], v14 offset:12288
    s_waitcnt lgkmcnt(5)
    v_mfma_f32_32x32x16_bf16 v[32:47], a[156:159], v[76:79], v[32:47]
    ds_read_b128 v[68:71], v14 offset:13312
    s_waitcnt lgkmcnt(5)
    v_mfma_f32_32x32x16_bf16 v[32:47], a[160:163], v[48:51], v[32:47]
    ds_read_b128 v[72:75], v14 offset:14336
    s_waitcnt lgkmcnt(5)
    v_mfma_f32_32x32x16_bf16 v[32:47], a[164:167], v[52:55], v[32:47]
    ds_read_b128 v[76:79], v14 offset:15360
    s_waitcnt lgkmcnt(5)
    v_mfma_f32_32x32x16_bf16 v[32:47], a[168:171], v[56:59], v[32:47]
    s_waitcnt vmcnt(9)
    s_barrier
    ds_read_b128 v[48:51], v14 offset:16384
    s_waitcnt lgkmcnt(5)
    v_mfma_f32_32x32x16_bf16 v[32:47], a[172:175], v[60:63], v[32:47]
    ds_read_b128 v[52:55], v14 offset:17408
    s_waitcnt lgkmcnt(5)
    v_mfma_f32_32x32x16_bf16 v[32:47], a[176:179], v[64:67], v[32:47]
    ds_read_b128 v[56:59], v14 offset:18432
    s_waitcnt lgkmcnt(5)
    v_mfma_f32_32x32x16_bf16 v[32:47], a[180:183], v[68:71], v[32:47]
    ds_read_b128 v[60:63], v14 offset:19456
    s_waitcnt lgkmcnt(5)
    v_mfma_f32_32x32x16_bf16 v[32:47], a[184:187], v[72:75], v[32:47]
    ds_read_b128 v[64:67], v14 offset:20480
    s_waitcnt lgkmcnt(5)
    v_mfma_f32_32x32x16_bf16 v[32:47], a[188:191], v[76:79], v[32:47]
    ds_read_b128 v[68:71], v14 offset:21504
    s_waitcnt lgkmcnt(5)
    v_mfma_f32_32x32x16_bf16 v[32:47], a[192:195], v[48:51], v[32:47]
    ds_read_b128 v[72:75], v14 offset:22528
    s_waitcnt lgkmcnt(5)
    v_mfma_f32_32x32x16_bf16 v[32:47], a[196:199], v[52:55], v[32:47]
    ds_read_b128 v[76:79], v14 offset:23552
    s_waitcnt lgkmcnt(5)
    v_mfma_f32_32x32x16_bf16 v[32:47], a[200:203], v[56:59], v[32:47]
    s_waitcnt vmcnt(7)
    s_barrier
    ds_read_b128 v[48:51], v14 offset:24576
    s_waitcnt lgkmcnt(5)
    v_mfma_f32_32x32x16_bf16 v[32:47], a[204:207], v[60:63], v[32:47]
    ds_read_b128 v[52:55], v14 offset:25600
    s_waitcnt lgkmcnt(5)
    v_mfma_f32_32x32x16_bf16 v[32:47], a[208:211], v[64:67], v[32:47]
    ds_read_b128 v[56:59], v14 offset:26624
    s_waitcnt lgkmcnt(5)
    v_mfma_f32_32x32x16_bf16 v[32:47], a[212:215], v[68:71], v[32:47]
    ds_read_b128 v[60:63], v14 offset:27648
    s_waitcnt lgkmcnt(5)
    v_mfma_f32_32x32x16_bf16 v[32:47], a[216:219], v[72:75], v[32:47]
    ds_read_b128 v[64:67], v14 offset:28672
    s_waitcnt lgkmcnt(5)
    v_mfma_f32_32x32x16_bf16 v[32:47], a[220:223], v[76:79], v[32:47]
    ds_read_b128 v[68:71], v14 offset:29696
    s_waitcnt lgkmcnt(5)
    v_mfma_f32_32x32x16_bf16 v[32:47], a[224:227], v[48:51], v[32:47]
    ds_read_b128 v[72:75], v14 offset:30720
    s_waitcnt lgkmcnt(5)
    v_mfma_f32_32x32x16_bf16 v[32:47], a[228:231], v[52:55], v[32:47]
    ds_read_b128 v[76:79], v14 offset:31744
    s_waitcnt lgkmcnt(5)
    v_mfma_f32_32x32x16_bf16 v[32:47], a[232:235], v[56:59], v[32:47]
    s_waitcnt lgkmcnt(4)
    v_mfma_f32_32x32x16_bf16 v[32:47], a[236:239], v[60:63], v[32:47]
    s_waitcnt lgkmcnt(3)
    v_mfma_f32_32x32x16_bf16 v[32:47], a[240:243], v[64:67], v[32:47]
    s_waitcnt lgkmcnt(2)
    v_mfma_f32_32x32x16_bf16 v[32:47], a[244:247], v[68:71], v[32:47]
    s_waitcnt lgkmcnt(1)
    v_mfma_f32_32x32x16_bf16 v[32:47], a[248:251], v[72:75], v[32:47]
    s_waitcnt lgkmcnt(0)
    v_mfma_f32_32x32x16_bf16 v[32:47], a[252:255], v[76:79], v[32:47]
    v_mov_b32 v88, s54
    v_mov_b32_e64 v90, s55
    s_lshl_b32 s46, s13, 10
    v_add_u32 v15, s46, v1
    s_nop 8
    v_pk_mul_f32 v[80:81], v[32:33], v[32:33]
    v_pk_mul_f32 v[82:83], v[34:35], v[34:35]
    v_pk_mul_f32 v[84:85], v[36:37], v[36:37]
    v_pk_mul_f32 v[86:87], v[38:39], v[38:39]
    v_pk_fma_f32 v[80:81], v[80:81], v[90:91], v[88:89] op_sel_hi:[1,0,0]
    v_pk_fma_f32 v[82:83], v[82:83], v[90:91], v[88:89] op_sel_hi:[1,0,0]
    v_pk_fma_f32 v[84:85], v[84:85], v[90:91], v[88:89] op_sel_hi:[1,0,0]
    v_pk_fma_f32 v[86:87], v[86:87], v[90:91], v[88:89] op_sel_hi:[1,0,0]
    v_pk_mul_f32 v[80:81], v[80:81], v[32:33]
    v_pk_mul_f32 v[82:83], v[82:83], v[34:35]
    v_pk_mul_f32 v[84:85], v[84:85], v[36:37]
    v_pk_mul_f32 v[86:87], v[86:87], v[38:39]
    v_exp_f32 v80, v80
    v_exp_f32 v81, v81
    v_exp_f32 v82, v82
    v_exp_f32 v83, v83
    v_exp_f32 v84, v84
    v_exp_f32 v85, v85
    v_exp_f32 v86, v86
    v_exp_f32 v87, v87
    v_pk_mul_f32 v[32:33], v[32:33], v[40:41]
    v_pk_mul_f32 v[34:35], v[34:35], v[42:43]
    v_pk_mul_f32 v[36:37], v[36:37], v[44:45]
    v_pk_mul_f32 v[38:39], v[38:39], v[46:47]
    v_pk_add_f32 v[80:81], v[80:81], 1.0 op_sel_hi:[1,0]
    v_pk_add_f32 v[82:83], v[82:83], 1.0 op_sel_hi:[1,0]
    v_pk_add_f32 v[84:85], v[84:85], 1.0 op_sel_hi:[1,0]
    v_pk_add_f32 v[86:87], v[86:87], 1.0 op_sel_hi:[1,0]
    v_rcp_f32 v80, v80
    v_rcp_f32 v81, v81
    v_rcp_f32 v82, v82
    v_rcp_f32 v83, v83
    v_rcp_f32 v84, v84
    v_rcp_f32 v85, v85
    v_rcp_f32 v86, v86
    v_rcp_f32_e64 v87, v87
    s_nop 0
    v_pk_mul_f32 v[32:33], v[32:33], v[80:81]
    v_pk_mul_f32 v[34:35], v[34:35], v[82:83]
    v_pk_mul_f32 v[36:37], v[36:37], v[84:85]
    v_pk_mul_f32 v[38:39], v[38:39], v[86:87]
    v_cvt_pk_bf16_f32 v80, v32, v33
    v_cvt_pk_bf16_f32 v81, v34, v35
    v_cvt_pk_bf16_f32 v82, v36, v37
    v_cvt_pk_bf16_f32 v83, v38, v39
    ds_write_b128 v15, v[80:83] offset:37888
    s_waitcnt lgkmcnt(0)
    s_barrier
    ds_read_b128 v[32:35], v2 offset:37888
    ds_read_b128 v[36:39], v2 offset:39936
    ds_read_b128 v[40:43], v2 offset:38144
    ds_read_b128 v[44:47], v2 offset:40192
    s_waitcnt lgkmcnt(3)
    v_mfma_f32_16x16x32_bf16 v[96:99], v[32:35], v[192:195], 0
    v_mfma_f32_16x16x32_bf16 v[100:103], v[32:35], v[200:203], 0
    v_mfma_f32_16x16x32_bf16 v[104:107], v[32:35], v[208:211], 0
    v_mfma_f32_16x16x32_bf16 v[108:111], v[32:35], v[216:219], 0
    v_mfma_f32_16x16x32_bf16 v[112:115], v[32:35], v[224:227], 0
    v_mfma_f32_16x16x32_bf16 v[116:119], v[32:35], v[232:235], 0
    v_mfma_f32_16x16x32_bf16 v[120:123], v[32:35], v[240:243], 0
    v_mfma_f32_16x16x32_bf16 v[124:127], v[32:35], v[248:251], 0
    s_waitcnt lgkmcnt(2)
    v_mfma_f32_16x16x32_bf16 v[96:99], v[36:39], v[196:199], v[96:99]
    v_mfma_f32_16x16x32_bf16 v[100:103], v[36:39], v[204:207], v[100:103]
    v_mfma_f32_16x16x32_bf16 v[104:107], v[36:39], v[212:215], v[104:107]
    v_mfma_f32_16x16x32_bf16 v[108:111], v[36:39], v[220:223], v[108:111]
    v_mfma_f32_16x16x32_bf16 v[112:115], v[36:39], v[228:231], v[112:115]
    v_mfma_f32_16x16x32_bf16 v[116:119], v[36:39], v[236:239], v[116:119]
    v_mfma_f32_16x16x32_bf16 v[120:123], v[36:39], v[244:247], v[120:123]
    v_mfma_f32_16x16x32_bf16 v[124:127], v[36:39], v[252:255], v[124:127]
    s_waitcnt lgkmcnt(1)
    v_mfma_f32_16x16x32_bf16 v[128:131], v[40:43], v[192:195], 0
    v_mfma_f32_16x16x32_bf16 v[132:135], v[40:43], v[200:203], 0
    v_cvt_pk_bf16_f32 v160, v96, v100
    v_cvt_pk_bf16_f32 v161, v104, v108
    v_mfma_f32_16x16x32_bf16 v[136:139], v[40:43], v[208:211], 0
    v_cvt_pk_bf16_f32 v162, v112, v116
    v_cvt_pk_bf16_f32 v163, v120, v124
    v_mfma_f32_16x16x32_bf16 v[140:143], v[40:43], v[216:219], 0
    s_add_u32 s46, s49, 1048576
    buffer_store_dwordx4 v[160:163], v8, s[4:7], s46 offen
    v_mfma_f32_16x16x32_bf16 v[144:147], v[40:43], v[224:227], 0
    v_cvt_pk_bf16_f32 v164, v97, v101
    v_cvt_pk_bf16_f32 v165, v105, v109
    v_mfma_f32_16x16x32_bf16 v[148:151], v[40:43], v[232:235], 0
    v_cvt_pk_bf16_f32 v166, v113, v117
    v_cvt_pk_bf16_f32 v167, v121, v125
    v_mfma_f32_16x16x32_bf16 v[152:155], v[40:43], v[240:243], 0
    s_add_u32 s46, s49, 1081344
    buffer_store_dwordx4 v[164:167], v8, s[4:7], s46 offen
    v_mfma_f32_16x16x32_bf16 v[156:159], v[40:43], v[248:251], 0
    v_cvt_pk_bf16_f32 v168, v98, v102
    v_cvt_pk_bf16_f32 v169, v106, v110
    s_waitcnt lgkmcnt(0)
    v_mfma_f32_16x16x32_bf16 v[128:131], v[44:47], v[196:199], v[128:131]
    v_cvt_pk_bf16_f32 v170, v114, v118
    v_cvt_pk_bf16_f32 v171, v122, v126
    v_mfma_f32_16x16x32_bf16 v[132:135], v[44:47], v[204:207], v[132:135]
    s_add_u32 s46, s49, 1114112
    buffer_store_dwordx4 v[168:171], v8, s[4:7], s46 offen
    v_mfma_f32_16x16x32_bf16 v[136:139], v[44:47], v[212:215], v[136:139]
    v_cvt_pk_bf16_f32 v172, v99, v103
    v_cvt_pk_bf16_f32 v173, v107, v111
    v_mfma_f32_16x16x32_bf16 v[140:143], v[44:47], v[220:223], v[140:143]
    v_cvt_pk_bf16_f32 v174, v115, v119
    v_cvt_pk_bf16_f32 v175, v123, v127
    v_mfma_f32_16x16x32_bf16 v[144:147], v[44:47], v[228:231], v[144:147]
    s_add_u32 s46, s49, 1146880
    buffer_store_dwordx4 v[172:175], v8, s[4:7], s46 offen
    v_mfma_f32_16x16x32_bf16 v[148:151], v[44:47], v[236:239], v[148:151]
    v_mfma_f32_16x16x32_bf16 v[152:155], v[44:47], v[244:247], v[152:155]
    v_mfma_f32_16x16x32_bf16 v[156:159], v[44:47], v[252:255], v[156:159]
    s_nop 4
    v_cvt_pk_bf16_f32 v176, v128, v132
    v_cvt_pk_bf16_f32 v177, v136, v140
    v_cvt_pk_bf16_f32 v178, v144, v148
    v_cvt_pk_bf16_f32 v179, v152, v156
    s_add_u32 s46, s49, 1572864
    buffer_store_dwordx4 v[176:179], v8, s[4:7], s46 offen
    v_cvt_pk_bf16_f32 v180, v129, v133
    v_cvt_pk_bf16_f32 v181, v137, v141
    v_cvt_pk_bf16_f32 v182, v145, v149
    v_cvt_pk_bf16_f32 v183, v153, v157
    s_add_u32 s46, s49, 1605632
    buffer_store_dwordx4 v[180:183], v8, s[4:7], s46 offen
    v_cvt_pk_bf16_f32 v184, v130, v134
    v_cvt_pk_bf16_f32 v185, v138, v142
    v_cvt_pk_bf16_f32 v186, v146, v150
    v_cvt_pk_bf16_f32 v187, v154, v158
    s_add_u32 s46, s49, 1638400
    buffer_store_dwordx4 v[184:187], v8, s[4:7], s46 offen
    v_cvt_pk_bf16_f32 v188, v131, v135
    v_cvt_pk_bf16_f32 v189, v139, v143
    v_cvt_pk_bf16_f32 v190, v147, v151
    v_cvt_pk_bf16_f32 v191, v155, v159
    s_add_u32 s46, s49, 1671168
    buffer_store_dwordx4 v[188:191], v8, s[4:7], s46 offen
    s_waitcnt vmcnt(0)
    s_barrier
    s_cmp_lg_u32 s13, 0
    s_cbranch_scc1 L_sigc
    v_mov_b32 v14, s45
    s_lshl_b32 s46, s14, 2
    v_mov_b32_e64 v15, s46
    s_mov_b64 exec, 1
    buffer_store_dword v14, v15, s[4:7], s50 offen offset:256
    s_mov_b64 exec, -1
L_sigc:
L_pnoffn:
    s_mov_b32 s73, s44
    s_mov_b32 s74, s45
    s_mov_b32 s44, s65
    s_add_u32 s45, s45, 1
    s_cmp_eq_u32 s71, 3
    s_cselect_b32 s72, 1, 0
    s_cbranch_scc1 L_ploop
    v_min_u32 v15, 108, v12
L_awc:
    buffer_load_dword v14, v15, s[4:7], s50 offen offset:256 sc1
    s_waitcnt vmcnt(0)
    v_cmp_gt_i32 vcc, s74, v14
    s_cbranch_vccz L_awokc
    s_sub_u32 s96, s96, 1
    s_cbranch_scc0 L_awc
    s_branch L_abort
L_awokc:
    s_add_u32 s46, s49, 1048576
    buffer_load_dwordx4 v[32:35], v9, s[4:7], s46 offen sc1
    s_add_u32 s46, s46, 4096
    buffer_load_dwordx4 v[36:39], v9, s[4:7], s46 offen sc1
    s_add_u32 s46, s46, 4096
    buffer_load_dwordx4 v[40:43], v9, s[4:7], s46 offen sc1
    s_add_u32 s46, s46, 4096
    buffer_load_dwordx4 v[44:47], v9, s[4:7], s46 offen sc1
    s_add_u32 s46, s46, 4096
    buffer_load_dwordx4 v[48:51], v9, s[4:7], s46 offen sc1
    s_add_u32 s46, s46, 4096
    buffer_load_dwordx4 v[52:55], v9, s[4:7], s46 offen sc1
    s_add_u32 s46, s46, 4096
    buffer_load_dwordx4 v[56:59], v9, s[4:7], s46 offen sc1
    s_waitcnt vmcnt(6)
    v_mfma_f32_16x16x32_bf16 v[64:67], v[16:19], v[32:35], 0
    s_waitcnt vmcnt(5)
    v_mfma_f32_16x16x32_bf16 v[64:67], v[16:19], v[36:39], v[64:67]
    s_waitcnt vmcnt(4)
    v_mfma_f32_16x16x32_bf16 v[64:67], v[16:19], v[40:43], v[64:67]
    s_waitcnt vmcnt(3)
    v_mfma_f32_16x16x32_bf16 v[64:67], v[16:19], v[44:47], v[64:67]
    s_waitcnt vmcnt(2)
    v_mfma_f32_16x16x32_bf16 v[64:67], v[16:19], v[48:51], v[64:67]
    s_waitcnt vmcnt(1)
    v_mfma_f32_16x16x32_bf16 v[64:67], v[16:19], v[52:55], v[64:67]
    s_waitcnt vmcnt(0)
    v_mfma_f32_16x16x32_bf16 v[64:67], v[16:19], v[56:59], v[64:67]
    s_nop 7
    v_add_f32 v64, v64, v28
    v_add_f32 v65, v65, v29
    v_add_f32 v66, v66, v30
    v_add_f32 v67, v67, v31
    v_cvt_pk_bf16_f32 v64, v64, v65
    v_cvt_pk_bf16_f32 v65, v66, v67
    s_lshl_b32 s46, s73, 15
    s_mov_b32 exec_hi, 0
    buffer_store_dwordx2 v[64:65], v10, s[56:59], s46 offen
    s_mov_b64 exec, -1
    s_cmp_lt_u32 s44, 64
    s_cbranch_scc1 L_ploop
    s_waitcnt vmcnt(0)
    s_endpgm
L_ploopX:
    s_add_u32 s65, s44, 3
    s_cmp_lt_u32 s65, 18
    s_cselect_b32 s65, s65, s64
    s_add_u32 s46, s44, 6
    s_cmp_ge_u32 s44, 18
    s_cselect_b32 s65, s46, s65
    s_bitcmp1_b32 s71, 0
    s_cbranch_scc1 L_fqdoneX
L_fqX:
    s_mov_b32 s46, 65830912
    buffer_load_dword v14, v13, s[4:7], s46 offen sc1
    s_waitcnt vmcnt(0)
    v_cmp_gt_i32 vcc, s44, v14
    s_and_b32 s46, vcc_lo, 7
    s_cbranch_scc0 L_fqokX
    s_sleep 8
    s_sub_u32 s96, s96, 1
    s_cbranch_scc0 L_fqX
    s_branch L_abort
L_fqokX:
    s_lshl_b32 s47, s44, 18
    s_lshl_b32 s48, s14, 13
    s_add_u32 s47, s47, s48
    s_lshl_b32 s48, s13, 11
    s_add_u32 s47, s47, s48
    s_add_u32 m0, s48, 0
    s_add_u32 s46, s47, 0
    buffer_load_dwordx4 v1, s[4:7], s46 offen offset:0 sc1 lds
    buffer_load_dwordx4 v1, s[4:7], s46 offen offset:1024 sc1 lds
    s_add_u32 m0, s48, 8192
    s_add_u32 s46, s47, 16777216
    buffer_load_dwordx4 v1, s[4:7], s46 offen offset:0 sc1 lds
    buffer_load_dwordx4 v1, s[4:7], s46 offen offset:1024 sc1 lds
    s_add_u32 m0, s48, 16384
    s_add_u32 s46, s47, 33554432
    buffer_load_dwordx4 v1, s[4:7], s46 offen offset:0 sc1 lds
    buffer_load_dwordx4 v1, s[4:7], s46 offen offset:1024 sc1 lds
L_fqdoneX:
    s_sub_u32 s53, s44, 1
    s_min_u32 s53, s53, 61
    s_cmp_ge_u32 s44, 56
    s_cselect_b32 s53, s53, s44
    s_lshr_b32 s46, s71, 1
    s_or_b32 s46, s46, s13
    s_cbranch_scc1 L_ppubwX
L_ppubX:
    s_mov_b32 s46, 65830912
    buffer_load_dword v14, v13, s[4:7], s46 offen sc1
    s_waitcnt vmcnt(0)
    v_readlane_b32 s48, v14, 3
    s_cmp_ge_i32 s48, s53
    s_cbranch_scc1 L_ppubwX
    s_add_u32 s48, s48, 1
    s_cmp_ge_i32 s48, s53
    s_cbranch_scc1 L_pnearX
    s_sleep 40
L_pnearX:
    s_sleep 3
    s_sub_u32 s96, s96, 1
    s_cbranch_scc0 L_ppubX
    s_branch L_abort
L_ppubwX:
    s_barrier
    s_cmp_ge_u32 s44, 56
    s_cbranch_scc1 L_plastX
    s_bitcmp1_b32 s71, 1
    s_cbranch_scc1 L_plastX
    s_add_u32 s46, s44, 1
    s_lshl_b32 s46, s46, 17
    s_add_u32 s46, s46, s70
    s_add_u32 s46, s46, 50331648
    s_mov_b32 m0, s68
    s_nop 0
    buffer_load_dwordx4 v1, s[4:7], s46 offen sc1 lds
    s_waitcnt vmcnt(1)
    s_branch L_pgoX
L_plastX:
    s_bitcmp1_b32 s71, 0
    s_cbranch_scc1 L_pgoX
    s_waitcnt vmcnt(0)
L_pgoX:
    s_barrier
    ds_read_b128 v[64:67], v3 offset:0
    ds_read_b128 v[32:35], v2 offset:8192
    ds_read_b128 v[36:39], v2 offset:8448
    ds_read_b128 v[68:71], v3 offset:2048
    ds_read_b128 v[40:43], v2 offset:10240
    ds_read_b128 v[44:47], v2 offset:10496
    ds_read_b128 v[72:75], v3 offset:4096
    ds_read_b128 v[48:51], v2 offset:12288
    ds_read_b128 v[52:55], v2 offset:12544
    ds_read_b128 v[76:79], v3 offset:6144
    ds_read_b128 v[56:59], v2 offset:14336
    ds_read_b128 v[60:63], v2 offset:14592
    s_waitcnt lgkmcnt(9)
    v_mfma_f32_16x16x32_bf16 v[128:131], v[32:35], v[64:67], v[20:23]
    v_mfma_f32_16x16x32_bf16 v[132:135], v[36:39], v[64:67], v[24:27]
    ds_read_b64_tr_b16 v[96:97], v5 offset:16384
    ds_read_b64_tr_b16 v[98:99], v5 offset:16640
    s_waitcnt lgkmcnt(8)
    v_mfma_f32_16x16x32_bf16 v[128:131], v[40:43], v[68:71], v[128:131]
    v_mfma_f32_16x16x32_bf16 v[132:135], v[44:47], v[68:71], v[132:135]
    ds_read_b64_tr_b16 v[100:101], v5 offset:17408
    ds_read_b64_tr_b16 v[102:103], v5 offset:17664
    s_waitcnt lgkmcnt(7)
    v_mfma_f32_16x16x32_bf16 v[128:131], v[48:51], v[72:75], v[128:131]
    v_mfma_f32_16x16x32_bf16 v[132:135], v[52:55], v[72:75], v[132:135]
    ds_read_b64_tr_b16 v[104:105], v5 offset:18432
    ds_read_b64_tr_b16 v[106:107], v5 offset:18688
    s_waitcnt lgkmcnt(6)
    v_mfma_f32_16x16x32_bf16 v[128:131], v[56:59], v[76:79], v[128:131]
    v_mfma_f32_16x16x32_bf16 v[132:135], v[60:63], v[76:79], v[132:135]
    ds_read_b64_tr_b16 v[108:109], v5 offset:19456
    ds_read_b64_tr_b16 v[110:111], v5 offset:19712
    v_mov_b32 v144, 0x3f803f80
    v_mov_b32_e64 v113, 0
    v_mov_b32 v145, 0x3f803f80
    v_mov_b32_e64 v115, 0
    v_mov_b32 v146, 0x3f803f80
    v_mov_b32_e64 v117, 0
    v_mov_b32 v147, 0x3f803f80
    v_mov_b32 v119, 0
    s_cmp_lt_u32 s44, 56
    s_cbranch_scc1 L_pkmX
    s_sub_u32 s46, s44, 56
    s_lshl_b32 s46, s46, 17
    s_add_u32 s46, s46, s70
    s_add_u32 s46, s46, 66060288
    v_add_u32 v15, s68, v1
L_pdirX:
    buffer_load_dwordx4 v[80:83], v1, s[4:7], s46 offen sc1
    s_waitcnt vmcnt(0)
    v_max3_u32 v14, v80, v81, v82
    v_max_u32_e64 v14, v14, v83
    v_cmp_eq_u32 vcc, -1, v14
    s_cbranch_vccz L_pdirokX
    s_sleep 2
    s_sub_u32 s96, s96, 1
    s_cbranch_scc0 L_pdirX
    s_branch L_abort
L_pdirokX:
    ds_write_b128 v15, v[80:83]
    s_waitcnt lgkmcnt(0)
L_pkmX:
    s_waitcnt vmcnt(0)
    s_barrier
    ds_read_b64_tr_b16 v[80:81], v4 offset:24576
    ds_read_b64_tr_b16 v[82:83], v4 offset:24608
    ds_read_b64_tr_b16 v[84:85], v4 offset:24832
    ds_read_b64_tr_b16 v[86:87], v4 offset:24864
    ds_read_b64_tr_b16 v[88:89], v4 offset:25088
    ds_read_b64_tr_b16 v[90:91], v4 offset:25120
    ds_read_b64_tr_b16 v[92:93], v4 offset:25344
    ds_read_b64_tr_b16 v[94:95], v4 offset:25376
    ds_read_b32 v112, v6 offset:24580
    ds_read_b32 v114, v6 offset:24708
    ds_read_b32 v116, v6 offset:24836
    ds_read_b32 v118, v6 offset:24964
    s_waitcnt lgkmcnt(10)
    v_mfma_f32_16x16x32_bf16 v[136:139], v[80:83], v[64:67], 0
    s_waitcnt lgkmcnt(8)
    v_mfma_f32_16x16x32_bf16 v[136:139], v[84:87], v[68:71], v[136:139]
    s_waitcnt lgkmcnt(6)
    v_mfma_f32_16x16x32_bf16 v[136:139], v[88:91], v[72:75], v[136:139]
    s_waitcnt lgkmcnt(4)
    v_mfma_f32_16x16x32_bf16 v[136:139], v[92:95], v[76:79], v[136:139]
    v_max3_f32 v140, v128, v129, v130
    v_max3_f32 v141, v131, v132, v133
    v_max3_f32 v140, v140, v134, v135
    s_nop 4
    v_max3_f32 v141, v141, v136, v137
    v_max_f32 v138, v140, v141
    v_max_f32 v139, v140, v141
    s_nop 1
    v_permlane16_swap_b32 v138, v139
    v_max_f32 v140, v138, v139
    v_max_f32 v141, v138, v139
    s_nop 1
    v_permlane32_swap_b32 v140, v141
    v_max_f32 v138, v140, v141
    v_mul_f32 v138, s51, v138
    v_fma_f32 v128, v128, s51, -v138
    v_fma_f32 v129, v129, s51, -v138
    v_fma_f32 v130, v130, s51, -v138
    v_fma_f32 v131, v131, s51, -v138
    v_fma_f32 v132, v132, s51, -v138
    v_fma_f32 v133, v133, s51, -v138
    v_fma_f32 v134, v134, s51, -v138
    v_fma_f32 v135, v135, s51, -v138
    v_fma_f32 v136, v136, s51, -v138
    v_fma_f32 v137, v137, s51, -v138
    v_exp_f32 v128, v128
    v_exp_f32 v129, v129
    v_exp_f32 v130, v130
    v_exp_f32 v131, v131
    v_exp_f32 v132, v132
    v_exp_f32 v133, v133
    v_exp_f32 v134, v134
    v_exp_f32 v135, v135
    v_exp_f32 v136, v136
    v_exp_f32 v137, v137
    v_cvt_pk_bf16_f32 v140, v128, v129
    v_cvt_pk_bf16_f32 v141, v130, v131
    v_cvt_pk_bf16_f32 v142, v132, v133
    v_cvt_pk_bf16_f32 v143, v134, v135
    v_cvt_pk_bf16_f32 v136, v136, v137
    v_mov_b32 v137, 0
    s_waitcnt lgkmcnt(0)
    v_mfma_f32_16x16x32_bf16 v[148:151], v[144:147], v[140:143], 0
    v_mfma_f32_16x16x32_bf16 v[152:155], v[96:99], v[140:143], 0
    v_mfma_f32_16x16x32_bf16 v[156:159], v[100:103], v[140:143], 0
    v_mfma_f32_16x16x32_bf16 v[160:163], v[104:107], v[140:143], 0
    v_mfma_f32_16x16x32_bf16 v[164:167], v[108:111], v[140:143], 0
    v_mfma_f32_16x16x16_bf16 v[148:151], v[144:145], v[136:137], v[148:151]
    v_mfma_f32_16x16x16_bf16 v[152:155], v[112:113], v[136:137], v[152:155]
    v_mfma_f32_16x16x16_bf16 v[156:159], v[114:115], v[136:137], v[156:159]
    v_mfma_f32_16x16x16_bf16 v[160:163], v[116:117], v[136:137], v[160:163]
    v_mfma_f32_16x16x16_bf16 v[164:167], v[118:119], v[136:137], v[164:167]
    v_rcp_f32 v148, v148
    s_nop 0
    v_mul_f32 v152, v152, v148
    v_mul_f32 v153, v153, v148
    v_mul_f32 v154, v154, v148
    v_mul_f32 v155, v155, v148
    v_cvt_pk_bf16_f32 v152, v152, v153
    v_cvt_pk_bf16_f32 v153, v154, v155
    ds_write_b64 v7, v[152:153] offset:29696
    v_mul_f32 v156, v156, v148
    v_mul_f32 v157, v157, v148
    v_mul_f32 v158, v158, v148
    v_mul_f32 v159, v159, v148
    v_cvt_pk_bf16_f32 v156, v156, v157
    v_cvt_pk_bf16_f32 v157, v158, v159
    ds_write_b64 v7, v[156:157] offset:30720
    v_mul_f32 v160, v160, v148
    v_mul_f32 v161, v161, v148
    v_mul_f32 v162, v162, v148
    v_mul_f32 v163, v163, v148
    v_cvt_pk_bf16_f32 v160, v160, v161
    v_cvt_pk_bf16_f32 v161, v162, v163
    ds_write_b64 v7, v[160:161] offset:31744
    v_mul_f32 v164, v164, v148
    v_mul_f32 v165, v165, v148
    v_mul_f32 v166, v166, v148
    v_mul_f32 v167, v167, v148
    v_cvt_pk_bf16_f32 v164, v164, v165
    v_cvt_pk_bf16_f32 v165, v166, v167
    ds_write_b64 v7, v[164:165] offset:32768
    s_waitcnt lgkmcnt(0)
    s_barrier
    s_lshl_b32 s46, s44, 15
    buffer_load_dwordx2 v[80:81], v10, s[60:63], s46 offen
    s_mov_b32 s46, 65830912
    buffer_load_dword v0, v13, s[4:7], s46 offen sc1
    ds_read_b128 v[32:35], v2 offset:29696
    ds_read_b128 v[36:39], v2 offset:31744
    ds_read_b128 v[40:43], v2 offset:33792
    ds_read_b128 v[44:47], v2 offset:35840
    ds_read_b128 v[48:51], v2 offset:29952
    ds_read_b128 v[52:55], v2 offset:32000
    ds_read_b128 v[56:59], v2 offset:34048
    ds_read_b128 v[60:63], v2 offset:36096
    s_waitcnt lgkmcnt(7)
    v_mfma_f32_16x16x32_bf16 v[96:99], v[32:35], a[0:3], 0
    v_mfma_f32_16x16x32_bf16 v[100:103], v[32:35], a[16:19], 0
    v_mfma_f32_16x16x32_bf16 v[104:107], v[32:35], a[32:35], 0
    v_mfma_f32_16x16x32_bf16 v[108:111], v[32:35], a[48:51], 0
    v_mfma_f32_16x16x32_bf16 v[112:115], v[32:35], a[64:67], 0
    v_mfma_f32_16x16x32_bf16 v[116:119], v[32:35], a[80:83], 0
    v_mfma_f32_16x16x32_bf16 v[120:123], v[32:35], a[96:99], 0
    v_mfma_f32_16x16x32_bf16 v[124:127], v[32:35], a[112:115], 0
    s_waitcnt lgkmcnt(6)
    v_mfma_f32_16x16x32_bf16 v[96:99], v[36:39], a[4:7], v[96:99]
    v_mfma_f32_16x16x32_bf16 v[100:103], v[36:39], a[20:23], v[100:103]
    v_mfma_f32_16x16x32_bf16 v[104:107], v[36:39], a[36:39], v[104:107]
    v_mfma_f32_16x16x32_bf16 v[108:111], v[36:39], a[52:55], v[108:111]
    v_mfma_f32_16x16x32_bf16 v[112:115], v[36:39], a[68:71], v[112:115]
    v_mfma_f32_16x16x32_bf16 v[116:119], v[36:39], a[84:87], v[116:119]
    v_mfma_f32_16x16x32_bf16 v[120:123], v[36:39], a[100:103], v[120:123]
    v_mfma_f32_16x16x32_bf16 v[124:127], v[36:39], a[116:119], v[124:127]
    s_waitcnt lgkmcnt(5)
    v_mfma_f32_16x16x32_bf16 v[96:99], v[40:43], a[8:11], v[96:99]
    v_mfma_f32_16x16x32_bf16 v[100:103], v[40:43], a[24:27], v[100:103]
    v_mfma_f32_16x16x32_bf16 v[104:107], v[40:43], a[40:43], v[104:107]
    v_mfma_f32_16x16x32_bf16 v[108:111], v[40:43], a[56:59], v[108:111]
    v_mfma_f32_16x16x32_bf16 v[112:115], v[40:43], a[72:75], v[112:115]
    v_mfma_f32_16x16x32_bf16 v[116:119], v[40:43], a[88:91], v[116:119]
    v_mfma_f32_16x16x32_bf16 v[120:123], v[40:43], a[104:107], v[120:123]
    v_mfma_f32_16x16x32_bf16 v[124:127], v[40:43], a[120:123], v[124:127]
    s_waitcnt lgkmcnt(4)
    v_mfma_f32_16x16x32_bf16 v[96:99], v[44:47], a[12:15], v[96:99]
    v_mfma_f32_16x16x32_bf16 v[100:103], v[44:47], a[28:31], v[100:103]
    v_mfma_f32_16x16x32_bf16 v[104:107], v[44:47], a[44:47], v[104:107]
    v_mfma_f32_16x16x32_bf16 v[108:111], v[44:47], a[60:63], v[108:111]
    v_mfma_f32_16x16x32_bf16 v[112:115], v[44:47], a[76:79], v[112:115]
    v_mfma_f32_16x16x32_bf16 v[116:119], v[44:47], a[92:95], v[116:119]
    v_mfma_f32_16x16x32_bf16 v[120:123], v[44:47], a[108:111], v[120:123]
    v_mfma_f32_16x16x32_bf16 v[124:127], v[44:47], a[124:127], v[124:127]
    s_waitcnt lgkmcnt(3)
    v_mfma_f32_16x16x32_bf16 v[128:131], v[48:51], a[0:3], 0
    v_mfma_f32_16x16x32_bf16 v[132:135], v[48:51], a[16:19], 0
    v_cvt_pk_bf16_f32 v160, v96, v100
    v_cvt_pk_bf16_f32 v161, v104, v108
    v_mfma_f32_16x16x32_bf16 v[136:139], v[48:51], a[32:35], 0
    v_cvt_pk_bf16_f32 v162, v112, v116
    v_cvt_pk_bf16_f32 v163, v120, v124
    v_mfma_f32_16x16x32_bf16 v[140:143], v[48:51], a[48:51], 0
    s_add_u32 s46, s49, 0
    buffer_store_dwordx4 v[160:163], v8, s[4:7], s46 offen sc1
    v_mfma_f32_16x16x32_bf16 v[144:147], v[48:51], a[64:67], 0
    v_cvt_pk_bf16_f32 v164, v97, v101
    v_cvt_pk_bf16_f32 v165, v105, v109
    v_mfma_f32_16x16x32_bf16 v[148:151], v[48:51], a[80:83], 0
    v_cvt_pk_bf16_f32 v166, v113, v117
    v_cvt_pk_bf16_f32 v167, v121, v125
    v_mfma_f32_16x16x32_bf16 v[152:155], v[48:51], a[96:99], 0
    s_add_u32 s46, s49, 32768
    buffer_store_dwordx4 v[164:167], v8, s[4:7], s46 offen sc1
    v_mfma_f32_16x16x32_bf16 v[156:159], v[48:51], a[112:115], 0
    v_cvt_pk_bf16_f32 v168, v98, v102
    v_cvt_pk_bf16_f32 v169, v106, v110
    s_waitcnt lgkmcnt(2)
    v_mfma_f32_16x16x32_bf16 v[128:131], v[52:55], a[4:7], v[128:131]
    v_cvt_pk_bf16_f32 v170, v114, v118
    v_cvt_pk_bf16_f32 v171, v122, v126
    v_mfma_f32_16x16x32_bf16 v[132:135], v[52:55], a[20:23], v[132:135]
    s_add_u32 s46, s49, 65536
    buffer_store_dwordx4 v[168:171], v8, s[4:7], s46 offen sc1
    v_mfma_f32_16x16x32_bf16 v[136:139], v[52:55], a[36:39], v[136:139]
    v_cvt_pk_bf16_f32 v172, v99, v103
    v_cvt_pk_bf16_f32 v173, v107, v111
    v_mfma_f32_16x16x32_bf16 v[140:143], v[52:55], a[52:55], v[140:143]
    v_cvt_pk_bf16_f32 v174, v115, v119
    v_cvt_pk_bf16_f32 v175, v123, v127
    v_mfma_f32_16x16x32_bf16 v[144:147], v[52:55], a[68:71], v[144:147]
    s_add_u32 s46, s49, 98304
    buffer_store_dwordx4 v[172:175], v8, s[4:7], s46 offen sc1
    v_mfma_f32_16x16x32_bf16 v[148:151], v[52:55], a[84:87], v[148:151]
    v_mfma_f32_16x16x32_bf16 v[152:155], v[52:55], a[100:103], v[152:155]
    v_mfma_f32_16x16x32_bf16 v[156:159], v[52:55], a[116:119], v[156:159]
    s_waitcnt lgkmcnt(1)
    v_mfma_f32_16x16x32_bf16 v[128:131], v[56:59], a[8:11], v[128:131]
    v_mfma_f32_16x16x32_bf16 v[132:135], v[56:59], a[24:27], v[132:135]
    v_mfma_f32_16x16x32_bf16 v[136:139], v[56:59], a[40:43], v[136:139]
    v_mfma_f32_16x16x32_bf16 v[140:143], v[56:59], a[56:59], v[140:143]
    v_mfma_f32_16x16x32_bf16 v[144:147], v[56:59], a[72:75], v[144:147]
    v_mfma_f32_16x16x32_bf16 v[148:151], v[56:59], a[88:91], v[148:151]
    v_mfma_f32_16x16x32_bf16 v[152:155], v[56:59], a[104:107], v[152:155]
    v_mfma_f32_16x16x32_bf16 v[156:159], v[56:59], a[120:123], v[156:159]
    s_waitcnt lgkmcnt(0)
    v_mfma_f32_16x16x32_bf16 v[128:131], v[60:63], a[12:15], v[128:131]
    v_mfma_f32_16x16x32_bf16 v[132:135], v[60:63], a[28:31], v[132:135]
    v_mfma_f32_16x16x32_bf16 v[136:139], v[60:63], a[44:47], v[136:139]
    v_mfma_f32_16x16x32_bf16 v[140:143], v[60:63], a[60:63], v[140:143]
    v_mfma_f32_16x16x32_bf16 v[144:147], v[60:63], a[76:79], v[144:147]
    v_mfma_f32_16x16x32_bf16 v[148:151], v[60:63], a[92:95], v[148:151]
    v_mfma_f32_16x16x32_bf16 v[152:155], v[60:63], a[108:111], v[152:155]
    v_mfma_f32_16x16x32_bf16 v[156:159], v[60:63], a[124:127], v[156:159]
    s_nop 4
    v_cvt_pk_bf16_f32 v176, v128, v132
    v_cvt_pk_bf16_f32 v177, v136, v140
    v_cvt_pk_bf16_f32 v178, v144, v148
    v_cvt_pk_bf16_f32 v179, v152, v156
    s_add_u32 s46, s49, 524288
    buffer_store_dwordx4 v[176:179], v8, s[4:7], s46 offen sc1
    v_cvt_pk_bf16_f32 v180, v129, v133
    v_cvt_pk_bf16_f32 v181, v137, v141
    v_cvt_pk_bf16_f32 v182, v145, v149
    v_cvt_pk_bf16_f32 v183, v153, v157
    s_add_u32 s46, s49, 557056
    buffer_store_dwordx4 v[180:183], v8, s[4:7], s46 offen sc1
    v_cvt_pk_bf16_f32 v184, v130, v134
    v_cvt_pk_bf16_f32 v185, v138, v142
    v_cvt_pk_bf16_f32 v186, v146, v150
    v_cvt_pk_bf16_f32 v187, v154, v158
    s_add_u32 s46, s49, 589824
    buffer_store_dwordx4 v[184:187], v8, s[4:7], s46 offen sc1
    v_cvt_pk_bf16_f32 v188, v131, v135
    v_cvt_pk_bf16_f32 v189, v139, v143
    v_cvt_pk_bf16_f32 v190, v147, v151
    v_cvt_pk_bf16_f32 v191, v155, v159
    s_add_u32 s46, s49, 622592
    buffer_store_dwordx4 v[188:191], v8, s[4:7], s46 offen sc1
    s_cmp_eq_u32 s72, 0
    s_cbranch_scc1 L_pnopendX
    v_min_u32 v15, 108, v12
L_awpX:
    buffer_load_dword v14, v15, s[4:7], s50 offen offset:256 sc1
    s_waitcnt vmcnt(0)
    v_cmp_gt_i32 vcc, s74, v14
    s_cbranch_vccz L_awokpX
    s_sub_u32 s96, s96, 1
    s_cbranch_scc0 L_awpX
    s_branch L_abort
L_awokpX:
    s_add_u32 s46, s49, 1048576
    buffer_load_dwordx4 v[32:35], v9, s[4:7], s46 offen sc1
    s_add_u32 s46, s46, 4096
    buffer_load_dwordx4 v[36:39], v9, s[4:7], s46 offen sc1
    s_add_u32 s46, s46, 4096
    buffer_load_dwordx4 v[40:43], v9, s[4:7], s46 offen sc1
    s_add_u32 s46, s46, 4096
    buffer_load_dwordx4 v[44:47], v9, s[4:7], s46 offen sc1
    s_add_u32 s46, s46, 4096
    buffer_load_dwordx4 v[48:51], v9, s[4:7], s46 offen sc1
    s_add_u32 s46, s46, 4096
    buffer_load_dwordx4 v[52:55], v9, s[4:7], s46 offen sc1
    s_add_u32 s46, s46, 4096
    buffer_load_dwordx4 v[56:59], v9, s[4:7], s46 offen sc1
    s_waitcnt vmcnt(6)
    v_mfma_f32_16x16x32_bf16 v[64:67], v[16:19], v[32:35], 0
    s_waitcnt vmcnt(5)
    v_mfma_f32_16x16x32_bf16 v[64:67], v[16:19], v[36:39], v[64:67]
    s_waitcnt vmcnt(4)
    v_mfma_f32_16x16x32_bf16 v[64:67], v[16:19], v[40:43], v[64:67]
    s_waitcnt vmcnt(3)
    v_mfma_f32_16x16x32_bf16 v[64:67], v[16:19], v[44:47], v[64:67]
    s_waitcnt vmcnt(2)
    v_mfma_f32_16x16x32_bf16 v[64:67], v[16:19], v[48:51], v[64:67]
    s_waitcnt vmcnt(1)
    v_mfma_f32_16x16x32_bf16 v[64:67], v[16:19], v[52:55], v[64:67]
    s_waitcnt vmcnt(0)
    v_mfma_f32_16x16x32_bf16 v[64:67], v[16:19], v[56:59], v[64:67]
    s_nop 7
    v_add_f32 v64, v64, v28
    v_add_f32 v65, v65, v29
    v_add_f32 v66, v66, v30
    v_add_f32_e64 v67, v67, v31
    v_cvt_pk_bf16_f32 v64, v64, v65
    v_cvt_pk_bf16_f32 v65, v66, v67
    s_lshl_b32 s46, s73, 15
    s_mov_b32 exec_hi, 0
    buffer_store_dwordx2 v[64:65], v10, s[56:59], s46 offen sc1
    s_mov_b64 exec, -1
    s_mov_b32 s72, 0
L_pnopendX:
    s_waitcnt vmcnt(0)
    s_barrier
    s_cmp_lg_u32 s13, 0
    s_cbranch_scc1 L_sigaX
    v_mov_b32 v14, s45
    s_lshl_b32 s46, s14, 2
    v_mov_b32 v15, s46
    s_mov_b64 exec, 1
    buffer_store_dword v14, v15, s[4:7], s50 offen offset:0 sc1
    s_mov_b64 exec, -1
L_sigaX:
    v_min_u32 v15, 124, v12
L_awaX:
    buffer_load_dword v14, v15, s[4:7], s50 offen offset:0 sc1
    s_waitcnt vmcnt(0)
    v_cmp_gt_i32 vcc, s45, v14
    s_cbranch_vccz L_awokaX
    s_sub_u32 s96, s96, 1
    s_cbranch_scc0 L_awaX
    s_branch L_abort
L_awokaX:
    s_add_u32 s46, s49, 0
    buffer_load_dwordx4 v[32:35], v9, s[4:7], s46 offen sc1
    s_add_u32 s46, s46, 4096
    buffer_load_dwordx4 v[36:39], v9, s[4:7], s46 offen sc1
    s_add_u32 s46, s46, 4096
    buffer_load_dwordx4 v[40:43], v9, s[4:7], s46 offen sc1
    s_add_u32 s46, s46, 4096
    buffer_load_dwordx4 v[44:47], v9, s[4:7], s46 offen sc1
    s_add_u32 s46, s46, 4096
    buffer_load_dwordx4 v[48:51], v9, s[4:7], s46 offen sc1
    s_add_u32 s46, s46, 4096
    buffer_load_dwordx4 v[52:55], v9, s[4:7], s46 offen sc1
    s_add_u32 s46, s46, 4096
    buffer_load_dwordx4 v[56:59], v9, s[4:7], s46 offen sc1
    s_add_u32 s46, s46, 4096
    buffer_load_dwordx4 v[60:63], v9, s[4:7], s46 offen sc1
    s_waitcnt vmcnt(7)
    v_mfma_f32_16x16x32_bf16 v[64:67], v[16:19], v[32:35], 0
    s_waitcnt vmcnt(6)
    v_mfma_f32_16x16x32_bf16 v[64:67], v[16:19], v[36:39], v[64:67]
    s_waitcnt vmcnt(5)
    v_mfma_f32_16x16x32_bf16 v[64:67], v[16:19], v[40:43], v[64:67]
    s_waitcnt vmcnt(4)
    v_mfma_f32_16x16x32_bf16 v[64:67], v[16:19], v[44:47], v[64:67]
    s_waitcnt vmcnt(3)
    v_mfma_f32_16x16x32_bf16 v[64:67], v[16:19], v[48:51], v[64:67]
    s_waitcnt vmcnt(2)
    v_mfma_f32_16x16x32_bf16 v[64:67], v[16:19], v[52:55], v[64:67]
    s_waitcnt vmcnt(1)
    v_mfma_f32_16x16x32_bf16 v[64:67], v[16:19], v[56:59], v[64:67]
    s_waitcnt vmcnt(0)
    v_mfma_f32_16x16x32_bf16 v[64:67], v[16:19], v[60:63], v[64:67]
    s_nop 7
    v_lshlrev_b32 v68, 16, v80
    v_and_b32 v69, 0xffff0000, v80
    v_lshlrev_b32 v70, 16, v81
    v_and_b32 v71, 0xffff0000, v81
    v_add_f32 v28, v64, v68
    v_add_f32 v29, v65, v69
    v_add_f32 v30, v66, v70
    v_add_f32 v31, v67, v71
    v_readfirstlane_b32 s48, v28
    s_lshl_b32 s46, s13, 4
    v_mov_b32 v14, s46
    v_subrev_f32 v68, s48, v28
    v_subrev_f32 v69, s48, v29
    v_subrev_f32 v70, s48, v30
    v_subrev_f32 v71, s48, v31
    v_add_f32 v64, v68, v69
    v_mul_f32 v65, v68, v68
    v_add_f32 v66, v70, v71
    v_fmac_f32 v65, v69, v69
    v_fmac_f32 v65, v70, v70
    v_fmac_f32 v65, v71, v71
    v_add_f32 v64, v64, v66
    v_mov_b32 v66, s48
    v_add_f32_dpp v65, v65, v65 row_ror:8 row_mask:0xf bank_mask:0xf
    v_add_f32_dpp v64, v64, v64 row_ror:8 row_mask:0xf bank_mask:0xf
    s_nop 0
    v_add_f32_dpp v65, v65, v65 row_ror:4 row_mask:0xf bank_mask:0xf
    v_add_f32_dpp v64, v64, v64 row_ror:4 row_mask:0xf bank_mask:0xf
    s_nop 0
    v_add_f32_dpp v65, v65, v65 row_ror:2 row_mask:0xf bank_mask:0xf
    v_add_f32_dpp v64, v64, v64 row_ror:2 row_mask:0xf bank_mask:0xf
    s_nop 0
    v_add_f32_dpp v65, v65, v65 row_ror:1 row_mask:0xf bank_mask:0xf
    v_add_f32_dpp v64, v64, v64 row_ror:1 row_mask:0xf bank_mask:0xf
    s_nop 0
    v_mov_b32 v69, v65
    v_mov_b32 v68, v64
    s_nop 0
    v_permlane16_swap_b32 v65, v69
    v_permlane16_swap_b32 v64, v68
    v_add_f32 v65, v65, v69
    v_add_f32_e64 v64, v64, v68
    v_mul_f32 v67, 0x3c000000, v64
    v_fma_f32 v65, -v67, v64, v65
    v_add_f32_e64 v64, v66, v67
    v_lshrrev_b32 v14, 1, v14
    s_mov_b64 exec, 1
    ds_write_b64 v14, v[64:65] offset:41984
    s_cmp_eq_u32 s13, 0
    s_cselect_b64 exec, 15, 0
    ds_write_b32 v12, v0 offset:42048
    s_mov_b64 exec, -1
    v_mov_b32_e64 v14, 0
    v_min_u32 v15, 12, v12
    s_waitcnt lgkmcnt(0)
    s_barrier
    ds_read_b32 v0, v15 offset:42048
    ds_read_b128 v[72:75], v14 offset:41984
    ds_read_b128 v[76:79], v14 offset:42000
    s_waitcnt lgkmcnt(0)
    v_add_f32 v64, v72, v74
    v_add_f32 v65, v76, v78
    v_add_f32 v64, v64, v65
    v_mul_f32 v64, 0x3e800000, v64
    v_add_f32 v65, v73, v75
    v_add_f32 v66, v77, v79
    v_add_f32 v65, v65, v66
    v_sub_f32 v72, v72, v64
    v_sub_f32 v74, v74, v64
    v_sub_f32 v76, v76, v64
    v_sub_f32 v78, v78, v64
    v_mul_f32_e64 v66, v72, v72
    v_fmac_f32 v66, v74, v74
    v_fmac_f32 v66, v76, v76
    v_fmac_f32 v66, v78, v78
    v_fmac_f32 v65, 0x43000000, v66
    v_mov_b32 v66, 0x3727c5ac
    v_fmac_f32 v66, 0x3b000000, v65
    v_rsq_f32 v66, v66
    v_sub_f32 v68, v28, v64
    v_sub_f32 v69, v29, v64
    v_sub_f32 v70, v30, v64
    v_sub_f32 v71, v31, v64
    v_mul_f32 v68, v68, v66
    v_mul_f32 v69, v69, v66
    v_mul_f32 v70, v70, v66
    v_mul_f32_e64 v71, v71, v66
    v_cvt_pk_bf16_f32 v68, v68, v69
    v_cvt_pk_bf16_f32 v69, v70, v71
    s_add_u32 s46, s49, 2097152
    s_mov_b32 exec_hi, 0
    buffer_store_dwordx2 v[68:69], v11, s[4:7], s46 offen sc1
    s_mov_b64 exec, -1
    s_waitcnt vmcnt(0)
    s_barrier
    s_cmp_lg_u32 s13, 0
    s_cbranch_scc1 L_sigbX
    v_mov_b32 v14, s45
    s_lshl_b32 s46, s14, 2
    v_mov_b32 v15, s46
    s_mov_b64 exec, 1
    buffer_store_dword v14, v15, s[4:7], s50 offen offset:128 sc1
    s_mov_b64 exec, -1
L_sigbX:
    s_cmp_lt_u32 s14, 28
    s_cbranch_scc1 L_pffnX
    v_cmp_gt_i32 vcc, s65, v0
    s_lshl_b32 s47, s65, 18
    s_lshl_b32 s48, s14, 13
    s_add_u32 s47, s47, s48
    s_lshl_b32 s48, s13, 11
    s_add_u32 s47, s47, s48
    s_and_b32 s46, vcc_lo, 7
    s_cselect_b32 s47, 1073741824, s47
    s_cselect_b32 s71, 0, 1
    s_add_u32 m0, s48, 0
    s_add_u32 s46, s47, 0
    buffer_load_dwordx4 v1, s[4:7], s46 offen offset:0 sc1 lds
    buffer_load_dwordx4 v1, s[4:7], s46 offen offset:1024 sc1 lds
    s_add_u32 m0, s48, 8192
    s_add_u32 s46, s47, 16777216
    buffer_load_dwordx4 v1, s[4:7], s46 offen offset:0 sc1 lds
    buffer_load_dwordx4 v1, s[4:7], s46 offen offset:1024 sc1 lds
    s_add_u32 m0, s48, 16384
    s_add_u32 s46, s47, 33554432
    buffer_load_dwordx4 v1, s[4:7], s46 offen offset:0 sc1 lds
    buffer_load_dwordx4 v1, s[4:7], s46 offen offset:1024 sc1 lds
    s_add_u32 s47, s65, 1
    s_lshl_b32 s47, s47, 17
    s_add_u32 s47, s47, s70
    s_add_u32 s47, s47, 50331648
    s_cmp_ge_u32 s65, 56
    s_cselect_b32 s46, 8, 0
    s_or_b32 s46, s46, vcc_lo
    s_and_b32 s46, s46, 15
    s_cselect_b32 s47, 1073741824, s47
    s_cselect_b32 s71, s71, 3
    s_mov_b32 m0, s68
    s_nop 0
    buffer_load_dwordx4 v1, s[4:7], s47 offen sc1 lds
    v_min_u32 v15, 124, v12
L_awnX:
    buffer_load_dword v14, v15, s[4:7], s50 offen offset:128 sc1
    s_waitcnt vmcnt(0)
    v_cmp_gt_i32 vcc, s45, v14
    s_cbranch_vccz L_awoknX
    s_sub_u32 s96, s96, 1
    s_cbranch_scc0 L_awnX
    s_branch L_abort
L_awoknX:
    s_branch L_pnoffnX
L_pffnX:
    v_min_u32 v15, 124, v12
L_awbX:
    buffer_load_dword v14, v15, s[4:7], s50 offen offset:128 sc1
    s_waitcnt vmcnt(0)
    v_cmp_gt_i32 vcc, s45, v14
    s_cbranch_vccz L_awokbX
    s_sub_u32 s96, s96, 1
    s_cbranch_scc0 L_awbX
    s_branch L_abort
L_awokbX:
    s_lshl_b32 s48, s13, 10
    s_add_u32 s47, s49, s48
    s_add_u32 m0, s48, 43008
    s_add_u32 s46, s47, 2097152
    buffer_load_dwordx4 v1, s[4:7], s46 offen sc1 lds
    s_add_u32 m0, s48, 47104
    s_add_u32 s46, s47, 2101248
    buffer_load_dwordx4 v1, s[4:7], s46 offen sc1 lds
    s_add_u32 m0, s48, 51200
    s_add_u32 s46, s47, 2105344
    buffer_load_dwordx4 v1, s[4:7], s46 offen sc1 lds
    s_add_u32 m0, s48, 55296
    s_add_u32 s46, s47, 2109440
    buffer_load_dwordx4 v1, s[4:7], s46 offen sc1 lds
    s_add_u32 m0, s48, 59392
    s_add_u32 s46, s47, 2113536
    buffer_load_dwordx4 v1, s[4:7], s46 offen sc1 lds
    s_add_u32 m0, s48, 63488
    s_add_u32 s46, s47, 2117632
    buffer_load_dwordx4 v1, s[4:7], s46 offen sc1 lds
    s_add_u32 m0, s48, 67584
    s_add_u32 s46, s47, 2121728
    buffer_load_dwordx4 v1, s[4:7], s46 offen sc1 lds
    s_add_u32 m0, s48, 71680
    s_add_u32 s46, s47, 2125824
    buffer_load_dwordx4 v1, s[4:7], s46 offen sc1 lds
    v_add_u32 v14, 43008, v1
    s_waitcnt vmcnt(6)
    s_barrier
    ds_read_b128 v[48:51], v14 offset:0
    ds_read_b128 v[52:55], v14 offset:1024
    ds_read_b128 v[56:59], v14 offset:2048
    ds_read_b128 v[60:63], v14 offset:3072
    ds_read_b128 v[64:67], v14 offset:4096
    ds_read_b128 v[68:71], v14 offset:5120
    s_waitcnt lgkmcnt(5)
    v_mfma_f32_32x32x16_bf16 v[32:47], a[128:131], v[48:51], 0
    v_cmp_gt_i32 vcc, s65, v0
    s_lshl_b32 s47, s65, 18
    s_lshl_b32 s48, s14, 13
    s_add_u32 s47, s47, s48
    s_lshl_b32 s48, s13, 11
    s_add_u32 s47, s47, s48
    s_and_b32 s46, vcc_lo, 7
    s_cselect_b32 s47, 1073741824, s47
    s_cselect_b32 s71, 0, 1
    s_add_u32 m0, s48, 0
    s_add_u32 s46, s47, 0
    buffer_load_dwordx4 v1, s[4:7], s46 offen offset:0 sc1 lds
    buffer_load_dwordx4 v1, s[4:7], s46 offen offset:1024 sc1 lds
    s_add_u32 m0, s48, 8192
    s_add_u32 s46, s47, 16777216
    buffer_load_dwordx4 v1, s[4:7], s46 offen offset:0 sc1 lds
    buffer_load_dwordx4 v1, s[4:7], s46 offen offset:1024 sc1 lds
    s_add_u32 m0, s48, 16384
    s_add_u32 s46, s47, 33554432
    buffer_load_dwordx4 v1, s[4:7], s46 offen offset:0 sc1 lds
    buffer_load_dwordx4 v1, s[4:7], s46 offen offset:1024 sc1 lds
    s_add_u32 s47, s65, 1
    s_lshl_b32 s47, s47, 17
    s_add_u32 s47, s47, s70
    s_add_u32 s47, s47, 50331648
    s_cmp_ge_u32 s65, 56
    s_cselect_b32 s46, 8, 0
    s_or_b32 s46, s46, vcc_lo
    s_and_b32 s46, s46, 15
    s_cselect_b32 s47, 1073741824, s47
    s_cselect_b32 s71, s71, 3
    s_mov_b32 m0, s68
    s_nop 0
    buffer_load_dwordx4 v1, s[4:7], s47 offen sc1 lds
    ds_read_b128 v[72:75], v14 offset:6144
    s_waitcnt lgkmcnt(5)
    v_mfma_f32_32x32x16_bf16 v[32:47], a[132:135], v[52:55], v[32:47]
    ds_read_b128 v[76:79], v14 offset:7168
    s_waitcnt lgkmcnt(5)
    v_mfma_f32_32x32x16_bf16 v[32:47], a[136:139], v[56:59], v[32:47]
    s_waitcnt vmcnt(11)
    s_barrier
    ds_read_b128 v[48:51], v14 offset:8192
    s_waitcnt lgkmcnt(5)
    v_mfma_f32_32x32x16_bf16 v[32:47], a[140:143], v[60:63], v[32:47]
    ds_read_b128 v[52:55], v14 offset:9216
    s_waitcnt lgkmcnt(5)
    v_mfma_f32_32x32x16_bf16 v[32:47], a[144:147], v[64:67], v[32:47]
    ds_read_b128 v[56:59], v14 offset:10240
    s_waitcnt lgkmcnt(5)
    v_mfma_f32_32x32x16_bf16 v[32:47], a[148:151], v[68:71], v[32:47]
    ds_read_b128 v[60:63], v14 offset:11264
    s_waitcnt lgkmcnt(5)
    v_mfma_f32_32x32x16_bf16 v[32:47], a[152:155], v[72:75], v[32:47]
    ds_read_b128 v[64:67], v14 offset:12288
    s_waitcnt lgkmcnt(5)
    v_mfma_f32_32x32x16_bf16 v[32:47], a[156:159], v[76:79], v[32:47]
    ds_read_b128 v[68:71], v14 offset:13312
    s_waitcnt lgkmcnt(5)
    v_mfma_f32_32x32x16_bf16 v[32:47], a[160:163], v[48:51], v[32:47]
    ds_read_b128 v[72:75], v14 offset:14336
    s_waitcnt lgkmcnt(5)
    v_mfma_f32_32x32x16_bf16 v[32:47], a[164:167], v[52:55], v[32:47]
    ds_read_b128 v[76:79], v14 offset:15360
    s_waitcnt lgkmcnt(5)
    v_mfma_f32_32x32x16_bf16 v[32:47], a[168:171], v[56:59], v[32:47]
    s_waitcnt vmcnt(9)
    s_barrier
    ds_read_b128 v[48:51], v14 offset:16384
    s_waitcnt lgkmcnt(5)
    v_mfma_f32_32x32x16_bf16 v[32:47], a[172:175], v[60:63], v[32:47]
    ds_read_b128 v[52:55], v14 offset:17408
    s_waitcnt lgkmcnt(5)
    v_mfma_f32_32x32x16_bf16 v[32:47], a[176:179], v[64:67], v[32:47]
    ds_read_b128 v[56:59], v14 offset:18432
    s_waitcnt lgkmcnt(5)
    v_mfma_f32_32x32x16_bf16 v[32:47], a[180:183], v[68:71], v[32:47]
    ds_read_b128 v[60:63], v14 offset:19456
    s_waitcnt lgkmcnt(5)
    v_mfma_f32_32x32x16_bf16 v[32:47], a[184:187], v[72:75], v[32:47]
    ds_read_b128 v[64:67], v14 offset:20480
    s_waitcnt lgkmcnt(5)
    v_mfma_f32_32x32x16_bf16 v[32:47], a[188:191], v[76:79], v[32:47]
    ds_read_b128 v[68:71], v14 offset:21504
    s_waitcnt lgkmcnt(5)
    v_mfma_f32_32x32x16_bf16 v[32:47], a[192:195], v[48:51], v[32:47]
    ds_read_b128 v[72:75], v14 offset:22528
    s_waitcnt lgkmcnt(5)
    v_mfma_f32_32x32x16_bf16 v[32:47], a[196:199], v[52:55], v[32:47]
    ds_read_b128 v[76:79], v14 offset:23552
    s_waitcnt lgkmcnt(5)
    v_mfma_f32_32x32x16_bf16 v[32:47], a[200:203], v[56:59], v[32:47]
    s_waitcnt vmcnt(7)
    s_barrier
    ds_read_b128 v[48:51], v14 offset:24576
    s_waitcnt lgkmcnt(5)
    v_mfma_f32_32x32x16_bf16 v[32:47], a[204:207], v[60:63], v[32:47]
    ds_read_b128 v[52:55], v14 offset:25600
    s_waitcnt lgkmcnt(5)
    v_mfma_f32_32x32x16_bf16 v[32:47], a[208:211], v[64:67], v[32:47]
    ds_read_b128 v[56:59], v14 offset:26624
    s_waitcnt lgkmcnt(5)
    v_mfma_f32_32x32x16_bf16 v[32:47], a[212:215], v[68:71], v[32:47]
    ds_read_b128 v[60:63], v14 offset:27648
    s_waitcnt lgkmcnt(5)
    v_mfma_f32_32x32x16_bf16 v[32:47], a[216:219], v[72:75], v[32:47]
    ds_read_b128 v[64:67], v14 offset:28672
    s_waitcnt lgkmcnt(5)
    v_mfma_f32_32x32x16_bf16 v[32:47], a[220:223], v[76:79], v[32:47]
    ds_read_b128 v[68:71], v14 offset:29696
    s_waitcnt lgkmcnt(5)
    v_mfma_f32_32x32x16_bf16 v[32:47], a[224:227], v[48:51], v[32:47]
    ds_read_b128 v[72:75], v14 offset:30720
    s_waitcnt lgkmcnt(5)
    v_mfma_f32_32x32x16_bf16 v[32:47], a[228:231], v[52:55], v[32:47]
    ds_read_b128 v[76:79], v14 offset:31744
    s_waitcnt lgkmcnt(5)
    v_mfma_f32_32x32x16_bf16 v[32:47], a[232:235], v[56:59], v[32:47]
    s_waitcnt lgkmcnt(4)
    v_mfma_f32_32x32x16_bf16 v[32:47], a[236:239], v[60:63], v[32:47]
    s_waitcnt lgkmcnt(3)
    v_mfma_f32_32x32x16_bf16 v[32:47], a[240:243], v[64:67], v[32:47]
    s_waitcnt lgkmcnt(2)
    v_mfma_f32_32x32x16_bf16 v[32:47], a[244:247], v[68:71], v[32:47]
    s_waitcnt lgkmcnt(1)
    v_mfma_f32_32x32x16_bf16 v[32:47], a[248:251], v[72:75], v[32:47]
    s_waitcnt lgkmcnt(0)
    v_mfma_f32_32x32x16_bf16 v[32:47], a[252:255], v[76:79], v[32:47]
    v_mov_b32 v88, s54
    v_mov_b32_e64 v90, s55
    s_lshl_b32 s46, s13, 10
    v_add_u32 v15, s46, v1
    s_nop 8
    v_pk_mul_f32 v[80:81], v[32:33], v[32:33]
    v_pk_mul_f32 v[82:83], v[34:35], v[34:35]
    v_pk_mul_f32 v[84:85], v[36:37], v[36:37]
    v_pk_mul_f32 v[86:87], v[38:39], v[38:39]
    v_pk_fma_f32 v[80:81], v[80:81], v[90:91], v[88:89] op_sel_hi:[1,0,0]
    v_pk_fma_f32 v[82:83], v[82:83], v[90:91], v[88:89] op_sel_hi:[1,0,0]
    v_pk_fma_f32 v[84:85], v[84:85], v[90:91], v[88:89] op_sel_hi:[1,0,0]
    v_pk_fma_f32 v[86:87], v[86:87], v[90:91], v[88:89] op_sel_hi:[1,0,0]
    v_pk_mul_f32 v[80:81], v[80:81], v[32:33]
    v_pk_mul_f32 v[82:83], v[82:83], v[34:35]
    v_pk_mul_f32 v[84:85], v[84:85], v[36:37]
    v_pk_mul_f32 v[86:87], v[86:87], v[38:39]
    v_exp_f32 v80, v80
    v_exp_f32 v81, v81
    v_exp_f32 v82, v82
    v_exp_f32 v83, v83
    v_exp_f32 v84, v84
    v_exp_f32 v85, v85
    v_exp_f32 v86, v86
    v_exp_f32 v87, v87
    v_pk_mul_f32 v[32:33], v[32:33], v[40:41]
    v_pk_mul_f32 v[34:35], v[34:35], v[42:43]
    v_pk_mul_f32 v[36:37], v[36:37], v[44:45]
    v_pk_mul_f32 v[38:39], v[38:39], v[46:47]
    v_pk_add_f32 v[80:81], v[80:81], 1.0 op_sel_hi:[1,0]
    v_pk_add_f32 v[82:83], v[82:83], 1.0 op_sel_hi:[1,0]
    v_pk_add_f32 v[84:85], v[84:85], 1.0 op_sel_hi:[1,0]
    v_pk_add_f32 v[86:87], v[86:87], 1.0 op_sel_hi:[1,0]
    v_rcp_f32 v80, v80
    v_rcp_f32 v81, v81
    v_rcp_f32 v82, v82
    v_rcp_f32 v83, v83
    v_rcp_f32 v84, v84
    v_rcp_f32 v85, v85
    v_rcp_f32 v86, v86
    v_rcp_f32_e64 v87, v87
    s_nop 0
    v_pk_mul_f32 v[32:33], v[32:33], v[80:81]
    v_pk_mul_f32 v[34:35], v[34:35], v[82:83]
    v_pk_mul_f32 v[36:37], v[36:37], v[84:85]
    v_pk_mul_f32 v[38:39], v[38:39], v[86:87]
    v_cvt_pk_bf16_f32 v80, v32, v33
    v_cvt_pk_bf16_f32 v81, v34, v35
    v_cvt_pk_bf16_f32 v82, v36, v37
    v_cvt_pk_bf16_f32 v83, v38, v39
    ds_write_b128 v15, v[80:83] offset:37888
    s_waitcnt lgkmcnt(0)
    s_barrier
    ds_read_b128 v[32:35], v2 offset:37888
    ds_read_b128 v[36:39], v2 offset:39936
    ds_read_b128 v[40:43], v2 offset:38144
    ds_read_b128 v[44:47], v2 offset:40192
    s_waitcnt lgkmcnt(3)
    v_mfma_f32_16x16x32_bf16 v[96:99], v[32:35], v[192:195], 0
    v_mfma_f32_16x16x32_bf16 v[100:103], v[32:35], v[200:203], 0
    v_mfma_f32_16x16x32_bf16 v[104:107], v[32:35], v[208:211], 0
    v_mfma_f32_16x16x32_bf16 v[108:111], v[32:35], v[216:219], 0
    v_mfma_f32_16x16x32_bf16 v[112:115], v[32:35], v[224:227], 0
    v_mfma_f32_16x16x32_bf16 v[116:119], v[32:35], v[232:235], 0
    v_mfma_f32_16x16x32_bf16 v[120:123], v[32:35], v[240:243], 0
    v_mfma_f32_16x16x32_bf16 v[124:127], v[32:35], v[248:251], 0
    s_waitcnt lgkmcnt(2)
    v_mfma_f32_16x16x32_bf16 v[96:99], v[36:39], v[196:199], v[96:99]
    v_mfma_f32_16x16x32_bf16 v[100:103], v[36:39], v[204:207], v[100:103]
    v_mfma_f32_16x16x32_bf16 v[104:107], v[36:39], v[212:215], v[104:107]
    v_mfma_f32_16x16x32_bf16 v[108:111], v[36:39], v[220:223], v[108:111]
    v_mfma_f32_16x16x32_bf16 v[112:115], v[36:39], v[228:231], v[112:115]
    v_mfma_f32_16x16x32_bf16 v[116:119], v[36:39], v[236:239], v[116:119]
    v_mfma_f32_16x16x32_bf16 v[120:123], v[36:39], v[244:247], v[120:123]
    v_mfma_f32_16x16x32_bf16 v[124:127], v[36:39], v[252:255], v[124:127]
    s_waitcnt lgkmcnt(1)
    v_mfma_f32_16x16x32_bf16 v[128:131], v[40:43], v[192:195], 0
    v_mfma_f32_16x16x32_bf16 v[132:135], v[40:43], v[200:203], 0
    v_cvt_pk_bf16_f32 v160, v96, v100
    v_cvt_pk_bf16_f32 v161, v104, v108
    v_mfma_f32_16x16x32_bf16 v[136:139], v[40:43], v[208:211], 0
    v_cvt_pk_bf16_f32 v162, v112, v116
    v_cvt_pk_bf16_f32 v163, v120, v124
    v_mfma_f32_16x16x32_bf16 v[140:143], v[40:43], v[216:219], 0
    s_add_u32 s46, s49, 1048576
    buffer_store_dwordx4 v[160:163], v8, s[4:7], s46 offen sc1
    v_mfma_f32_16x16x32_bf16 v[144:147], v[40:43], v[224:227], 0
    v_cvt_pk_bf16_f32 v164, v97, v101
    v_cvt_pk_bf16_f32 v165, v105, v109
    v_mfma_f32_16x16x32_bf16 v[148:151], v[40:43], v[232:235], 0
    v_cvt_pk_bf16_f32 v166, v113, v117
    v_cvt_pk_bf16_f32 v167, v121, v125
    v_mfma_f32_16x16x32_bf16 v[152:155], v[40:43], v[240:243], 0
    s_add_u32 s46, s49, 1081344
    buffer_store_dwordx4 v[164:167], v8, s[4:7], s46 offen sc1
    v_mfma_f32_16x16x32_bf16 v[156:159], v[40:43], v[248:251], 0
    v_cvt_pk_bf16_f32 v168, v98, v102
    v_cvt_pk_bf16_f32 v169, v106, v110
    s_waitcnt lgkmcnt(0)
    v_mfma_f32_16x16x32_bf16 v[128:131], v[44:47], v[196:199], v[128:131]
    v_cvt_pk_bf16_f32 v170, v114, v118
    v_cvt_pk_bf16_f32 v171, v122, v126
    v_mfma_f32_16x16x32_bf16 v[132:135], v[44:47], v[204:207], v[132:135]
    s_add_u32 s46, s49, 1114112
    buffer_store_dwordx4 v[168:171], v8, s[4:7], s46 offen sc1
    v_mfma_f32_16x16x32_bf16 v[136:139], v[44:47], v[212:215], v[136:139]
    v_cvt_pk_bf16_f32 v172, v99, v103
    v_cvt_pk_bf16_f32 v173, v107, v111
    v_mfma_f32_16x16x32_bf16 v[140:143], v[44:47], v[220:223], v[140:143]
    v_cvt_pk_bf16_f32 v174, v115, v119
    v_cvt_pk_bf16_f32 v175, v123, v127
    v_mfma_f32_16x16x32_bf16 v[144:147], v[44:47], v[228:231], v[144:147]
    s_add_u32 s46, s49, 1146880
    buffer_store_dwordx4 v[172:175], v8, s[4:7], s46 offen sc1
    v_mfma_f32_16x16x32_bf16 v[148:151], v[44:47], v[236:239], v[148:151]
    v_mfma_f32_16x16x32_bf16 v[152:155], v[44:47], v[244:247], v[152:155]
    v_mfma_f32_16x16x32_bf16 v[156:159], v[44:47], v[252:255], v[156:159]
    s_nop 4
    v_cvt_pk_bf16_f32 v176, v128, v132
    v_cvt_pk_bf16_f32 v177, v136, v140
    v_cvt_pk_bf16_f32 v178, v144, v148
    v_cvt_pk_bf16_f32 v179, v152, v156
    s_add_u32 s46, s49, 1572864
    buffer_store_dwordx4 v[176:179], v8, s[4:7], s46 offen sc1
    v_cvt_pk_bf16_f32 v180, v129, v133
    v_cvt_pk_bf16_f32 v181, v137, v141
    v_cvt_pk_bf16_f32 v182, v145, v149
    v_cvt_pk_bf16_f32 v183, v153, v157
    s_add_u32 s46, s49, 1605632
    buffer_store_dwordx4 v[180:183], v8, s[4:7], s46 offen sc1
    v_cvt_pk_bf16_f32 v184, v130, v134
    v_cvt_pk_bf16_f32 v185, v138, v142
    v_cvt_pk_bf16_f32 v186, v146, v150
    v_cvt_pk_bf16_f32 v187, v154, v158
    s_add_u32 s46, s49, 1638400
    buffer_store_dwordx4 v[184:187], v8, s[4:7], s46 offen sc1
    v_cvt_pk_bf16_f32 v188, v131, v135
    v_cvt_pk_bf16_f32 v189, v139, v143
    v_cvt_pk_bf16_f32 v190, v147, v151
    v_cvt_pk_bf16_f32 v191, v155, v159
    s_add_u32 s46, s49, 1671168
    buffer_store_dwordx4 v[188:191], v8, s[4:7], s46 offen sc1
    s_waitcnt vmcnt(0)
    s_barrier
    s_cmp_lg_u32 s13, 0
    s_cbranch_scc1 L_sigcX
    v_mov_b32 v14, s45
    s_lshl_b32 s46, s14, 2
    v_mov_b32_e64 v15, s46
    s_mov_b64 exec, 1
    buffer_store_dword v14, v15, s[4:7], s50 offen offset:256 sc1
    s_mov_b64 exec, -1
L_sigcX:
L_pnoffnX:
    s_mov_b32 s73, s44
    s_mov_b32 s74, s45
    s_mov_b32 s44, s65
    s_add_u32 s45, s45, 1
    s_cmp_eq_u32 s71, 3
    s_cselect_b32 s72, 1, 0
    s_cbranch_scc1 L_ploopX
    v_min_u32 v15, 108, v12
L_awcX:
    buffer_load_dword v14, v15, s[4:7], s50 offen offset:256 sc1
    s_waitcnt vmcnt(0)
    v_cmp_gt_i32 vcc, s74, v14
    s_cbranch_vccz L_awokcX
    s_sub_u32 s96, s96, 1
    s_cbranch_scc0 L_awcX
    s_branch L_abort
L_awokcX:
    s_add_u32 s46, s49, 1048576
    buffer_load_dwordx4 v[32:35], v9, s[4:7], s46 offen sc1
    s_add_u32 s46, s46, 4096
    buffer_load_dwordx4 v[36:39], v9, s[4:7], s46 offen sc1
    s_add_u32 s46, s46, 4096
    buffer_load_dwordx4 v[40:43], v9, s[4:7], s46 offen sc1
    s_add_u32 s46, s46, 4096
    buffer_load_dwordx4 v[44:47], v9, s[4:7], s46 offen sc1
    s_add_u32 s46, s46, 4096
    buffer_load_dwordx4 v[48:51], v9, s[4:7], s46 offen sc1
    s_add_u32 s46, s46, 4096
    buffer_load_dwordx4 v[52:55], v9, s[4:7], s46 offen sc1
    s_add_u32 s46, s46, 4096
    buffer_load_dwordx4 v[56:59], v9, s[4:7], s46 offen sc1
    s_waitcnt vmcnt(6)
    v_mfma_f32_16x16x32_bf16 v[64:67], v[16:19], v[32:35], 0
    s_waitcnt vmcnt(5)
    v_mfma_f32_16x16x32_bf16 v[64:67], v[16:19], v[36:39], v[64:67]
    s_waitcnt vmcnt(4)
    v_mfma_f32_16x16x32_bf16 v[64:67], v[16:19], v[40:43], v[64:67]
    s_waitcnt vmcnt(3)
    v_mfma_f32_16x16x32_bf16 v[64:67], v[16:19], v[44:47], v[64:67]
    s_waitcnt vmcnt(2)
    v_mfma_f32_16x16x32_bf16 v[64:67], v[16:19], v[48:51], v[64:67]
    s_waitcnt vmcnt(1)
    v_mfma_f32_16x16x32_bf16 v[64:67], v[16:19], v[52:55], v[64:67]
    s_waitcnt vmcnt(0)
    v_mfma_f32_16x16x32_bf16 v[64:67], v[16:19], v[56:59], v[64:67]
    s_nop 7
    v_add_f32 v64, v64, v28
    v_add_f32 v65, v65, v29
    v_add_f32 v66, v66, v30
    v_add_f32 v67, v67, v31
    v_cvt_pk_bf16_f32 v64, v64, v65
    v_cvt_pk_bf16_f32 v65, v66, v67
    s_lshl_b32 s46, s73, 15
    s_mov_b32 exec_hi, 0
    buffer_store_dwordx2 v[64:65], v10, s[56:59], s46 offen sc1
    s_mov_b64 exec, -1
    s_cmp_lt_u32 s44, 64
    s_cbranch_scc1 L_ploopX
    s_waitcnt vmcnt(0)
    s_endpgm
L_chain:
    v_and_b32_e64 v90, 63, v0
    s_lshl_b32 s58, s13, 15
    s_add_u32 s58, s58, 32768
    v_bfe_u32 v17, v90, 4, 1
    v_bfe_u32 v18, v90, 2, 1
    v_lshl_add_u32 v17, v17, 1, v18
    v_lshlrev_b32 v17, 4, v17
    v_bfe_u32 v18, v90, 3, 1
    v_lshl_add_u32 v17, v18, 1, v17
    v_bfe_u32 v18, v90, 5, 1
    v_add_u32 v17, v17, v18
    v_lshlrev_b32 v17, 13, v17
    v_and_b32 v18, 3, v90
    v_lshl_add_u32 v17, v18, 4, v17
    s_lshl_b32 s51, s14, 8
    s_lshl_b32 s52, s13, 6
    s_add_u32 s51, s51, s52
    v_add_u32 v80, s51, v17
    v_add_u32 v81, 31744, v80
    v_add_u32 v82, 63488, v80
    v_add_u32 v83, 95232, v80
    s_mov_b32 s8, s20
    s_and_b32 s9, s21, 0xffff
    s_mov_b32 s10, 4194304
    s_mov_b32 s11, 0x20000
    s_add_u32 m0, s58, 0
    s_mov_b32 s51, 0
    buffer_load_dwordx4 v80, s[8:11], s51 offen offset:0  lds
    buffer_load_dwordx4 v81, s[8:11], s51 offen offset:1024  lds
    buffer_load_dwordx4 v82, s[8:11], s51 offen offset:2048  lds
    buffer_load_dwordx4 v83, s[8:11], s51 offen offset:3072  lds
    s_add_u32 m0, s58, 4096
    s_mov_b32 s51, 1048576
    buffer_load_dwordx4 v80, s[8:11], s51 offen offset:0  lds
    buffer_load_dwordx4 v81, s[8:11], s51 offen offset:1024  lds
    buffer_load_dwordx4 v82, s[8:11], s51 offen offset:2048  lds
    buffer_load_dwordx4 v83, s[8:11], s51 offen offset:3072  lds
    s_add_u32 m0, s58, 8192
    s_mov_b32 s51, 2097152
    buffer_load_dwordx4 v80, s[8:11], s51 offen offset:0  lds
    buffer_load_dwordx4 v81, s[8:11], s51 offen offset:1024  lds
    buffer_load_dwordx4 v82, s[8:11], s51 offen offset:2048  lds
    buffer_load_dwordx4 v83, s[8:11], s51 offen offset:3072  lds
    s_add_u32 m0, s58, 12288
    s_mov_b32 s51, 3145728
    buffer_load_dwordx4 v80, s[8:11], s51 offen offset:0  lds
    buffer_load_dwordx4 v81, s[8:11], s51 offen offset:1024  lds
    buffer_load_dwordx4 v82, s[8:11], s51 offen offset:2048  lds
    buffer_load_dwordx4 v83, s[8:11], s51 offen offset:3072  lds
    s_add_u32 m0, s58, 16384
    s_mov_b32 s51, 524288
    buffer_load_dwordx4 v80, s[8:11], s51 offen offset:0  lds
    buffer_load_dwordx4 v81, s[8:11], s51 offen offset:1024  lds
    buffer_load_dwordx4 v82, s[8:11], s51 offen offset:2048  lds
    buffer_load_dwordx4 v83, s[8:11], s51 offen offset:3072  lds
    s_add_u32 m0, s58, 20480
    s_mov_b32 s51, 1572864
    buffer_load_dwordx4 v80, s[8:11], s51 offen offset:0  lds
    buffer_load_dwordx4 v81, s[8:11], s51 offen offset:1024  lds
    buffer_load_dwordx4 v82, s[8:11], s51 offen offset:2048  lds
    buffer_load_dwordx4 v83, s[8:11], s51 offen offset:3072  lds
    s_add_u32 m0, s58, 24576
    s_mov_b32 s51, 2621440
    buffer_load_dwordx4 v80, s[8:11], s51 offen offset:0  lds
    buffer_load_dwordx4 v81, s[8:11], s51 offen offset:1024  lds
    buffer_load_dwordx4 v82, s[8:11], s51 offen offset:2048  lds
    buffer_load_dwordx4 v83, s[8:11], s51 offen offset:3072  lds
    s_add_u32 m0, s58, 28672
    s_mov_b32 s51, 3670016
    buffer_load_dwordx4 v80, s[8:11], s51 offen offset:0  lds
    buffer_load_dwordx4 v81, s[8:11], s51 offen offset:1024  lds
    buffer_load_dwordx4 v82, s[8:11], s51 offen offset:2048  lds
    buffer_load_dwordx4 v83, s[8:11], s51 offen offset:3072  lds
    v_bfe_u32 v17, v90, 4, 1
    v_bfe_u32 v18, v90, 5, 1
    v_lshl_add_u32 v17, v17, 1, v18
    v_bfe_u32 v18, v90, 3, 1
    v_lshl_add_u32 v17, v17, 1, v18
    v_lshlrev_b32 v17, 10, v17
    v_and_b32_e64 v18, 7, v90
    v_lshl_add_u32 v17, v18, 4, v17
    s_lshl_b32 s51, s14, 17
    s_lshl_b32 s52, s13, 8
    s_add_u32 s51, s51, s52
    v_add_u32 v84, s51, v17
    v_add_u32 v85, 15360, v84
    v_add_u32 v86, 6144, v84
    v_add_u32 v87, 21504, v84
    v_lshrrev_b32 v17, 4, v90
    v_bfe_u32 v18, v90, 2, 2
    v_lshl_add_u32 v17, v17, 3, v18
    v_and_b32_e64 v18, 3, v90
    v_lshlrev_b32 v18, 3, v18
    v_lshl_add_u32 v88, v17, 6, v18
    v_lshl_add_u32 v89, v17, 7, v18
    v_add_u32 v88, s58, v88
    v_add_u32 v89, s58, v89
    s_mov_b32 s8, s18
    s_and_b32 s9, s19, 0xffff
    s_mov_b32 s10, 8192
    s_mov_b32 s11, 0x20000
    v_bfe_u32 v17, v90, 1, 3
    v_lshlrev_b32 v17, 10, v17
    v_lshrrev_b32 v18, 4, v90
    v_lshl_add_u32 v17, v18, 3, v17
    v_and_b32 v18, 1, v90
    v_lshl_add_u32 v17, v18, 2, v17
    buffer_load_dword v64, v17, s[8:11], s52 offen offset:0
    buffer_load_dword v65, v17, s[8:11], s52 offen offset:32
    buffer_load_dword v66, v17, s[8:11], s52 offen offset:64
    buffer_load_dword v67, v17, s[8:11], s52 offen offset:96
    buffer_load_dword v68, v17, s[8:11], s52 offen offset:128
    buffer_load_dword v69, v17, s[8:11], s52 offen offset:160
    buffer_load_dword v70, v17, s[8:11], s52 offen offset:192
    buffer_load_dword v71, v17, s[8:11], s52 offen offset:224
    s_cmp_eq_u32 s13, 1
    s_cbranch_scc1 L_csetup1
    s_cmp_eq_u32 s13, 2
    s_cbranch_scc1 L_csetup2
    s_cmp_eq_u32 s13, 3
    s_cbranch_scc1 L_csetup3
    s_branch L_csetup0
L_cload:
    s_waitcnt vmcnt(36)
    ds_read_b64_tr_b16 a[0:1], v88 offset:0
    ds_read_b64_tr_b16 a[2:3], v88 offset:256
    ds_read_b64_tr_b16 a[4:5], v88 offset:2048
    ds_read_b64_tr_b16 a[6:7], v88 offset:2304
    ds_read_b64_tr_b16 a[8:9], v88 offset:32
    ds_read_b64_tr_b16 a[10:11], v88 offset:288
    ds_read_b64_tr_b16 a[12:13], v88 offset:2080
    ds_read_b64_tr_b16 a[14:15], v88 offset:2336
    s_waitcnt lgkmcnt(0)
    s_mov_b32 s8, s22
    s_and_b32 s9, s23, 0xffff
    s_mov_b32 s10, 4194304
    s_mov_b32 s11, 0x20000
    s_add_u32 m0, s58, 0
    s_mov_b32 s51, 0
    buffer_load_dwordx4 v80, s[8:11], s51 offen offset:0  lds
    buffer_load_dwordx4 v81, s[8:11], s51 offen offset:1024  lds
    buffer_load_dwordx4 v82, s[8:11], s51 offen offset:2048  lds
    buffer_load_dwordx4 v83, s[8:11], s51 offen offset:3072  lds
    s_waitcnt vmcnt(36)
    ds_read_b64_tr_b16 a[16:17], v88 offset:4096
    ds_read_b64_tr_b16 a[18:19], v88 offset:4352
    ds_read_b64_tr_b16 a[20:21], v88 offset:6144
    ds_read_b64_tr_b16 a[22:23], v88 offset:6400
    ds_read_b64_tr_b16 a[24:25], v88 offset:4128
    ds_read_b64_tr_b16 a[26:27], v88 offset:4384
    ds_read_b64_tr_b16 a[28:29], v88 offset:6176
    ds_read_b64_tr_b16 a[30:31], v88 offset:6432
    s_waitcnt lgkmcnt(0)
    s_add_u32 m0, s58, 4096
    s_mov_b32 s51, 1048576
    buffer_load_dwordx4 v80, s[8:11], s51 offen offset:0  lds
    buffer_load_dwordx4 v81, s[8:11], s51 offen offset:1024  lds
    buffer_load_dwordx4 v82, s[8:11], s51 offen offset:2048  lds
    buffer_load_dwordx4 v83, s[8:11], s51 offen offset:3072  lds
    s_waitcnt vmcnt(36)
    ds_read_b64_tr_b16 a[32:33], v88 offset:8192
    ds_read_b64_tr_b16 a[34:35], v88 offset:8448
    ds_read_b64_tr_b16 a[36:37], v88 offset:10240
    ds_read_b64_tr_b16 a[38:39], v88 offset:10496
    ds_read_b64_tr_b16 a[40:41], v88 offset:8224
    ds_read_b64_tr_b16 a[42:43], v88 offset:8480
    ds_read_b64_tr_b16 a[44:45], v88 offset:10272
    ds_read_b64_tr_b16 a[46:47], v88 offset:10528
    s_waitcnt lgkmcnt(0)
    s_add_u32 m0, s58, 8192
    s_mov_b32 s51, 2097152
    buffer_load_dwordx4 v80, s[8:11], s51 offen offset:0  lds
    buffer_load_dwordx4 v81, s[8:11], s51 offen offset:1024  lds
    buffer_load_dwordx4 v82, s[8:11], s51 offen offset:2048  lds
    buffer_load_dwordx4 v83, s[8:11], s51 offen offset:3072  lds
    s_waitcnt vmcnt(36)
    ds_read_b64_tr_b16 a[48:49], v88 offset:12288
    ds_read_b64_tr_b16 a[50:51], v88 offset:12544
    ds_read_b64_tr_b16 a[52:53], v88 offset:14336
    ds_read_b64_tr_b16 a[54:55], v88 offset:14592
    ds_read_b64_tr_b16 a[56:57], v88 offset:12320
    ds_read_b64_tr_b16 a[58:59], v88 offset:12576
    ds_read_b64_tr_b16 a[60:61], v88 offset:14368
    ds_read_b64_tr_b16 a[62:63], v88 offset:14624
    s_waitcnt lgkmcnt(0)
    s_add_u32 m0, s58, 12288
    s_mov_b32 s51, 3145728
    buffer_load_dwordx4 v80, s[8:11], s51 offen offset:0  lds
    buffer_load_dwordx4 v81, s[8:11], s51 offen offset:1024  lds
    buffer_load_dwordx4 v82, s[8:11], s51 offen offset:2048  lds
    buffer_load_dwordx4 v83, s[8:11], s51 offen offset:3072  lds
    s_waitcnt vmcnt(36)
    ds_read_b64_tr_b16 a[64:65], v88 offset:16384
    ds_read_b64_tr_b16 a[66:67], v88 offset:16640
    ds_read_b64_tr_b16 a[68:69], v88 offset:18432
    ds_read_b64_tr_b16 a[70:71], v88 offset:18688
    ds_read_b64_tr_b16 a[72:73], v88 offset:16416
    ds_read_b64_tr_b16 a[74:75], v88 offset:16672
    ds_read_b64_tr_b16 a[76:77], v88 offset:18464
    ds_read_b64_tr_b16 a[78:79], v88 offset:18720
    s_waitcnt lgkmcnt(0)
    s_add_u32 m0, s58, 16384
    s_mov_b32 s51, 524288
    buffer_load_dwordx4 v80, s[8:11], s51 offen offset:0  lds
    buffer_load_dwordx4 v81, s[8:11], s51 offen offset:1024  lds
    buffer_load_dwordx4 v82, s[8:11], s51 offen offset:2048  lds
    buffer_load_dwordx4 v83, s[8:11], s51 offen offset:3072  lds
    s_waitcnt vmcnt(36)
    ds_read_b64_tr_b16 a[80:81], v88 offset:20480
    ds_read_b64_tr_b16 a[82:83], v88 offset:20736
    ds_read_b64_tr_b16 a[84:85], v88 offset:22528
    ds_read_b64_tr_b16 a[86:87], v88 offset:22784
    ds_read_b64_tr_b16 a[88:89], v88 offset:20512
    ds_read_b64_tr_b16 a[90:91], v88 offset:20768
    ds_read_b64_tr_b16 a[92:93], v88 offset:22560
    ds_read_b64_tr_b16 a[94:95], v88 offset:22816
    s_waitcnt lgkmcnt(0)
    s_add_u32 m0, s58, 20480
    s_mov_b32 s51, 1572864
    buffer_load_dwordx4 v80, s[8:11], s51 offen offset:0  lds
    buffer_load_dwordx4 v81, s[8:11], s51 offen offset:1024  lds
    buffer_load_dwordx4 v82, s[8:11], s51 offen offset:2048  lds
    buffer_load_dwordx4 v83, s[8:11], s51 offen offset:3072  lds
    s_waitcnt vmcnt(36)
    ds_read_b64_tr_b16 a[96:97], v88 offset:24576
    ds_read_b64_tr_b16 a[98:99], v88 offset:24832
    ds_read_b64_tr_b16 a[100:101], v88 offset:26624
    ds_read_b64_tr_b16 a[102:103], v88 offset:26880
    ds_read_b64_tr_b16 a[104:105], v88 offset:24608
    ds_read_b64_tr_b16 a[106:107], v88 offset:24864
    ds_read_b64_tr_b16 a[108:109], v88 offset:26656
    ds_read_b64_tr_b16 a[110:111], v88 offset:26912
    s_waitcnt lgkmcnt(0)
    s_add_u32 m0, s58, 24576
    s_mov_b32 s51, 2621440
    buffer_load_dwordx4 v80, s[8:11], s51 offen offset:0  lds
    buffer_load_dwordx4 v81, s[8:11], s51 offen offset:1024  lds
    buffer_load_dwordx4 v82, s[8:11], s51 offen offset:2048  lds
    buffer_load_dwordx4 v83, s[8:11], s51 offen offset:3072  lds
    v_mov_b32_e64 v91, 64
    global_load_dword v91, v91, s[40:41] sc1
    s_waitcnt vmcnt(37)
    ds_read_b64_tr_b16 a[112:113], v88 offset:28672
    ds_read_b64_tr_b16 a[114:115], v88 offset:28928
    ds_read_b64_tr_b16 a[116:117], v88 offset:30720
    ds_read_b64_tr_b16 a[118:119], v88 offset:30976
    ds_read_b64_tr_b16 a[120:121], v88 offset:28704
    ds_read_b64_tr_b16 a[122:123], v88 offset:28960
    ds_read_b64_tr_b16 a[124:125], v88 offset:30752
    ds_read_b64_tr_b16 a[126:127], v88 offset:31008
    s_waitcnt lgkmcnt(0)
    s_add_u32 m0, s58, 28672
    s_mov_b32 s51, 3670016
    buffer_load_dwordx4 v80, s[8:11], s51 offen offset:0  lds
    buffer_load_dwordx4 v81, s[8:11], s51 offen offset:1024  lds
    buffer_load_dwordx4 v82, s[8:11], s51 offen offset:2048  lds
    buffer_load_dwordx4 v83, s[8:11], s51 offen offset:3072  lds
    s_waitcnt vmcnt(29)
    ds_read_b64_tr_b16 a[128:129], v88 offset:0
    ds_read_b64_tr_b16 a[130:131], v88 offset:256
    ds_read_b64_tr_b16 a[132:133], v88 offset:2048
    ds_read_b64_tr_b16 a[134:135], v88 offset:2304
    ds_read_b64_tr_b16 a[136:137], v88 offset:32
    ds_read_b64_tr_b16 a[138:139], v88 offset:288
    ds_read_b64_tr_b16 a[140:141], v88 offset:2080
    ds_read_b64_tr_b16 a[142:143], v88 offset:2336
    s_waitcnt lgkmcnt(0)
    s_mov_b32 s8, s24
    s_and_b32 s9, s25, 0xffff
    s_mov_b32 s10, 4194304
    s_mov_b32 s11, 0x20000
    s_add_u32 m0, s58, 0
    s_mov_b32 s51, 0
    buffer_load_dwordx4 v80, s[8:11], s51 offen offset:0  lds
    buffer_load_dwordx4 v81, s[8:11], s51 offen offset:1024  lds
    buffer_load_dwordx4 v82, s[8:11], s51 offen offset:2048  lds
    buffer_load_dwordx4 v83, s[8:11], s51 offen offset:3072  lds
    s_waitcnt vmcnt(29)
    ds_read_b64_tr_b16 a[144:145], v88 offset:4096
    ds_read_b64_tr_b16 a[146:147], v88 offset:4352
    ds_read_b64_tr_b16 a[148:149], v88 offset:6144
    ds_read_b64_tr_b16 a[150:151], v88 offset:6400
    ds_read_b64_tr_b16 a[152:153], v88 offset:4128
    ds_read_b64_tr_b16 a[154:155], v88 offset:4384
    ds_read_b64_tr_b16 a[156:157], v88 offset:6176
    ds_read_b64_tr_b16 a[158:159], v88 offset:6432
    s_waitcnt lgkmcnt(0)
    s_add_u32 m0, s58, 4096
    s_mov_b32 s51, 1048576
    buffer_load_dwordx4 v80, s[8:11], s51 offen offset:0  lds
    buffer_load_dwordx4 v81, s[8:11], s51 offen offset:1024  lds
    buffer_load_dwordx4 v82, s[8:11], s51 offen offset:2048  lds
    buffer_load_dwordx4 v83, s[8:11], s51 offen offset:3072  lds
    s_waitcnt vmcnt(29)
    ds_read_b64_tr_b16 a[160:161], v88 offset:8192
    ds_read_b64_tr_b16 a[162:163], v88 offset:8448
    ds_read_b64_tr_b16 a[164:165], v88 offset:10240
    ds_read_b64_tr_b16 a[166:167], v88 offset:10496
    ds_read_b64_tr_b16 a[168:169], v88 offset:8224
    ds_read_b64_tr_b16 a[170:171], v88 offset:8480
    ds_read_b64_tr_b16 a[172:173], v88 offset:10272
    ds_read_b64_tr_b16 a[174:175], v88 offset:10528
    s_waitcnt lgkmcnt(0)
    s_add_u32 m0, s58, 8192
    s_mov_b32 s51, 2097152
    buffer_load_dwordx4 v80, s[8:11], s51 offen offset:0  lds
    buffer_load_dwordx4 v81, s[8:11], s51 offen offset:1024  lds
    buffer_load_dwordx4 v82, s[8:11], s51 offen offset:2048  lds
    buffer_load_dwordx4 v83, s[8:11], s51 offen offset:3072  lds
    s_waitcnt vmcnt(29)
    ds_read_b64_tr_b16 a[176:177], v88 offset:12288
    ds_read_b64_tr_b16 a[178:179], v88 offset:12544
    ds_read_b64_tr_b16 a[180:181], v88 offset:14336
    ds_read_b64_tr_b16 a[182:183], v88 offset:14592
    ds_read_b64_tr_b16 a[184:185], v88 offset:12320
    ds_read_b64_tr_b16 a[186:187], v88 offset:12576
    ds_read_b64_tr_b16 a[188:189], v88 offset:14368
    ds_read_b64_tr_b16 a[190:191], v88 offset:14624
    s_waitcnt lgkmcnt(0)
    s_add_u32 m0, s58, 12288
    s_mov_b32 s51, 3145728
    buffer_load_dwordx4 v80, s[8:11], s51 offen offset:0  lds
    buffer_load_dwordx4 v81, s[8:11], s51 offen offset:1024  lds
    buffer_load_dwordx4 v82, s[8:11], s51 offen offset:2048  lds
    buffer_load_dwordx4 v83, s[8:11], s51 offen offset:3072  lds
    s_waitcnt vmcnt(29)
    ds_read_b64_tr_b16 a[192:193], v88 offset:16384
    ds_read_b64_tr_b16 a[194:195], v88 offset:16640
    ds_read_b64_tr_b16 a[196:197], v88 offset:18432
    ds_read_b64_tr_b16 a[198:199], v88 offset:18688
    ds_read_b64_tr_b16 a[200:201], v88 offset:16416
    ds_read_b64_tr_b16 a[202:203], v88 offset:16672
    ds_read_b64_tr_b16 a[204:205], v88 offset:18464
    ds_read_b64_tr_b16 a[206:207], v88 offset:18720
    s_waitcnt lgkmcnt(0)
    s_mov_b32 s8, s26
    s_and_b32 s9, s27, 0xffff
    s_mov_b32 s10, 4194304
    s_mov_b32 s11, 0x20000
    s_add_u32 m0, s58, 16384
    s_mov_b32 s51, 0
    buffer_load_dwordx4 v84, s[8:11], s51 offen offset:0  lds
    buffer_load_dwordx4 v85, s[8:11], s51 offen offset:1024  lds
    buffer_load_dwordx4 v86, s[8:11], s51 offen offset:2048  lds
    buffer_load_dwordx4 v87, s[8:11], s51 offen offset:3072  lds
    s_waitcnt vmcnt(29)
    ds_read_b64_tr_b16 a[208:209], v88 offset:20480
    ds_read_b64_tr_b16 a[210:211], v88 offset:20736
    ds_read_b64_tr_b16 a[212:213], v88 offset:22528
    ds_read_b64_tr_b16 a[214:215], v88 offset:22784
    ds_read_b64_tr_b16 a[216:217], v88 offset:20512
    ds_read_b64_tr_b16 a[218:219], v88 offset:20768
    ds_read_b64_tr_b16 a[220:221], v88 offset:22560
    ds_read_b64_tr_b16 a[222:223], v88 offset:22816
    s_waitcnt lgkmcnt(0)
    s_add_u32 m0, s58, 20480
    s_mov_b32 s51, 32768
    buffer_load_dwordx4 v84, s[8:11], s51 offen offset:0  lds
    buffer_load_dwordx4 v85, s[8:11], s51 offen offset:1024  lds
    buffer_load_dwordx4 v86, s[8:11], s51 offen offset:2048  lds
    buffer_load_dwordx4 v87, s[8:11], s51 offen offset:3072  lds
    s_waitcnt vmcnt(29)
    ds_read_b64_tr_b16 a[224:225], v88 offset:24576
    ds_read_b64_tr_b16 a[226:227], v88 offset:24832
    ds_read_b64_tr_b16 a[228:229], v88 offset:26624
    ds_read_b64_tr_b16 a[230:231], v88 offset:26880
    ds_read_b64_tr_b16 a[232:233], v88 offset:24608
    ds_read_b64_tr_b16 a[234:235], v88 offset:24864
    ds_read_b64_tr_b16 a[236:237], v88 offset:26656
    ds_read_b64_tr_b16 a[238:239], v88 offset:26912
    s_waitcnt lgkmcnt(0)
    s_add_u32 m0, s58, 24576
    s_mov_b32 s51, 65536
    buffer_load_dwordx4 v84, s[8:11], s51 offen offset:0  lds
    buffer_load_dwordx4 v85, s[8:11], s51 offen offset:1024  lds
    buffer_load_dwordx4 v86, s[8:11], s51 offen offset:2048  lds
    buffer_load_dwordx4 v87, s[8:11], s51 offen offset:3072  lds
    s_waitcnt vmcnt(28)
    ds_read_b64_tr_b16 a[240:241], v88 offset:28672
    ds_read_b64_tr_b16 a[242:243], v88 offset:28928
    ds_read_b64_tr_b16 a[244:245], v88 offset:30720
    ds_read_b64_tr_b16 a[246:247], v88 offset:30976
    ds_read_b64_tr_b16 a[248:249], v88 offset:28704
    ds_read_b64_tr_b16 a[250:251], v88 offset:28960
    ds_read_b64_tr_b16 a[252:253], v88 offset:30752
    ds_read_b64_tr_b16 a[254:255], v88 offset:31008
    s_waitcnt lgkmcnt(0)
    s_add_u32 m0, s58, 28672
    s_mov_b32 s51, 98304
    buffer_load_dwordx4 v84, s[8:11], s51 offen offset:0  lds
    buffer_load_dwordx4 v85, s[8:11], s51 offen offset:1024  lds
    buffer_load_dwordx4 v86, s[8:11], s51 offen offset:2048  lds
    buffer_load_dwordx4 v87, s[8:11], s51 offen offset:3072  lds
    v_cmp_gt_u32 vcc, 0x100, v91
    s_cbranch_vccz L_crdy
    v_mov_b32 v91, v0
L_rdyc:
    v_mov_b32 v0, 64
    global_load_dword v0, v0, s[40:41] sc1
    s_waitcnt vmcnt(0)
    v_cmp_gt_u32 vcc, 0x100, v0
    s_cbranch_vccz L_rdyokc
    s_sub_u32 s96, s96, 1
    s_cbranch_scc0 L_rdyc
    s_branch L_abort
L_rdyokc:
    v_mov_b32 v0, v91
L_crdy:
    s_mov_b32 s52, 0x05040100
    s_mov_b32 s53, 0x07060302
    v_perm_b32 v72, v65, v64, s52
    v_perm_b32 v73, v67, v66, s52
    v_perm_b32 v74, v65, v64, s53
    v_perm_b32 v75, v67, v66, s53
    v_perm_b32 v76, v69, v68, s52
    v_perm_b32 v77, v71, v70, s52
    v_perm_b32 v78, v69, v68, s53
    v_perm_b32 v79, v71, v70, s53
    v_min_u32 v72, -2, v72
    v_min_u32 v73, -2, v73
    v_min_u32 v74, -2, v74
    v_min_u32 v75, -2, v75
    v_min_u32 v76, -2, v76
    v_min_u32 v77, -2, v77
    v_min_u32 v78, -2, v78
    v_min_u32 v79, -2, v79
    s_lshl_b32 s54, s13, 10
    s_add_u32 s54, s54, s1
    s_add_u32 s51, s54, 0
    buffer_store_dwordx4 v[72:75], v1, s[4:7], s51 offen sc1
    s_add_u32 s51, s54, 4096
    buffer_store_dwordx4 v[76:79], v1, s[4:7], s51 offen sc1
    v_mov_b32 v93, 0
    global_load_dword v93, v93, s[40:41] sc1
    s_lshl_b32 s51, s14, 7
    s_add_u32 s51, s51, 65830912
    v_and_b32_e64 v92, 1, v90
    v_lshlrev_b32 v92, 2, v92
    v_add_u32 v92, s51, v92
    s_waitcnt vmcnt(31)
    ds_read_b64_tr_b16 v[128:129], v88 offset:0
    ds_read_b64_tr_b16 v[130:131], v88 offset:256
    ds_read_b64_tr_b16 v[132:133], v88 offset:2048
    ds_read_b64_tr_b16 v[134:135], v88 offset:2304
    ds_read_b64_tr_b16 v[136:137], v88 offset:32
    ds_read_b64_tr_b16 v[138:139], v88 offset:288
    ds_read_b64_tr_b16 v[140:141], v88 offset:2080
    ds_read_b64_tr_b16 v[142:143], v88 offset:2336
    s_waitcnt lgkmcnt(0)
    s_mov_b32 s8, s24
    s_and_b32 s9, s25, 0xffff
    s_mov_b32 s10, 4194304
    s_mov_b32 s11, 0x20000
    s_add_u32 m0, s58, 0
    s_mov_b32 s51, 524288
    buffer_load_dwordx4 v80, s[8:11], s51 offen offset:0  lds
    buffer_load_dwordx4 v81, s[8:11], s51 offen offset:1024  lds
    buffer_load_dwordx4 v82, s[8:11], s51 offen offset:2048  lds
    buffer_load_dwordx4 v83, s[8:11], s51 offen offset:3072  lds
    s_waitcnt vmcnt(31)
    ds_read_b64_tr_b16 v[144:145], v88 offset:4096
    ds_read_b64_tr_b16 v[146:147], v88 offset:4352
    ds_read_b64_tr_b16 v[148:149], v88 offset:6144
    ds_read_b64_tr_b16 v[150:151], v88 offset:6400
    ds_read_b64_tr_b16 v[152:153], v88 offset:4128
    ds_read_b64_tr_b16 v[154:155], v88 offset:4384
    ds_read_b64_tr_b16 v[156:157], v88 offset:6176
    ds_read_b64_tr_b16 v[158:159], v88 offset:6432
    s_waitcnt lgkmcnt(0)
    s_add_u32 m0, s58, 4096
    s_mov_b32 s51, 1572864
    buffer_load_dwordx4 v80, s[8:11], s51 offen offset:0  lds
    buffer_load_dwordx4 v81, s[8:11], s51 offen offset:1024  lds
    buffer_load_dwordx4 v82, s[8:11], s51 offen offset:2048  lds
    buffer_load_dwordx4 v83, s[8:11], s51 offen offset:3072  lds
    buffer_load_dword v91, v92, s[4:7], 0 offen sc1
    s_waitcnt vmcnt(32)
    ds_read_b64_tr_b16 v[160:161], v88 offset:8192
    ds_read_b64_tr_b16 v[162:163], v88 offset:8448
    ds_read_b64_tr_b16 v[164:165], v88 offset:10240
    ds_read_b64_tr_b16 v[166:167], v88 offset:10496
    ds_read_b64_tr_b16 v[168:169], v88 offset:8224
    ds_read_b64_tr_b16 v[170:171], v88 offset:8480
    ds_read_b64_tr_b16 v[172:173], v88 offset:10272
    ds_read_b64_tr_b16 v[174:175], v88 offset:10528
    s_waitcnt lgkmcnt(0)
    s_add_u32 m0, s58, 8192
    s_mov_b32 s51, 2621440
    buffer_load_dwordx4 v80, s[8:11], s51 offen offset:0  lds
    buffer_load_dwordx4 v81, s[8:11], s51 offen offset:1024  lds
    buffer_load_dwordx4 v82, s[8:11], s51 offen offset:2048  lds
    buffer_load_dwordx4 v83, s[8:11], s51 offen offset:3072  lds
    s_waitcnt vmcnt(32)
    ds_read_b64_tr_b16 v[176:177], v88 offset:12288
    ds_read_b64_tr_b16 v[178:179], v88 offset:12544
    ds_read_b64_tr_b16 v[180:181], v88 offset:14336
    ds_read_b64_tr_b16 v[182:183], v88 offset:14592
    ds_read_b64_tr_b16 v[184:185], v88 offset:12320
    ds_read_b64_tr_b16 v[186:187], v88 offset:12576
    ds_read_b64_tr_b16 v[188:189], v88 offset:14368
    ds_read_b64_tr_b16 v[190:191], v88 offset:14624
    s_waitcnt lgkmcnt(0)
    s_add_u32 m0, s58, 12288
    s_mov_b32 s51, 3670016
    buffer_load_dwordx4 v80, s[8:11], s51 offen offset:0  lds
    buffer_load_dwordx4 v81, s[8:11], s51 offen offset:1024  lds
    buffer_load_dwordx4 v82, s[8:11], s51 offen offset:2048  lds
    buffer_load_dwordx4 v83, s[8:11], s51 offen offset:3072  lds
    s_waitcnt vmcnt(28)
    ds_read_b64_tr_b16 v[192:193], v89 offset:16384
    ds_read_b64_tr_b16 v[194:195], v89 offset:16896
    ds_read_b64_tr_b16 v[196:197], v89 offset:20480
    ds_read_b64_tr_b16 v[198:199], v89 offset:20992
    ds_read_b64_tr_b16 v[208:209], v89 offset:16416
    ds_read_b64_tr_b16 v[210:211], v89 offset:16928
    ds_read_b64_tr_b16 v[212:213], v89 offset:20512
    ds_read_b64_tr_b16 v[214:215], v89 offset:21024
    ds_read_b64_tr_b16 v[224:225], v89 offset:16448
    ds_read_b64_tr_b16 v[226:227], v89 offset:16960
    ds_read_b64_tr_b16 v[228:229], v89 offset:20544
    ds_read_b64_tr_b16 v[230:231], v89 offset:21056
    ds_read_b64_tr_b16 v[240:241], v89 offset:16480
    ds_read_b64_tr_b16 v[242:243], v89 offset:16992
    ds_read_b64_tr_b16 v[244:245], v89 offset:20576
    ds_read_b64_tr_b16 v[246:247], v89 offset:21088
    s_waitcnt lgkmcnt(0)
    s_mov_b32 s8, s26
    s_and_b32 s9, s27, 0xffff
    s_mov_b32 s10, 4194304
    s_mov_b32 s11, 0x20000
    s_add_u32 m0, s58, 16384
    s_mov_b32 s51, 128
    buffer_load_dwordx4 v84, s[8:11], s51 offen offset:0  lds
    buffer_load_dwordx4 v85, s[8:11], s51 offen offset:1024  lds
    buffer_load_dwordx4 v86, s[8:11], s51 offen offset:2048  lds
    buffer_load_dwordx4 v87, s[8:11], s51 offen offset:3072  lds
    s_add_u32 m0, s58, 20480
    s_mov_b32 s51, 32896
    buffer_load_dwordx4 v84, s[8:11], s51 offen offset:0  lds
    buffer_load_dwordx4 v85, s[8:11], s51 offen offset:1024  lds
    buffer_load_dwordx4 v86, s[8:11], s51 offen offset:2048  lds
    buffer_load_dwordx4 v87, s[8:11], s51 offen offset:3072  lds
    s_waitcnt vmcnt(28)
    ds_read_b64_tr_b16 v[200:201], v89 offset:24576
    ds_read_b64_tr_b16 v[202:203], v89 offset:25088
    ds_read_b64_tr_b16 v[204:205], v89 offset:28672
    ds_read_b64_tr_b16 v[206:207], v89 offset:29184
    ds_read_b64_tr_b16 v[216:217], v89 offset:24608
    ds_read_b64_tr_b16 v[218:219], v89 offset:25120
    ds_read_b64_tr_b16 v[220:221], v89 offset:28704
    ds_read_b64_tr_b16 v[222:223], v89 offset:29216
    ds_read_b64_tr_b16 v[232:233], v89 offset:24640
    ds_read_b64_tr_b16 v[234:235], v89 offset:25152
    ds_read_b64_tr_b16 v[236:237], v89 offset:28736
    ds_read_b64_tr_b16 v[238:239], v89 offset:29248
    ds_read_b64_tr_b16 v[248:249], v89 offset:24672
    ds_read_b64_tr_b16 v[250:251], v89 offset:25184
    ds_read_b64_tr_b16 v[252:253], v89 offset:28768
    ds_read_b64_tr_b16 v[254:255], v89 offset:29280
    s_waitcnt lgkmcnt(0)
    s_add_u32 m0, s58, 24576
    s_mov_b32 s51, 65664
    buffer_load_dwordx4 v84, s[8:11], s51 offen offset:0  lds
    buffer_load_dwordx4 v85, s[8:11], s51 offen offset:1024  lds
    buffer_load_dwordx4 v86, s[8:11], s51 offen offset:2048  lds
    buffer_load_dwordx4 v87, s[8:11], s51 offen offset:3072  lds
    s_add_u32 m0, s58, 28672
    s_mov_b32 s51, 98432
    buffer_load_dwordx4 v84, s[8:11], s51 offen offset:0  lds
    buffer_load_dwordx4 v85, s[8:11], s51 offen offset:1024  lds
    buffer_load_dwordx4 v86, s[8:11], s51 offen offset:2048  lds
    buffer_load_dwordx4 v87, s[8:11], s51 offen offset:3072  lds
    s_waitcnt vmcnt(29)
    ds_read_b64_tr_b16 v[32:33], v88 offset:0
    ds_read_b64_tr_b16 v[34:35], v88 offset:256
    ds_read_b64_tr_b16 v[36:37], v88 offset:2048
    ds_read_b64_tr_b16 v[38:39], v88 offset:2304
    ds_read_b64_tr_b16 v[40:41], v88 offset:32
    ds_read_b64_tr_b16 v[42:43], v88 offset:288
    ds_read_b64_tr_b16 v[44:45], v88 offset:2080
    ds_read_b64_tr_b16 v[46:47], v88 offset:2336
    s_waitcnt lgkmcnt(0)
    ds_write_b128 v2, v[32:35] offset:0
    ds_write_b128 v2, v[36:39] offset:1024
    ds_write_b128 v2, v[40:43] offset:2048
    ds_write_b128 v2, v[44:47] offset:3072
    s_waitcnt lgkmcnt(0)
    s_waitcnt vmcnt(25)
    ds_read_b64_tr_b16 v[32:33], v88 offset:4096
    ds_read_b64_tr_b16 v[34:35], v88 offset:4352
    ds_read_b64_tr_b16 v[36:37], v88 offset:6144
    ds_read_b64_tr_b16 v[38:39], v88 offset:6400
    ds_read_b64_tr_b16 v[40:41], v88 offset:4128
    ds_read_b64_tr_b16 v[42:43], v88 offset:4384
    ds_read_b64_tr_b16 v[44:45], v88 offset:6176
    ds_read_b64_tr_b16 v[46:47], v88 offset:6432
    s_waitcnt lgkmcnt(0)
    ds_write_b128 v2, v[32:35] offset:4096
    ds_write_b128 v2, v[36:39] offset:5120
    ds_write_b128 v2, v[40:43] offset:6144
    ds_write_b128 v2, v[44:47] offset:7168
    s_waitcnt lgkmcnt(0)
    s_waitcnt vmcnt(24)
L_ckv:
    v_cmp_gt_i32 vcc, 0, v91
    s_cbranch_vccz L_ckvok
    buffer_load_dword v91, v92, s[4:7], 0 offen sc1
    s_waitcnt vmcnt(0)
    s_sub_u32 s96, s96, 1
    s_cbranch_scc0 L_ckv
    s_branch L_abort
L_ckvok:
    s_lshl_b32 s54, s13, 11
    s_lshl_b32 s52, s14, 13
    s_add_u32 s52, s52, s54
    s_add_u32 m0, s54, 0
    s_add_u32 s51, s52, 16777216
    buffer_load_dwordx4 v1, s[4:7], s51 offen offset:0 sc1 lds
    buffer_load_dwordx4 v1, s[4:7], s51 offen offset:1024 sc1 lds
    s_add_u32 m0, s54, 8192
    s_add_u32 s51, s52, 33554432
    buffer_load_dwordx4 v1, s[4:7], s51 offen offset:0 sc1 lds
    buffer_load_dwordx4 v1, s[4:7], s51 offen offset:1024 sc1 lds
    buffer_load_dword v91, v92, s[4:7], 0 offen sc1
    s_waitcnt vmcnt(25)
    ds_read_b64_tr_b16 v[32:33], v88 offset:8192
    ds_read_b64_tr_b16 v[34:35], v88 offset:8448
    ds_read_b64_tr_b16 v[36:37], v88 offset:10240
    ds_read_b64_tr_b16 v[38:39], v88 offset:10496
    ds_read_b64_tr_b16 v[40:41], v88 offset:8224
    ds_read_b64_tr_b16 v[42:43], v88 offset:8480
    ds_read_b64_tr_b16 v[44:45], v88 offset:10272
    ds_read_b64_tr_b16 v[46:47], v88 offset:10528
    s_waitcnt lgkmcnt(0)
    ds_write_b128 v2, v[32:35] offset:8192
    ds_write_b128 v2, v[36:39] offset:9216
    ds_write_b128 v2, v[40:43] offset:10240
    ds_write_b128 v2, v[44:47] offset:11264
    s_waitcnt lgkmcnt(0)
    s_waitcnt vmcnt(21)
    ds_read_b64_tr_b16 v[32:33], v88 offset:12288
    ds_read_b64_tr_b16 v[34:35], v88 offset:12544
    ds_read_b64_tr_b16 v[36:37], v88 offset:14336
    ds_read_b64_tr_b16 v[38:39], v88 offset:14592
    ds_read_b64_tr_b16 v[40:41], v88 offset:12320
    ds_read_b64_tr_b16 v[42:43], v88 offset:12576
    ds_read_b64_tr_b16 v[44:45], v88 offset:14368
    ds_read_b64_tr_b16 v[46:47], v88 offset:14624
    s_waitcnt lgkmcnt(0)
    ds_write_b128 v2, v[32:35] offset:12288
    ds_write_b128 v2, v[36:39] offset:13312
    ds_write_b128 v2, v[40:43] offset:14336
    ds_write_b128 v2, v[44:47] offset:15360
    s_waitcnt lgkmcnt(0)
    s_waitcnt vmcnt(13)
    ds_read_b64_tr_b16 v[32:33], v89 offset:16384
    ds_read_b64_tr_b16 v[34:35], v89 offset:16896
    ds_read_b64_tr_b16 v[36:37], v89 offset:20480
    ds_read_b64_tr_b16 v[38:39], v89 offset:20992
    ds_read_b64_tr_b16 v[40:41], v89 offset:16416
    ds_read_b64_tr_b16 v[42:43], v89 offset:16928
    ds_read_b64_tr_b16 v[44:45], v89 offset:20512
    ds_read_b64_tr_b16 v[46:47], v89 offset:21024
    ds_read_b64_tr_b16 v[48:49], v89 offset:16448
    ds_read_b64_tr_b16 v[50:51], v89 offset:16960
    ds_read_b64_tr_b16 v[52:53], v89 offset:20544
    ds_read_b64_tr_b16 v[54:55], v89 offset:21056
    ds_read_b64_tr_b16 v[56:57], v89 offset:16480
    ds_read_b64_tr_b16 v[58:59], v89 offset:16992
    ds_read_b64_tr_b16 v[60:61], v89 offset:20576
    ds_read_b64_tr_b16 v[62:63], v89 offset:21088
    s_waitcnt lgkmcnt(0)
    ds_write_b128 v2, v[32:35] offset:16384
    ds_write_b128 v2, v[36:39] offset:17408
    ds_write_b128 v2, v[40:43] offset:18432
    ds_write_b128 v2, v[44:47] offset:19456
    ds_write_b128 v2, v[48:51] offset:20480
    ds_write_b128 v2, v[52:55] offset:21504
    ds_write_b128 v2, v[56:59] offset:22528
    ds_write_b128 v2, v[60:63] offset:23552
    s_waitcnt lgkmcnt(0)
    s_waitcnt vmcnt(5)
    ds_read_b64_tr_b16 v[32:33], v89 offset:24576
    ds_read_b64_tr_b16 v[34:35], v89 offset:25088
    ds_read_b64_tr_b16 v[36:37], v89 offset:28672
    ds_read_b64_tr_b16 v[38:39], v89 offset:29184
    ds_read_b64_tr_b16 v[40:41], v89 offset:24608
    ds_read_b64_tr_b16 v[42:43], v89 offset:25120
    ds_read_b64_tr_b16 v[44:45], v89 offset:28704
    ds_read_b64_tr_b16 v[46:47], v89 offset:29216
    ds_read_b64_tr_b16 v[48:49], v89 offset:24640
    ds_read_b64_tr_b16 v[50:51], v89 offset:25152
    ds_read_b64_tr_b16 v[52:53], v89 offset:28736
    ds_read_b64_tr_b16 v[54:55], v89 offset:29248
    ds_read_b64_tr_b16 v[56:57], v89 offset:24672
    ds_read_b64_tr_b16 v[58:59], v89 offset:25184
    ds_read_b64_tr_b16 v[60:61], v89 offset:28768
    ds_read_b64_tr_b16 v[62:63], v89 offset:29280
    s_waitcnt lgkmcnt(0)
    ds_write_b128 v2, v[32:35] offset:24576
    ds_write_b128 v2, v[36:39] offset:25600
    ds_write_b128 v2, v[40:43] offset:26624
    ds_write_b128 v2, v[44:47] offset:27648
    ds_write_b128 v2, v[48:51] offset:28672
    ds_write_b128 v2, v[52:55] offset:29696
    ds_write_b128 v2, v[56:59] offset:30720
    ds_write_b128 v2, v[60:63] offset:31744
    s_waitcnt lgkmcnt(0)
    s_waitcnt vmcnt(0)
    v_readfirstlane_b32 s51, v93
    s_barrier
    s_cmp_lt_u32 s51, 32
    s_cbranch_scc1 L_cmixed
    s_cmp_eq_u32 s13, 1
    s_cbranch_scc1 L_cstart1
    s_cmp_eq_u32 s13, 2
    s_cbranch_scc1 L_cstart2
    s_cmp_eq_u32 s13, 3
    s_cbranch_scc1 L_cstart3
    s_branch L_cstart0
L_cmixed:
    s_cmp_eq_u32 s13, 1
    s_cbranch_scc1 L_cstart1X
    s_cmp_eq_u32 s13, 2
    s_cbranch_scc1 L_cstart2X
    s_cmp_eq_u32 s13, 3
    s_cbranch_scc1 L_cstart3X
    s_branch L_cstart0X
L_csetup0:
    v_and_b32 v16, 63, v0
    v_lshlrev_b32 v1, 4, v16
    v_add_u32 v2, 32768, v1
    v_lshrrev_b32 v17, 4, v16
    v_and_b32 v18, 15, v16
    v_lshrrev_b32 v19, 2, v18
    v_and_b32_e64 v20, 3, v16
    v_lshlrev_b32 v3, 9, v17
    v_lshl_add_u32 v3, v18, 4, v3
    v_lshrrev_b32 v21, 1, v20
    v_lshlrev_b32 v4, 9, v21
    v_lshl_add_u32 v22, v17, 2, v19
    v_lshl_add_u32 v4, v22, 4, v4
    v_and_b32_e64 v22, 1, v20
    v_lshl_add_u32 v4, v22, 3, v4
    v_lshlrev_b32 v5, 10, v20
    v_lshl_add_u32 v5, v22, 5, v5
    v_lshl_add_u32 v5, v21, 7, v5
    v_lshl_add_u32 v23, v17, 3, v19
    v_lshl_add_u32 v5, v23, 3, v5
    v_and_b32 v24, 1, v17
    v_lshrrev_b32 v25, 1, v17
    v_lshlrev_b32 v6, 10, v17
    v_lshl_add_u32 v6, v24, 5, v6
    v_lshl_add_u32 v6, v25, 7, v6
    v_lshl_add_u32 v6, v18, 3, v6
    v_lshl_add_u32 v26, v19, 1, v22
    v_lshl_add_u32 v26, v26, 1, v24
    v_lshl_add_u32 v26, v25, 4, v26
    v_lshlrev_b32 v7, 4, v26
    v_lshlrev_b32 v26, 5, v25
    v_lshl_add_u32 v26, v19, 3, v26
    v_lshl_add_u32 v26, v24, 2, v26
    v_add_u32 v26, v26, v20
    s_lshl_b32 s51, s14, 13
    s_add_u32 s52, s51, 0
    v_lshl_add_u32 v8, v26, 4, s52
    v_mov_b32 v11, 0x4444
    v_mov_b32 v27, 0xeeee
    v_cmp_eq_u32 vcc, 1, v22
    s_nop 1
    v_cndmask_b32 v11, v11, v27, vcc
    v_lshrrev_b32 v26, 3, v16
    v_and_b32_e64 v27, 7, v16
    v_lshlrev_b32 v9, 13, v26
    v_lshl_add_u32 v9, v27, 4, v9
    s_lshl_b32 s52, s14, 7
    s_add_u32 s52, s52, 0
    v_add_u32 v9, s52, v9
    s_lshr_b32 s52, s14, 3
    s_add_u32 s52, s52, 0
    s_lshl_b32 s52, s52, 10
    s_and_b32 s53, s14, 3
    s_lshl_b32 s53, s53, 8
    s_add_u32 s52, s52, s53
    s_and_b32 s53, s14, 4
    s_lshl_b32 s53, s53, 5
    s_add_u32 s52, s52, s53
    v_and_b32_e64 v26, 1, v19
    v_lshl_add_u32 v26, v26, 1, v24
    v_lshlrev_b32 v26, 5, v26
    v_lshl_add_u32 v26, v20, 3, v26
    v_add_u32 v10, s52, v26
    v_lshrrev_b32 v26, 3, v18
    v_lshl_add_u32 v26, v25, 1, v26
    v_lshl_add_u32 v10, v26, 13, v10
    v_and_b32 v18, 7, v18
    v_mov_b32_e64 v12, 0
    v_mov_b32 v26, 0x3f80
    v_cmp_eq_u32 vcc, 0, v18
    s_nop 1
    v_cndmask_b32 v12, v12, v26, vcc
    v_mov_b32 v26, 0x3f800000
    v_cmp_eq_u32 vcc, 1, v18
    s_nop 1
    v_cndmask_b32 v12, v12, v26, vcc
    v_mov_b32 v13, 0
    v_mov_b32 v26, 0x3f80
    v_cmp_eq_u32 vcc, 2, v18
    s_nop 1
    v_cndmask_b32 v13, v13, v26, vcc
    v_mov_b32 v26, 0x3f800000
    v_cmp_eq_u32 vcc, 3, v18
    s_nop 1
    v_cndmask_b32 v13, v13, v26, vcc
    v_mov_b32 v14, 0
    v_mov_b32 v26, 0x3f80
    v_cmp_eq_u32 vcc, 4, v18
    s_nop 1
    v_cndmask_b32 v14, v14, v26, vcc
    v_mov_b32 v26, 0x3f800000
    v_cmp_eq_u32 vcc, 5, v18
    s_nop 1
    v_cndmask_b32 v14, v14, v26, vcc
    v_mov_b32 v15, 0
    v_mov_b32 v26, 0x3f80
    v_cmp_eq_u32 vcc, 6, v18
    s_nop 1
    v_cndmask_b32 v15, v15, v26, vcc
    v_mov_b32_e64 v26, 0x3f800000
    v_cmp_eq_u32 vcc, 7, v18
    s_nop 1
    v_cndmask_b32 v15, v15, v26, vcc
    s_mov_b32 s55, 0x3e0293ee
    s_mov_b32 s32, 0x3e0293ee
    s_mov_b32 s33, 0x3e0293ee
    s_mov_b32 s56, 0xcccccccc
    s_mov_b32 s57, 0xcccccccc
    s_mov_b32 s44, 0
    s_mov_b32 s45, 65011712
    s_mov_b32 s46, 65015808
    s_mov_b32 s47, 0
    s_mov_b32 s78, 0x3f803f80
    s_mov_b32 s79, 0x3f803f80
    s_mov_b32 s28, 65011712
    s_mov_b32 s29, 65077248
    s_mov_b32 s30, 65142784
    s_mov_b32 s31, 65208320
    s_mov_b32 s48, 65273856
    s_mov_b32 s49, 65306624
    s_mov_b32 s50, 65339392
    s_and_b32 s0, s14, 3
    s_lshl_b32 s0, s0, 13
    s_add_u32 s1, s48, s0
    s_add_u32 s3, s1, 4096
    s_mov_b32 s59, 65929216
    v_lshrrev_b32 v0, 2, v1
    v_and_b32 v0, 0x7c, v0
    s_and_b32 s51, s14, 7
    s_lshl_b32 s51, s51, 8
    v_add_u32 v0, s51, v0
    s_branch L_cload
L_csetup1:
    v_and_b32 v16, 63, v0
    v_lshlrev_b32 v1, 4, v16
    v_add_u32 v2, 65536, v1
    v_lshrrev_b32 v17, 4, v16
    v_and_b32 v18, 15, v16
    v_lshrrev_b32 v19, 2, v18
    v_and_b32_e64 v20, 3, v16
    v_lshlrev_b32 v3, 9, v17
    v_lshl_add_u32 v3, v18, 4, v3
    v_lshrrev_b32 v21, 1, v20
    v_lshlrev_b32 v4, 9, v21
    v_lshl_add_u32 v22, v17, 2, v19
    v_lshl_add_u32 v4, v22, 4, v4
    v_and_b32_e64 v22, 1, v20
    v_lshl_add_u32 v4, v22, 3, v4
    v_lshlrev_b32 v5, 10, v20
    v_lshl_add_u32 v5, v22, 5, v5
    v_lshl_add_u32 v5, v21, 7, v5
    v_lshl_add_u32 v23, v17, 3, v19
    v_lshl_add_u32 v5, v23, 3, v5
    v_and_b32 v24, 1, v17
    v_lshrrev_b32 v25, 1, v17
    v_lshlrev_b32 v6, 10, v17
    v_lshl_add_u32 v6, v24, 5, v6
    v_lshl_add_u32 v6, v25, 7, v6
    v_lshl_add_u32 v6, v18, 3, v6
    v_lshl_add_u32 v26, v19, 1, v22
    v_lshl_add_u32 v26, v26, 1, v24
    v_lshl_add_u32 v26, v25, 4, v26
    v_lshlrev_b32 v7, 4, v26
    v_lshlrev_b32 v26, 5, v25
    v_lshl_add_u32 v26, v19, 3, v26
    v_lshl_add_u32 v26, v24, 2, v26
    v_add_u32 v26, v26, v20
    s_lshl_b32 s51, s14, 13
    s_add_u32 s52, s51, 1024
    v_lshl_add_u32 v8, v26, 4, s52
    v_mov_b32 v11, 0x4444
    v_mov_b32 v27, 0xeeee
    v_cmp_eq_u32 vcc, 1, v22
    s_nop 1
    v_cndmask_b32 v11, v11, v27, vcc
    v_lshrrev_b32 v26, 3, v16
    v_and_b32 v27, 7, v16
    v_lshlrev_b32 v9, 13, v26
    v_lshl_add_u32 v9, v27, 4, v9
    s_lshl_b32 s52, s14, 7
    s_add_u32 s52, s52, 4096
    v_add_u32 v9, s52, v9
    s_lshr_b32 s52, s14, 3
    s_add_u32 s52, s52, 4
    s_lshl_b32 s52, s52, 10
    s_and_b32 s53, s14, 3
    s_lshl_b32 s53, s53, 8
    s_add_u32 s52, s52, s53
    s_and_b32 s53, s14, 4
    s_lshl_b32 s53, s53, 5
    s_add_u32 s52, s52, s53
    v_and_b32 v26, 1, v19
    v_lshl_add_u32 v26, v26, 1, v24
    v_lshlrev_b32 v26, 5, v26
    v_lshl_add_u32 v26, v20, 3, v26
    v_add_u32 v10, s52, v26
    v_lshrrev_b32 v26, 3, v18
    v_lshl_add_u32 v26, v25, 1, v26
    v_lshl_add_u32 v10, v26, 13, v10
    v_and_b32 v18, 7, v18
    v_mov_b32_e64 v12, 0
    v_mov_b32 v26, 0x3f80
    v_cmp_eq_u32 vcc, 0, v18
    s_nop 1
    v_cndmask_b32 v12, v12, v26, vcc
    v_mov_b32 v26, 0x3f800000
    v_cmp_eq_u32 vcc, 1, v18
    s_nop 1
    v_cndmask_b32 v12, v12, v26, vcc
    v_mov_b32 v13, 0
    v_mov_b32 v26, 0x3f80
    v_cmp_eq_u32 vcc, 2, v18
    s_nop 1
    v_cndmask_b32 v13, v13, v26, vcc
    v_mov_b32 v26, 0x3f800000
    v_cmp_eq_u32 vcc, 3, v18
    s_nop 1
    v_cndmask_b32 v13, v13, v26, vcc
    v_mov_b32 v14, 0
    v_mov_b32 v26, 0x3f80
    v_cmp_eq_u32 vcc, 4, v18
    s_nop 1
    v_cndmask_b32 v14, v14, v26, vcc
    v_mov_b32 v26, 0x3f800000
    v_cmp_eq_u32 vcc, 5, v18
    s_nop 1
    v_cndmask_b32 v14, v14, v26, vcc
    v_mov_b32 v15, 0
    v_mov_b32 v26, 0x3f80
    v_cmp_eq_u32 vcc, 6, v18
    s_nop 1
    v_cndmask_b32 v15, v15, v26, vcc
    v_mov_b32_e64 v26, 0x3f800000
    v_cmp_eq_u32 vcc, 7, v18
    s_nop 1
    v_cndmask_b32 v15, v15, v26, vcc
    s_mov_b32 s55, 0x3e0293ee
    s_mov_b32 s32, 0x3e0293ee
    s_mov_b32 s33, 0x3e0293ee
    s_mov_b32 s56, 0xcccccccc
    s_mov_b32 s57, 0xcccccccc
    s_mov_b32 s44, 0
    s_mov_b32 s45, 65011712
    s_mov_b32 s46, 65015808
    s_mov_b32 s47, 0
    s_mov_b32 s78, 0x3f803f80
    s_mov_b32 s79, 0x3f803f80
    s_mov_b32 s28, 65011712
    s_mov_b32 s29, 65077248
    s_mov_b32 s30, 65142784
    s_mov_b32 s31, 65208320
    s_mov_b32 s48, 65273856
    s_mov_b32 s49, 65306624
    s_mov_b32 s50, 65339392
    s_and_b32 s0, s14, 3
    s_lshl_b32 s0, s0, 13
    s_add_u32 s1, s48, s0
    s_add_u32 s3, s1, 4096
    s_mov_b32 s59, 65929216
    s_branch L_cload
L_csetup2:
    v_and_b32 v16, 63, v0
    v_lshlrev_b32 v1, 4, v16
    v_add_u32 v2, 98304, v1
    v_lshrrev_b32 v17, 4, v16
    v_and_b32 v18, 15, v16
    v_lshrrev_b32 v19, 2, v18
    v_and_b32_e64 v20, 3, v16
    v_lshlrev_b32 v3, 9, v17
    v_lshl_add_u32 v3, v18, 4, v3
    v_lshrrev_b32 v21, 1, v20
    v_lshlrev_b32 v4, 9, v21
    v_lshl_add_u32 v22, v17, 2, v19
    v_lshl_add_u32 v4, v22, 4, v4
    v_and_b32_e64 v22, 1, v20
    v_lshl_add_u32 v4, v22, 3, v4
    v_lshlrev_b32 v5, 10, v20
    v_lshl_add_u32 v5, v22, 5, v5
    v_lshl_add_u32 v5, v21, 7, v5
    v_lshl_add_u32 v23, v17, 3, v19
    v_lshl_add_u32 v5, v23, 3, v5
    v_and_b32 v24, 1, v17
    v_lshrrev_b32 v25, 1, v17
    v_lshlrev_b32 v6, 10, v17
    v_lshl_add_u32 v6, v24, 5, v6
    v_lshl_add_u32 v6, v25, 7, v6
    v_lshl_add_u32 v6, v18, 3, v6
    v_lshl_add_u32 v26, v19, 1, v22
    v_lshl_add_u32 v26, v26, 1, v24
    v_lshl_add_u32 v26, v25, 4, v26
    v_lshlrev_b32 v7, 4, v26
    v_lshlrev_b32 v26, 5, v25
    v_lshl_add_u32 v26, v19, 3, v26
    v_lshl_add_u32 v26, v24, 2, v26
    v_add_u32 v26, v26, v20
    s_lshl_b32 s51, s14, 13
    s_add_u32 s52, s51, 2048
    v_lshl_add_u32 v8, v26, 4, s52
    v_mov_b32 v11, 0x4444
    v_mov_b32 v27, 0xeeee
    v_cmp_eq_u32 vcc, 1, v22
    s_nop 1
    v_cndmask_b32 v11, v11, v27, vcc
    v_add_u32 v9, s51, v1
    s_lshl_b32 s52, s14, 12
    v_add_u32 v10, s52, v1
    s_lshl_b32 s52, s14, 7
    v_mov_b32 v13, s52
    s_mov_b32 s55, 0x3e0293ee
    s_mov_b32 s32, 0x3e0293ee
    s_mov_b32 s33, 0x3e0293ee
    s_mov_b32 s56, 0xcccccccc
    s_mov_b32 s57, 0xcccccccc
    s_mov_b32 s44, 0
    s_mov_b32 s45, 65011712
    s_mov_b32 s46, 65015808
    s_mov_b32 s47, 0
    s_mov_b32 s78, 0x3f803f80
    s_mov_b32 s79, 0x3f803f80
    s_mov_b32 s28, 65830912
    s_mov_b32 s30, 65835008
    s_mov_b32 s48, 65273856
    s_mov_b32 s49, 65306624
    s_mov_b32 s50, 65339392
    s_and_b32 s0, s14, 3
    s_lshl_b32 s0, s0, 13
    s_add_u32 s1, s48, s0
    s_add_u32 s3, s1, 4096
    s_mov_b32 s59, 65929216
    s_branch L_cload
L_csetup3:
    v_and_b32 v16, 63, v0
    v_lshlrev_b32 v1, 4, v16
    v_add_u32 v2, 131072, v1
    v_lshrrev_b32 v17, 4, v16
    v_and_b32 v18, 15, v16
    v_lshrrev_b32 v19, 2, v18
    v_and_b32_e64 v20, 3, v16
    v_lshlrev_b32 v3, 9, v17
    v_lshl_add_u32 v3, v18, 4, v3
    v_lshrrev_b32 v21, 1, v20
    v_lshlrev_b32 v4, 9, v21
    v_lshl_add_u32 v22, v17, 2, v19
    v_lshl_add_u32 v4, v22, 4, v4
    v_and_b32_e64 v22, 1, v20
    v_lshl_add_u32 v4, v22, 3, v4
    v_lshlrev_b32 v5, 10, v20
    v_lshl_add_u32 v5, v22, 5, v5
    v_lshl_add_u32 v5, v21, 7, v5
    v_lshl_add_u32 v23, v17, 3, v19
    v_lshl_add_u32 v5, v23, 3, v5
    v_and_b32 v24, 1, v17
    v_lshrrev_b32 v25, 1, v17
    v_lshlrev_b32 v6, 10, v17
    v_lshl_add_u32 v6, v24, 5, v6
    v_lshl_add_u32 v6, v25, 7, v6
    v_lshl_add_u32 v6, v18, 3, v6
    v_lshl_add_u32 v26, v19, 1, v22
    v_lshl_add_u32 v26, v26, 1, v24
    v_lshl_add_u32 v26, v25, 4, v26
    v_lshlrev_b32 v7, 4, v26
    v_lshlrev_b32 v26, 5, v25
    v_lshl_add_u32 v26, v19, 3, v26
    v_lshl_add_u32 v26, v24, 2, v26
    v_add_u32 v26, v26, v20
    s_lshl_b32 s51, s14, 13
    s_add_u32 s52, s51, 3072
    v_lshl_add_u32 v8, v26, 4, s52
    v_mov_b32 v11, 0x4444
    v_mov_b32 v27, 0xeeee
    v_cmp_eq_u32 vcc, 1, v22
    s_nop 1
    v_cndmask_b32 v11, v11, v27, vcc
    v_add_u32 v9, s51, v1
    s_lshl_b32 s52, s14, 12
    v_add_u32 v10, s52, v1
    s_lshl_b32 s52, s14, 7
    v_mov_b32 v13, s52
    s_mov_b32 s55, 0x3e0293ee
    s_mov_b32 s32, 0x3e0293ee
    s_mov_b32 s33, 0x3e0293ee
    s_mov_b32 s56, 0xcccccccc
    s_mov_b32 s57, 0xcccccccc
    s_mov_b32 s44, 0
    s_mov_b32 s45, 65011712
    s_mov_b32 s46, 65015808
    s_mov_b32 s47, 0
    s_mov_b32 s78, 0x3f803f80
    s_mov_b32 s79, 0x3f803f80
    s_mov_b32 s28, 65830916
    s_mov_b32 s30, 65835008
    s_mov_b32 s48, 65273856
    s_mov_b32 s49, 65306624
    s_mov_b32 s50, 65339392
    s_and_b32 s0, s14, 3
    s_lshl_b32 s0, s0, 13
    s_add_u32 s1, s48, s0
    s_add_u32 s3, s1, 4096
    s_mov_b32 s59, 65929216
    v_lshlrev_b32 v0, 4, v1
    v_and_b32 v0, 1792, v0
    s_lshl_b32 s51, s14, 2
    v_add_u32 v0, s51, v0
    s_branch L_cload
L_cstart0:
    ds_read_b128 v[80:83], v3 offset:0
    ds_read_b128 v[84:87], v3 offset:256
    ds_read_b128 v[88:91], v3 offset:2048
    ds_read_b128 v[92:95], v3 offset:2304
    ds_read_b128 v[96:99], v3 offset:4096
    ds_read_b128 v[100:103], v3 offset:4352
    ds_read_b128 v[104:107], v3 offset:6144
    ds_read_b128 v[108:111], v3 offset:6400
    ds_read_b64_tr_b16 v[72:73], v4 offset:8192
    ds_read_b64_tr_b16 v[74:75], v4 offset:8448
    ds_read_b64_tr_b16 v[76:77], v4 offset:9216
    ds_read_b64_tr_b16 v[78:79], v4 offset:9472
    v_mov_b64 v[48:49], 0
    v_mov_b64 v[50:51], 0
    v_mov_b64 v[52:53], 0
    v_mov_b64 v[54:55], 0
    v_mov_b64 v[56:57], 0
    v_mov_b64 v[58:59], 0
    v_mov_b64 v[60:61], 0
    v_mov_b64 v[62:63], 0
    v_mov_b64 v[64:65], 0
    v_mov_b64 v[66:67], 0
    v_mov_b64 v[68:69], 0
    v_mov_b64 v[70:71], 0
    s_waitcnt lgkmcnt(0)
    s_barrier
.p2align 6
L_top0:
    ds_read_b128 v[80:83], v3 offset:0
    ds_read_b128 v[84:87], v3 offset:256
    ds_read_b128 v[88:91], v3 offset:2048
    v_mov_b64 v[60:61], 0
    v_mov_b64 v[62:63], 0
    v_mov_b64 v[64:65], 0
    v_mov_b64 v[66:67], 0
    v_mov_b64 v[68:69], 0
    v_mov_b64 v[70:71], 0
L_pollA0:
    buffer_load_dwordx4 v[16:19], v1, s[4:7], s1 offen offset:0 sc1
    v_mov_b64 v[48:49], 0
    v_mov_b64 v[50:51], 0
    v_mov_b64 v[52:53], 0
    v_mov_b64 v[54:55], 0
    v_mov_b64 v[56:57], 0
    v_mov_b64 v[58:59], 0
    buffer_load_dwordx4 v[32:35], v1, s[4:7], s3 offen offset:0 sc1
    s_waitcnt vmcnt(1)
    v_max_u32_e64 v124, v16, v18
    v_cmp_eq_u32 vcc, -1, v124
    ds_write_b128 v1, v[16:19] offset:22784
    v_smfmac_f32_16x16x64_bf16 v[56:59], v[16:19], a[128:135], v11
    s_cbranch_vccnz L_againA0
L_gotE0:
    v_smfmac_f32_16x16x64_bf16 v[48:51], v[16:19], a[0:7], v11
    v_smfmac_f32_16x16x64_bf16 v[60:63], v[16:19], a[136:143], v11
    s_waitcnt vmcnt(0)
    v_max_u32 v124, v32, v34
    v_cmp_eq_u32 vcc, -1, v124
    ds_write_b128 v1, v[32:35] offset:26880
    v_smfmac_f32_16x16x64_bf16 v[52:55], v[16:19], a[8:15], v11
    s_cbranch_vccnz L_retryA0
L_lateA0:
    s_waitcnt lgkmcnt(1)
    s_barrier
    v_smfmac_f32_16x16x64_bf16 v[56:59], v[32:35], a[192:199], v11
    ds_read_b128 v[20:23], v1 offset:23808
    v_smfmac_f32_16x16x64_bf16 v[48:51], v[32:35], a[64:71], v11
    ds_read_b128 v[24:27], v1 offset:24832
    v_smfmac_f32_16x16x64_bf16 v[60:63], v[32:35], a[200:207], v11
    ds_read_b128 v[28:31], v1 offset:25856
    v_smfmac_f32_16x16x64_bf16 v[52:55], v[32:35], a[72:79], v11
    v_smfmac_f32_16x16x64_bf16 v[64:67], v[16:19], v[128:135], v11
    v_smfmac_f32_16x16x64_bf16 v[68:71], v[16:19], v[136:143], v11
    s_waitcnt lgkmcnt(2)
    s_barrier
    v_smfmac_f32_16x16x64_bf16 v[56:59], v[20:23], a[144:151], v11
    ds_read_b128 v[36:39], v1 offset:27904
    v_smfmac_f32_16x16x64_bf16 v[48:51], v[20:23], a[16:23], v11
    ds_read_b128 v[40:43], v1 offset:28928
    v_smfmac_f32_16x16x64_bf16 v[60:63], v[20:23], a[152:159], v11
    ds_read_b128 v[44:47], v1 offset:29952
    v_smfmac_f32_16x16x64_bf16 v[52:55], v[20:23], a[24:31], v11
    s_waitcnt lgkmcnt(4)
    v_smfmac_f32_16x16x64_bf16 v[56:59], v[24:27], a[160:167], v11
    v_smfmac_f32_16x16x64_bf16 v[48:51], v[24:27], a[32:39], v11
    v_smfmac_f32_16x16x64_bf16 v[60:63], v[24:27], a[168:175], v11
    v_smfmac_f32_16x16x64_bf16 v[52:55], v[24:27], a[40:47], v11
    s_waitcnt lgkmcnt(3)
    v_smfmac_f32_16x16x64_bf16 v[56:59], v[28:31], a[176:183], v11
    v_smfmac_f32_16x16x64_bf16 v[48:51], v[28:31], a[48:55], v11
    v_smfmac_f32_16x16x64_bf16 v[60:63], v[28:31], a[184:191], v11
    v_smfmac_f32_16x16x64_bf16 v[52:55], v[28:31], a[56:63], v11
    s_waitcnt lgkmcnt(2)
    v_smfmac_f32_16x16x64_bf16 v[56:59], v[36:39], a[208:215], v11
    v_smfmac_f32_16x16x64_bf16 v[48:51], v[36:39], a[80:87], v11
    v_smfmac_f32_16x16x64_bf16 v[60:63], v[36:39], a[216:223], v11
    v_smfmac_f32_16x16x64_bf16 v[52:55], v[36:39], a[88:95], v11
    s_waitcnt lgkmcnt(0)
    v_smfmac_f32_16x16x64_bf16 v[56:59], v[40:43], a[224:231], v11
    v_smfmac_f32_16x16x64_bf16 v[48:51], v[40:43], a[96:103], v11
    v_smfmac_f32_16x16x64_bf16 v[56:59], v[44:47], a[240:247], v11
    v_smfmac_f32_16x16x64_bf16 v[48:51], v[44:47], a[112:119], v11
    v_smfmac_f32_16x16x64_bf16 v[60:63], v[40:43], a[232:239], v11
    v_smfmac_f32_16x16x64_bf16 v[60:63], v[44:47], a[248:255], v11
    v_add_f32 v56, v56, v57
    v_smfmac_f32_16x16x64_bf16 v[52:55], v[40:43], a[104:111], v11
    v_add_f32_e64 v58, v58, v59
    v_smfmac_f32_16x16x64_bf16 v[52:55], v[44:47], a[120:127], v11
    v_add_f32 v48, v48, v49
    v_add_f32 v50, v50, v51
    v_cvt_pk_bf16_f32 v56, v56, v58
    v_cvt_pk_bf16_f32 v57, v48, v50
    ds_write_b64 v6, v[56:57] offset:16384
L_qkdone0:
    v_add_f32 v60, v60, v61
    v_add_f32 v62, v62, v63
    v_cvt_pk_bf16_f32 v60, v60, v62
    v_add_f32 v52, v52, v53
    v_add_f32 v54, v54, v55
    v_cvt_pk_bf16_f32 v61, v52, v54
    ds_write_b64 v6, v[60:61] offset:16512
    v_mov_b64_e64 v[112:113], -1
    buffer_store_dwordx2 v[112:113], v10, s[4:7], s50 offen
    v_smfmac_f32_16x16x64_bf16 v[64:67], v[20:23], v[144:151], v11
    v_smfmac_f32_16x16x64_bf16 v[68:71], v[20:23], v[152:159], v11
    v_smfmac_f32_16x16x64_bf16 v[64:67], v[24:27], v[160:167], v11
    v_smfmac_f32_16x16x64_bf16 v[68:71], v[24:27], v[168:175], v11
    s_waitcnt lgkmcnt(0)
    s_barrier
    ds_read_b64_tr_b16 v[48:49], v5 offset:16384
    ds_read_b64_tr_b16 v[50:51], v5 offset:16416
    ds_read_b64_tr_b16 v[52:53], v5 offset:16640
    ds_read_b64_tr_b16 v[54:55], v5 offset:16672
    ds_read_b64_tr_b16 v[56:57], v5 offset:16896
    ds_read_b64_tr_b16 v[58:59], v5 offset:16928
    ds_read_b64_tr_b16 v[60:61], v5 offset:17152
    ds_read_b64_tr_b16 v[62:63], v5 offset:17184
    v_smfmac_f32_16x16x64_bf16 v[64:67], v[28:31], v[176:183], v11
    v_smfmac_f32_16x16x64_bf16 v[68:71], v[28:31], v[184:191], v11
    ds_read_b128 v[16:19], v2 offset:0
    ds_read_b128 v[20:23], v2 offset:1024
    s_waitcnt lgkmcnt(8)
    v_mfma_f32_16x16x32_bf16 v[116:119], v[80:83], v[48:51], 0
    ds_read_b128 v[24:27], v2 offset:2048
    v_mfma_f32_16x16x32_bf16 v[120:123], v[84:87], v[48:51], 0
    ds_read_b128 v[28:31], v2 offset:3072
    v_mfma_f32_16x16x32_bf16 v[124:127], v[48:51], v[48:51], 0
    ds_read_b128 v[80:83], v2 offset:4096
    s_waitcnt lgkmcnt(9)
    v_mfma_f32_16x16x32_bf16 v[116:119], v[88:91], v[52:55], v[116:119]
    ds_read_b128 v[84:87], v2 offset:5120
    v_mfma_f32_16x16x32_bf16 v[120:123], v[92:95], v[52:55], v[120:123]
    ds_read_b128 v[88:91], v2 offset:6144
    v_mfma_f32_16x16x32_bf16 v[124:127], v[52:55], v[52:55], v[124:127]
    ds_read_b128 v[92:95], v2 offset:7168
    s_waitcnt lgkmcnt(10)
    v_mfma_f32_16x16x32_bf16 v[116:119], v[96:99], v[56:59], v[116:119]
    ds_read_b128 v[48:51], v2 offset:12288
    v_mfma_f32_16x16x32_bf16 v[120:123], v[100:103], v[56:59], v[120:123]
    ds_read_b128 v[52:55], v2 offset:13312
    v_mfma_f32_16x16x32_bf16 v[124:127], v[56:59], v[56:59], v[124:127]
    ds_read_b128 v[96:99], v2 offset:8192
    s_waitcnt lgkmcnt(11)
    v_mfma_f32_16x16x32_bf16 v[116:119], v[104:107], v[60:63], v[116:119]
    ds_read_b128 v[100:103], v2 offset:9216
    v_mfma_f32_16x16x32_bf16 v[120:123], v[108:111], v[60:63], v[120:123]
    ds_read_b128 v[104:107], v2 offset:10240
    v_mfma_f32_16x16x32_bf16 v[124:127], v[60:63], v[60:63], v[124:127]
    ds_read_b128 v[108:111], v2 offset:11264
    ds_read_b128 v[56:59], v2 offset:14336
    s_waitcnt lgkmcnt(11)
    v_smfmac_f32_16x16x64_bf16 v[64:67], v[32:35], v[16:23], v11
    ds_read_b128 v[60:63], v2 offset:15360
    v_max3_f32 v112, v116, v117, v118
    v_smfmac_f32_16x16x64_bf16 v[68:71], v[32:35], v[24:31], v11
    v_max3_f32 v113, v119, v120, v121
    s_waitcnt lgkmcnt(8)
    v_smfmac_f32_16x16x64_bf16 v[64:67], v[36:39], v[80:87], v11
    v_max3_f32 v112, v112, v122, v123
    v_max3_f32 v126, v113, v124, v125
    v_smfmac_f32_16x16x64_bf16 v[68:71], v[36:39], v[88:95], v11
    v_max_f32 v127, v112, v126
    v_max_f32_e64 v126, v112, v126
    s_waitcnt lgkmcnt(4)
    v_smfmac_f32_16x16x64_bf16 v[64:67], v[44:47], v[48:55], v11
    s_nop 0
    v_permlane16_swap_b32 v126, v127
    v_smfmac_f32_16x16x64_bf16 v[64:67], v[40:43], v[96:103], v11
    v_max_f32 v112, v126, v127
    v_max_f32_e64 v113, v126, v127
    s_waitcnt lgkmcnt(0)
    v_smfmac_f32_16x16x64_bf16 v[68:71], v[40:43], v[104:111], v11
    s_nop 0
    v_permlane32_swap_b32 v112, v113
    v_smfmac_f32_16x16x64_bf16 v[68:71], v[44:47], v[56:63], v11
    v_max_f32 v126, v112, v113
    v_mul_f32 v126, s55, v126
    v_mov_b64 v[16:17], s[78:79]
    v_mov_b64 v[18:19], s[78:79]
    v_pk_fma_f32 v[116:117], v[116:117], s[32:33], v[126:127] op_sel_hi:[1,1,0] neg_lo:[0,0,1] neg_hi:[0,0,1]
    v_pk_fma_f32 v[118:119], v[118:119], s[32:33], v[126:127] op_sel_hi:[1,1,0] neg_lo:[0,0,1] neg_hi:[0,0,1]
    v_pk_fma_f32 v[120:121], v[120:121], s[32:33], v[126:127] op_sel_hi:[1,1,0] neg_lo:[0,0,1] neg_hi:[0,0,1]
    v_pk_fma_f32 v[122:123], v[122:123], s[32:33], v[126:127] op_sel_hi:[1,1,0] neg_lo:[0,0,1] neg_hi:[0,0,1]
    v_pk_fma_f32 v[124:125], v[124:125], s[32:33], v[126:127] op_sel_hi:[1,1,0] neg_lo:[0,0,1] neg_hi:[0,0,1]
    v_exp_f32 v116, v116
    v_exp_f32 v117, v117
    v_exp_f32_e64 v118, v118
    v_cvt_pk_bf16_f32 v112, v116, v117
    v_exp_f32 v119, v119
    v_exp_f32 v120, v120
    v_cvt_pk_bf16_f32 v113, v118, v119
    v_exp_f32 v121, v121
    v_exp_f32 v122, v122
    v_cvt_pk_bf16_f32 v114, v120, v121
    v_exp_f32 v123, v123
    v_exp_f32 v124, v124
    v_cvt_pk_bf16_f32 v115, v122, v123
    v_exp_f32 v125, v125
    v_add_f32 v64, v64, v65
    v_mfma_f32_16x16x32_bf16 v[20:23], v[16:19], v[112:115], 0
    v_cvt_pk_bf16_f32 v124, v124, v125
    v_mov_b32_e64 v125, 0
    v_mfma_f32_16x16x32_bf16 v[24:27], v[72:75], v[112:115], 0
    v_add_f32 v66, v66, v67
    v_add_f32 v68, v68, v69
    v_mfma_f32_16x16x32_bf16 v[28:31], v[76:79], v[112:115], 0
    v_cvt_pk_bf16_f32 v64, v64, v66
    v_mov_b32_e64 v65, 0
    v_mfma_f32_16x16x16_bf16 v[20:23], v[16:17], v[124:125], v[20:23]
    v_add_f32 v70, v70, v71
    v_mov_b32 v69, 0
    v_cvt_pk_bf16_f32 v68, v68, v70
    v_mfma_f32_16x16x16_bf16 v[24:27], v[64:65], v[124:125], v[24:27]
    ds_read_b128 v[80:83], v2 offset:16384
    v_mfma_f32_16x16x16_bf16 v[28:31], v[68:69], v[124:125], v[28:31]
    v_rcp_f32_e64 v20, v20
    ds_read_b128 v[84:87], v2 offset:17408
    ds_read_b128 v[88:91], v2 offset:24576
    ds_read_b128 v[92:95], v2 offset:25600
    v_pk_mul_f32 v[24:25], v[24:25], v[20:21] op_sel_hi:[1,0]
    v_pk_mul_f32 v[26:27], v[26:27], v[20:21] op_sel_hi:[1,0]
    v_cvt_pk_bf16_f32 v16, v24, v25
    v_cvt_pk_bf16_f32 v17, v26, v27
    v_pk_mul_f32 v[28:29], v[28:29], v[20:21] op_sel_hi:[1,0]
    v_pk_mul_f32 v[30:31], v[30:31], v[20:21] op_sel_hi:[1,0]
    v_cvt_pk_bf16_f32 v18, v28, v29
    v_cvt_pk_bf16_f32 v19, v30, v31
    s_mov_b64 exec, s[56:57]
    ds_write_b128 v7, v[16:19] offset:20736
    s_mov_b64 exec, -1
    v_mov_b64 v[112:113], 0
    v_mov_b64 v[114:115], 0
    v_mov_b64 v[116:117], 0
    v_mov_b64 v[118:119], 0
    v_mov_b64 v[120:121], 0
    v_mov_b64 v[122:123], 0
    v_mov_b64 v[124:125], 0
    v_mov_b64 v[126:127], 0
    ds_read_b128 v[48:51], v2 offset:18432
    ds_read_b128 v[52:55], v2 offset:19456
    s_waitcnt lgkmcnt(2)
    s_barrier
    ds_read_b128 v[72:75], v1 offset:20736
    ds_read_b128 v[76:79], v1 offset:21760
    buffer_load_dword v65, v0, s[4:7], s59 offen sc1
    v_mov_b64 v[16:17], 0
    v_mov_b64 v[18:19], 0
    v_mov_b64 v[20:21], 0
    v_mov_b64 v[22:23], 0
    buffer_load_dword v66, v0, s[4:7], s59 offen sc1
    v_mov_b64 v[24:25], 0
    v_mov_b64 v[26:27], 0
    v_mov_b64 v[28:29], 0
    v_mov_b64 v[30:31], 0
    buffer_load_dword v67, v0, s[4:7], s59 offen sc1
    ds_read_b128 v[96:99], v2 offset:26624
    ds_read_b128 v[100:103], v2 offset:27648
    ds_read_b128 v[104:107], v2 offset:20480
    s_waitcnt lgkmcnt(4)
    v_smfmac_f32_16x16x64_bf16 v[112:115], v[72:75], v[192:199], v11
    ds_read_b128 v[108:111], v2 offset:21504
    buffer_load_dword v69, v0, s[4:7], s59 offen sc1
    s_waitcnt lgkmcnt(4)
    v_smfmac_f32_16x16x64_bf16 v[112:115], v[76:79], v[200:207], v11
    ds_read_b128 v[56:59], v2 offset:28672
    v_smfmac_f32_16x16x64_bf16 v[116:119], v[72:75], v[208:215], v11
    ds_read_b128 v[60:63], v2 offset:29696
    v_smfmac_f32_16x16x64_bf16 v[116:119], v[76:79], v[216:223], v11
    v_add_f32 v112, v112, v113
    v_add_f32 v114, v114, v115
    buffer_load_dword v70, v0, s[4:7], s59 offen sc1
    v_smfmac_f32_16x16x64_bf16 v[120:123], v[72:75], v[224:231], v11
    ds_read_b128 v[32:35], v2 offset:22528
    v_smfmac_f32_16x16x64_bf16 v[120:123], v[76:79], v[232:239], v11
    v_add_f32 v116, v116, v117
    v_add_f32 v118, v118, v119
    v_smfmac_f32_16x16x64_bf16 v[124:127], v[72:75], v[240:247], v11
    v_cvt_pk_bf16_f32 v112, v112, v116
    v_cvt_pk_bf16_f32 v114, v114, v118
    v_smfmac_f32_16x16x64_bf16 v[124:127], v[76:79], v[248:255], v11
    v_bfi_b32 v112, 1, s47, v112
    v_add_f32 v120, v120, v121
    v_add_f32 v122, v122, v123
    v_smfmac_f32_16x16x64_bf16 v[16:19], v[72:75], v[80:87], v11
    ds_read_b128 v[36:39], v2 offset:23552
    v_smfmac_f32_16x16x64_bf16 v[16:19], v[76:79], v[88:95], v11
    v_add_f32 v124, v124, v125
    v_add_f32 v126, v126, v127
    v_cvt_pk_bf16_f32 v113, v120, v124
    v_cvt_pk_bf16_f32 v115, v122, v126
    buffer_store_dwordx4 v[112:115], v8, s[4:7], s45 offen
    ds_read_b128 v[40:43], v2 offset:30720
    v_smfmac_f32_16x16x64_bf16 v[20:23], v[72:75], v[48:55], v11
    ds_read_b128 v[44:47], v2 offset:31744
    s_waitcnt lgkmcnt(8)
    v_smfmac_f32_16x16x64_bf16 v[20:23], v[76:79], v[96:103], v11
    v_add_f32 v16, v16, v17
    v_add_f32 v18, v18, v19
    s_waitcnt lgkmcnt(6)
    v_smfmac_f32_16x16x64_bf16 v[24:27], v[72:75], v[104:111], v11
    s_waitcnt lgkmcnt(4)
    v_smfmac_f32_16x16x64_bf16 v[24:27], v[76:79], v[56:63], v11
    v_add_f32 v20, v20, v21
    v_add_f32 v22, v22, v23
    s_waitcnt lgkmcnt(2)
    v_smfmac_f32_16x16x64_bf16 v[28:31], v[72:75], v[32:39], v11
    v_cvt_pk_bf16_f32 v16, v16, v20
    v_cvt_pk_bf16_f32 v18, v18, v22
    s_waitcnt lgkmcnt(0)
    v_smfmac_f32_16x16x64_bf16 v[28:31], v[76:79], v[40:47], v11
    v_bfi_b32 v16, 1, s47, v16
    v_add_f32 v24, v24, v25
    v_add_f32 v26, v26, v27
    s_nop 4
    v_add_f32 v28, v28, v29
    v_add_f32 v30, v30, v31
    v_cvt_pk_bf16_f32 v17, v24, v28
    v_cvt_pk_bf16_f32 v19, v26, v30
    buffer_store_dwordx4 v[16:19], v8, s[4:7], s46 offen
    ds_write_b32 v6, v64 offset:16388
    ds_write_b32 v6, v68 offset:16516
    buffer_load_dword v71, v0, s[4:7], s59 offen sc1
    s_mov_b32 s2, s44
    s_waitcnt vmcnt(7)
    v_cmp_gt_i32 vcc, s2, v65
    s_cbranch_vccnz L_hint0
L_hintok:
    s_waitcnt lgkmcnt(0)
    s_barrier
    buffer_load_dwordx4 v[32:35], v9, s[4:7], s28 offen sc1
    buffer_load_dwordx4 v[36:39], v9, s[4:7], s29 offen sc1
    buffer_load_dwordx4 v[40:43], v9, s[4:7], s30 offen sc1
    buffer_load_dwordx4 v[44:47], v9, s[4:7], s31 offen sc1
    ds_read_b128 v[92:95], v3 offset:2304
    ds_read_b128 v[96:99], v3 offset:4096
    ds_read_b128 v[100:103], v3 offset:4352
    ds_read_b128 v[104:107], v3 offset:6144
    ds_read_b128 v[108:111], v3 offset:6400
    ds_read_b64_tr_b16 v[72:73], v4 offset:8192
    ds_read_b64_tr_b16 v[74:75], v4 offset:8448
    ds_read_b64_tr_b16 v[76:77], v4 offset:9216
    ds_read_b64_tr_b16 v[78:79], v4 offset:9472
    s_add_u32 s44, s44, 1
    s_mov_b32 s51, s48
    s_mov_b32 s48, s49
    s_mov_b32 s49, s50
    s_mov_b32 s50, s51
    s_add_u32 s1, s48, s0
    s_add_u32 s3, s1, 4096
L_sumB0:
    s_waitcnt vmcnt(3)
    v_mfma_f32_16x16x32_bf16 v[20:23], v[12:15], v[32:35], 0
    s_waitcnt vmcnt(2)
    v_mfma_f32_16x16x32_bf16 v[20:23], v[12:15], v[36:39], v[20:23]
    v_bitop3_b32 v28, v32, v36, s47 bitop3:0x81
    s_waitcnt vmcnt(1)
    v_mfma_f32_16x16x32_bf16 v[20:23], v[12:15], v[40:43], v[20:23]
    s_waitcnt vmcnt(0)
    v_mfma_f32_16x16x32_bf16 v[20:23], v[12:15], v[44:47], v[20:23]
    v_bitop3_b32 v29, v40, v44, s47 bitop3:0x81
    v_bitop3_b32 v28, v28, v29, 1 bitop3:0x80
    v_cmp_eq_u32 vcc, 0, v28
    s_nop 4
    v_add_f32_dpp v20, v20, v20 row_ror:8 row_mask:0xf bank_mask:0xf
    v_add_f32_dpp v21, v21, v21 row_ror:8 row_mask:0xf bank_mask:0xf
    v_add_f32_dpp v22, v22, v22 row_ror:8 row_mask:0xf bank_mask:0xf
    v_add_f32_dpp v23, v23, v23 row_ror:8 row_mask:0xf bank_mask:0xf
    v_cvt_pk_bf16_f32 v24, v20, v21
    v_cvt_pk_bf16_f32 v25, v22, v23
    s_cbranch_vccnz L_retryB0
    buffer_store_dwordx2 v[24:25], v10, s[4:7], s48 offen
    s_xor_b32 s47, s47, 1
    s_waitcnt lgkmcnt(0)
    s_cmp_lt_u32 s44, 63
    s_barrier
    s_cbranch_scc1 L_top0
    s_branch L_final0
L_hint0:
    buffer_load_dword v65, v0, s[4:7], s59 offen sc1
    s_waitcnt vmcnt(7)
    v_cmp_gt_i32 vcc, s2, v66
    s_cbranch_vccz L_hintok
    buffer_load_dword v66, v0, s[4:7], s59 offen sc1
    s_waitcnt vmcnt(7)
    v_cmp_gt_i32 vcc, s2, v67
    s_cbranch_vccz L_hintok
    buffer_load_dword v67, v0, s[4:7], s59 offen sc1
    s_waitcnt vmcnt(7)
    v_cmp_gt_i32 vcc, s2, v69
    s_cbranch_vccz L_hintok
    buffer_load_dword v69, v0, s[4:7], s59 offen sc1
    s_waitcnt vmcnt(7)
    v_cmp_gt_i32 vcc, s2, v70
    s_cbranch_vccz L_hintok
    buffer_load_dword v70, v0, s[4:7], s59 offen sc1
    s_waitcnt vmcnt(5)
    v_cmp_gt_i32 vcc, s2, v71
    s_cbranch_vccz L_hintok
    buffer_load_dword v71, v0, s[4:7], s59 offen sc1
    s_mov_b32 s52, 300
L_hintl:
    s_waitcnt vmcnt(5)
    v_cmp_gt_i32 vcc, s2, v65
    s_cbranch_vccz L_hintok
    buffer_load_dword v65, v0, s[4:7], s59 offen sc1
    s_waitcnt vmcnt(5)
    v_cmp_gt_i32 vcc, s2, v66
    s_cbranch_vccz L_hintok
    buffer_load_dword v66, v0, s[4:7], s59 offen sc1
    s_waitcnt vmcnt(5)
    v_cmp_gt_i32 vcc, s2, v67
    s_cbranch_vccz L_hintok
    buffer_load_dword v67, v0, s[4:7], s59 offen sc1
    s_waitcnt vmcnt(5)
    v_cmp_gt_i32 vcc, s2, v69
    s_cbranch_vccz L_hintok
    buffer_load_dword v69, v0, s[4:7], s59 offen sc1
    s_waitcnt vmcnt(5)
    v_cmp_gt_i32 vcc, s2, v70
    s_cbranch_vccz L_hintok
    buffer_load_dword v70, v0, s[4:7], s59 offen sc1
    s_waitcnt vmcnt(5)
    v_cmp_gt_i32 vcc, s2, v71
    s_cbranch_vccz L_hintok
    buffer_load_dword v71, v0, s[4:7], s59 offen sc1
    s_sub_u32 s52, s52, 1
    s_cbranch_scc0 L_hintl
    s_branch L_hintok
L_againA0:
    s_waitcnt vmcnt(0) lgkmcnt(0)
    s_nop 7
    v_mov_b64 v[56:57], 0
    v_mov_b64_e64 v[58:59], 0
    s_sub_u32 s96, s96, 1
    s_cbranch_scc0 L_pollA0
    s_branch L_abort
L_retryA0:
L_retry20:
    s_waitcnt lgkmcnt(0)
    buffer_load_dwordx4 v[32:35], v1, s[4:7], s3 offen offset:0 sc1
    s_waitcnt vmcnt(0)
    v_max_u32_e64 v124, v32, v34
    v_cmp_eq_u32 vcc, -1, v124
    ds_write_b128 v1, v[32:35] offset:26880
    s_cbranch_vccz L_lateA0
    s_sub_u32 s96, s96, 1
    s_cbranch_scc0 L_retry20
    s_branch L_abort
L_againAf0:
    s_waitcnt vmcnt(0) lgkmcnt(0)
    s_nop 7
    v_mov_b64 v[56:57], 0
    v_mov_b64 v[58:59], 0
    s_sub_u32 s96, s96, 1
    s_cbranch_scc0 L_pollAf0
    s_branch L_abort
L_retryAf0:
L_retry2f0:
    s_waitcnt lgkmcnt(0)
    buffer_load_dwordx4 v[32:35], v1, s[4:7], s3 offen offset:0 sc1
    s_waitcnt vmcnt(0)
    v_max_u32_e64 v124, v32, v34
    v_cmp_eq_u32 vcc, -1, v124
    ds_write_b128 v1, v[32:35] offset:26880
    s_cbranch_vccz L_lateAf0
    s_sub_u32 s96, s96, 1
    s_cbranch_scc0 L_retry2f0
    s_branch L_abort
L_retryB0:
    buffer_load_dwordx4 v[32:35], v9, s[4:7], s28 offen sc1
    buffer_load_dwordx4 v[36:39], v9, s[4:7], s29 offen sc1
    buffer_load_dwordx4 v[40:43], v9, s[4:7], s30 offen sc1
    buffer_load_dwordx4 v[44:47], v9, s[4:7], s31 offen sc1
    s_sub_u32 s96, s96, 1
    s_cbranch_scc0 L_sumB0
    s_branch L_abort
L_final0:
    ds_read_b128 v[80:83], v3 offset:0
    ds_read_b128 v[84:87], v3 offset:256
    ds_read_b128 v[88:91], v3 offset:2048
    v_mov_b64 v[60:61], 0
    v_mov_b64 v[62:63], 0
    v_mov_b64 v[64:65], 0
    v_mov_b64 v[66:67], 0
    v_mov_b64 v[68:69], 0
    v_mov_b64_e64 v[70:71], 0
L_pollAf0:
    buffer_load_dwordx4 v[16:19], v1, s[4:7], s1 offen offset:0 sc1
    v_mov_b64 v[48:49], 0
    v_mov_b64 v[50:51], 0
    v_mov_b64 v[52:53], 0
    v_mov_b64 v[54:55], 0
    v_mov_b64 v[56:57], 0
    v_mov_b64 v[58:59], 0
    buffer_load_dwordx4 v[32:35], v1, s[4:7], s3 offen offset:0 sc1
    s_waitcnt vmcnt(1)
    v_max_u32_e64 v124, v16, v18
    v_cmp_eq_u32 vcc, -1, v124
    ds_write_b128 v1, v[16:19] offset:22784
    v_smfmac_f32_16x16x64_bf16 v[56:59], v[16:19], a[128:135], v11
    s_cbranch_vccnz L_againAf0
L_gotEf0:
    v_smfmac_f32_16x16x64_bf16 v[48:51], v[16:19], a[0:7], v11
    v_smfmac_f32_16x16x64_bf16 v[60:63], v[16:19], a[136:143], v11
    s_waitcnt vmcnt(0)
    v_max_u32 v124, v32, v34
    v_cmp_eq_u32 vcc, -1, v124
    ds_write_b128 v1, v[32:35] offset:26880
    v_smfmac_f32_16x16x64_bf16 v[52:55], v[16:19], a[8:15], v11
    s_cbranch_vccnz L_retryAf0
L_lateAf0:
    s_waitcnt lgkmcnt(1)
    s_barrier
    ds_read_b128 v[20:23], v1 offset:23808
    ds_read_b128 v[24:27], v1 offset:24832
    ds_read_b128 v[28:31], v1 offset:25856
    v_smfmac_f32_16x16x64_bf16 v[56:59], v[32:35], a[192:199], v11
    v_smfmac_f32_16x16x64_bf16 v[60:63], v[32:35], a[200:207], v11
    v_smfmac_f32_16x16x64_bf16 v[64:67], v[16:19], v[128:135], v11
    v_smfmac_f32_16x16x64_bf16 v[68:71], v[16:19], v[136:143], v11
    s_waitcnt lgkmcnt(2)
    s_barrier
    v_smfmac_f32_16x16x64_bf16 v[56:59], v[20:23], a[144:151], v11
    ds_read_b128 v[36:39], v1 offset:27904
    v_smfmac_f32_16x16x64_bf16 v[60:63], v[20:23], a[152:159], v11
    ds_read_b128 v[40:43], v1 offset:28928
    v_smfmac_f32_16x16x64_bf16 v[64:67], v[20:23], v[144:151], v11
    ds_read_b128 v[44:47], v1 offset:29952
    v_smfmac_f32_16x16x64_bf16 v[68:71], v[20:23], v[152:159], v11
    ds_read_b128 v[80:83], v2 offset:0
    s_waitcnt lgkmcnt(5)
    v_smfmac_f32_16x16x64_bf16 v[56:59], v[24:27], a[160:167], v11
    ds_read_b128 v[84:87], v2 offset:1024
    v_smfmac_f32_16x16x64_bf16 v[60:63], v[24:27], a[168:175], v11
    ds_read_b128 v[88:91], v2 offset:2048
    v_smfmac_f32_16x16x64_bf16 v[64:67], v[24:27], v[160:167], v11
    ds_read_b128 v[92:95], v2 offset:3072
    v_smfmac_f32_16x16x64_bf16 v[68:71], v[24:27], v[168:175], v11
    ds_read_b128 v[96:99], v2 offset:4096
    s_waitcnt lgkmcnt(8)
    v_smfmac_f32_16x16x64_bf16 v[56:59], v[28:31], a[176:183], v11
    ds_read_b128 v[100:103], v2 offset:5120
    v_smfmac_f32_16x16x64_bf16 v[60:63], v[28:31], a[184:191], v11
    ds_read_b128 v[104:107], v2 offset:6144
    v_smfmac_f32_16x16x64_bf16 v[64:67], v[28:31], v[176:183], v11
    ds_read_b128 v[108:111], v2 offset:7168
    v_smfmac_f32_16x16x64_bf16 v[68:71], v[28:31], v[184:191], v11
    v_lshrrev_b32 v120, 8, v1
    v_lshlrev_b32 v120, 10, v120
    v_bfe_u32 v121, v1, 4, 4
    v_lshl_add_u32 v120, v121, 3, v120
    s_lshl_b32 s52, s14, 12
    s_add_u32 s52, s52, 66977792
    s_waitcnt lgkmcnt(6)
    v_smfmac_f32_16x16x64_bf16 v[64:67], v[32:35], v[80:87], v11
    ds_read_b128 v[80:83], v2 offset:8192
    ds_read_b128 v[84:87], v2 offset:9216
    v_smfmac_f32_16x16x64_bf16 v[56:59], v[36:39], a[208:215], v11
    s_waitcnt lgkmcnt(6)
    v_smfmac_f32_16x16x64_bf16 v[68:71], v[32:35], v[88:95], v11
    ds_read_b128 v[88:91], v2 offset:10240
    ds_read_b128 v[92:95], v2 offset:11264
    v_smfmac_f32_16x16x64_bf16 v[60:63], v[36:39], a[216:223], v11
    s_waitcnt lgkmcnt(6)
    v_smfmac_f32_16x16x64_bf16 v[64:67], v[36:39], v[96:103], v11
    ds_read_b128 v[96:99], v2 offset:12288
    ds_read_b128 v[100:103], v2 offset:13312
    v_smfmac_f32_16x16x64_bf16 v[56:59], v[40:43], a[224:231], v11
    s_waitcnt lgkmcnt(6)
    v_smfmac_f32_16x16x64_bf16 v[68:71], v[36:39], v[104:111], v11
    ds_read_b128 v[104:107], v2 offset:14336
    ds_read_b128 v[108:111], v2 offset:15360
    v_smfmac_f32_16x16x64_bf16 v[60:63], v[40:43], a[232:239], v11
    s_waitcnt lgkmcnt(6)
    v_smfmac_f32_16x16x64_bf16 v[64:67], v[40:43], v[80:87], v11
    v_smfmac_f32_16x16x64_bf16 v[56:59], v[44:47], a[240:247], v11
    s_waitcnt lgkmcnt(4)
    v_smfmac_f32_16x16x64_bf16 v[68:71], v[40:43], v[88:95], v11
    v_smfmac_f32_16x16x64_bf16 v[60:63], v[44:47], a[248:255], v11
    s_waitcnt lgkmcnt(2)
    v_smfmac_f32_16x16x64_bf16 v[64:67], v[44:47], v[96:103], v11
    s_waitcnt lgkmcnt(0)
    v_smfmac_f32_16x16x64_bf16 v[68:71], v[44:47], v[104:111], v11
    v_add_f32 v56, v56, v57
    v_add_f32 v58, v58, v59
    v_cvt_pk_bf16_f32 v56, v56, v58
    v_add_f32 v60, v60, v61
    v_add_f32 v62, v62, v63
    v_cvt_pk_bf16_f32 v60, v60, v62
    s_nop 1
    v_add_f32 v64, v64, v65
    v_add_f32_e64 v66, v66, v67
    v_cvt_pk_bf16_f32 v57, v64, v66
    buffer_store_dwordx2 v[56:57], v120, s[4:7], s52 offen offset:0 sc1
    v_add_f32 v68, v68, v69
    v_add_f32 v70, v70, v71
    v_cvt_pk_bf16_f32 v61, v68, v70
    buffer_store_dwordx2 v[60:61], v120, s[4:7], s52 offen offset:128 sc1
    s_waitcnt vmcnt(0)
    s_endpgm
L_cstart1:
    ds_read_b128 v[80:83], v3 offset:0
    ds_read_b128 v[84:87], v3 offset:256
    ds_read_b128 v[88:91], v3 offset:2048
    ds_read_b128 v[92:95], v3 offset:2304
    ds_read_b128 v[96:99], v3 offset:4096
    ds_read_b128 v[100:103], v3 offset:4352
    ds_read_b128 v[104:107], v3 offset:6144
    ds_read_b128 v[108:111], v3 offset:6400
    ds_read_b64_tr_b16 v[72:73], v4 offset:10240
    ds_read_b64_tr_b16 v[74:75], v4 offset:10496
    ds_read_b64_tr_b16 v[76:77], v4 offset:11264
    ds_read_b64_tr_b16 v[78:79], v4 offset:11520
    v_mov_b64 v[48:49], 0
    v_mov_b64 v[50:51], 0
    v_mov_b64 v[52:53], 0
    v_mov_b64 v[54:55], 0
    v_mov_b64 v[56:57], 0
    v_mov_b64 v[58:59], 0
    v_mov_b64 v[60:61], 0
    v_mov_b64 v[62:63], 0
    v_mov_b64 v[64:65], 0
    v_mov_b64 v[66:67], 0
    v_mov_b64 v[68:69], 0
    v_mov_b64 v[70:71], 0
    s_waitcnt lgkmcnt(0)
    s_barrier
.p2align 6
L_top1:
    ds_read_b128 v[80:83], v3 offset:0
    ds_read_b128 v[84:87], v3 offset:256
    ds_read_b128 v[88:91], v3 offset:2048
    v_mov_b64 v[60:61], 0
    v_mov_b64 v[62:63], 0
    v_mov_b64 v[64:65], 0
    v_mov_b64 v[66:67], 0
    v_mov_b64 v[68:69], 0
    v_mov_b64 v[70:71], 0
L_pollA1:
    buffer_load_dwordx4 v[20:23], v1, s[4:7], s1 offen offset:1024 sc1
    v_mov_b64 v[48:49], 0
    v_mov_b64 v[50:51], 0
    v_mov_b64 v[52:53], 0
    v_mov_b64 v[54:55], 0
    v_mov_b64 v[56:57], 0
    v_mov_b64 v[58:59], 0
    buffer_load_dwordx4 v[36:39], v1, s[4:7], s3 offen offset:1024 sc1
    s_waitcnt vmcnt(1)
    v_max_u32_e64 v124, v20, v22
    v_cmp_eq_u32 vcc, -1, v124
    ds_write_b128 v1, v[20:23] offset:23808
    v_smfmac_f32_16x16x64_bf16 v[56:59], v[20:23], a[144:151], v11
    s_cbranch_vccnz L_againA1
L_gotE1:
    v_smfmac_f32_16x16x64_bf16 v[48:51], v[20:23], a[16:23], v11
    v_smfmac_f32_16x16x64_bf16 v[60:63], v[20:23], a[152:159], v11
    s_waitcnt vmcnt(0)
    v_max_u32 v124, v36, v38
    v_cmp_eq_u32 vcc, -1, v124
    ds_write_b128 v1, v[36:39] offset:27904
    v_smfmac_f32_16x16x64_bf16 v[52:55], v[20:23], a[24:31], v11
    s_cbranch_vccnz L_retryA1
L_lateA1:
    s_waitcnt lgkmcnt(1)
    s_barrier
    v_smfmac_f32_16x16x64_bf16 v[56:59], v[36:39], a[208:215], v11
    ds_read_b128 v[24:27], v1 offset:24832
    v_smfmac_f32_16x16x64_bf16 v[48:51], v[36:39], a[80:87], v11
    ds_read_b128 v[28:31], v1 offset:25856
    v_smfmac_f32_16x16x64_bf16 v[60:63], v[36:39], a[216:223], v11
    ds_read_b128 v[16:19], v1 offset:22784
    v_smfmac_f32_16x16x64_bf16 v[52:55], v[36:39], a[88:95], v11
    v_smfmac_f32_16x16x64_bf16 v[64:67], v[20:23], v[144:151], v11
    v_smfmac_f32_16x16x64_bf16 v[68:71], v[20:23], v[152:159], v11
    s_waitcnt lgkmcnt(2)
    s_barrier
    v_smfmac_f32_16x16x64_bf16 v[56:59], v[24:27], a[160:167], v11
    ds_read_b128 v[40:43], v1 offset:28928
    v_smfmac_f32_16x16x64_bf16 v[48:51], v[24:27], a[32:39], v11
    ds_read_b128 v[44:47], v1 offset:29952
    v_smfmac_f32_16x16x64_bf16 v[60:63], v[24:27], a[168:175], v11
    ds_read_b128 v[32:35], v1 offset:26880
    v_smfmac_f32_16x16x64_bf16 v[52:55], v[24:27], a[40:47], v11
    s_waitcnt lgkmcnt(4)
    v_smfmac_f32_16x16x64_bf16 v[56:59], v[28:31], a[176:183], v11
    v_smfmac_f32_16x16x64_bf16 v[48:51], v[28:31], a[48:55], v11
    v_smfmac_f32_16x16x64_bf16 v[60:63], v[28:31], a[184:191], v11
    v_smfmac_f32_16x16x64_bf16 v[52:55], v[28:31], a[56:63], v11
    s_waitcnt lgkmcnt(3)
    v_smfmac_f32_16x16x64_bf16 v[56:59], v[16:19], a[128:135], v11
    v_smfmac_f32_16x16x64_bf16 v[48:51], v[16:19], a[0:7], v11
    v_smfmac_f32_16x16x64_bf16 v[60:63], v[16:19], a[136:143], v11
    v_smfmac_f32_16x16x64_bf16 v[52:55], v[16:19], a[8:15], v11
    s_waitcnt lgkmcnt(2)
    v_smfmac_f32_16x16x64_bf16 v[56:59], v[40:43], a[224:231], v11
    v_smfmac_f32_16x16x64_bf16 v[48:51], v[40:43], a[96:103], v11
    v_smfmac_f32_16x16x64_bf16 v[60:63], v[40:43], a[232:239], v11
    v_smfmac_f32_16x16x64_bf16 v[52:55], v[40:43], a[104:111], v11
    s_waitcnt lgkmcnt(0)
    v_smfmac_f32_16x16x64_bf16 v[56:59], v[44:47], a[240:247], v11
    v_smfmac_f32_16x16x64_bf16 v[48:51], v[44:47], a[112:119], v11
    v_smfmac_f32_16x16x64_bf16 v[56:59], v[32:35], a[192:199], v11
    v_smfmac_f32_16x16x64_bf16 v[48:51], v[32:35], a[64:71], v11
    v_smfmac_f32_16x16x64_bf16 v[60:63], v[44:47], a[248:255], v11
    v_smfmac_f32_16x16x64_bf16 v[60:63], v[32:35], a[200:207], v11
    v_add_f32 v56, v56, v57
    v_smfmac_f32_16x16x64_bf16 v[52:55], v[44:47], a[120:127], v11
    v_add_f32_e64 v58, v58, v59
    v_smfmac_f32_16x16x64_bf16 v[52:55], v[32:35], a[72:79], v11
    v_add_f32 v48, v48, v49
    v_add_f32 v50, v50, v51
    v_cvt_pk_bf16_f32 v56, v56, v58
    v_cvt_pk_bf16_f32 v57, v48, v50
    ds_write_b64 v6, v[56:57] offset:16640
L_qkdone1:
    v_add_f32 v60, v60, v61
    v_add_f32 v62, v62, v63
    v_cvt_pk_bf16_f32 v60, v60, v62
    v_add_f32 v52, v52, v53
    v_add_f32 v54, v54, v55
    v_cvt_pk_bf16_f32 v61, v52, v54
    ds_write_b64 v6, v[60:61] offset:16768
    v_mov_b64_e64 v[112:113], -1
    buffer_store_dwordx2 v[112:113], v10, s[4:7], s50 offen
    v_smfmac_f32_16x16x64_bf16 v[64:67], v[24:27], v[160:167], v11
    v_smfmac_f32_16x16x64_bf16 v[68:71], v[24:27], v[168:175], v11
    v_smfmac_f32_16x16x64_bf16 v[64:67], v[28:31], v[176:183], v11
    v_smfmac_f32_16x16x64_bf16 v[68:71], v[28:31], v[184:191], v11
    s_waitcnt lgkmcnt(0)
    s_barrier
    ds_read_b64_tr_b16 v[48:49], v5 offset:16384
    ds_read_b64_tr_b16 v[50:51], v5 offset:16416
    ds_read_b64_tr_b16 v[52:53], v5 offset:16640
    ds_read_b64_tr_b16 v[54:55], v5 offset:16672
    ds_read_b64_tr_b16 v[56:57], v5 offset:16896
    ds_read_b64_tr_b16 v[58:59], v5 offset:16928
    ds_read_b64_tr_b16 v[60:61], v5 offset:17152
    ds_read_b64_tr_b16 v[62:63], v5 offset:17184
    v_smfmac_f32_16x16x64_bf16 v[64:67], v[16:19], v[128:135], v11
    v_smfmac_f32_16x16x64_bf16 v[68:71], v[16:19], v[136:143], v11
    ds_read_b128 v[16:19], v2 offset:0
    ds_read_b128 v[20:23], v2 offset:1024
    s_waitcnt lgkmcnt(8)
    v_mfma_f32_16x16x32_bf16 v[116:119], v[80:83], v[48:51], 0
    ds_read_b128 v[24:27], v2 offset:2048
    v_mfma_f32_16x16x32_bf16 v[120:123], v[84:87], v[48:51], 0
    ds_read_b128 v[28:31], v2 offset:3072
    v_mfma_f32_16x16x32_bf16 v[124:127], v[48:51], v[48:51], 0
    ds_read_b128 v[80:83], v2 offset:4096
    s_waitcnt lgkmcnt(9)
    v_mfma_f32_16x16x32_bf16 v[116:119], v[88:91], v[52:55], v[116:119]
    ds_read_b128 v[84:87], v2 offset:5120
    v_mfma_f32_16x16x32_bf16 v[120:123], v[92:95], v[52:55], v[120:123]
    ds_read_b128 v[88:91], v2 offset:6144
    v_mfma_f32_16x16x32_bf16 v[124:127], v[52:55], v[52:55], v[124:127]
    ds_read_b128 v[92:95], v2 offset:7168
    s_waitcnt lgkmcnt(10)
    v_mfma_f32_16x16x32_bf16 v[116:119], v[96:99], v[56:59], v[116:119]
    ds_read_b128 v[48:51], v2 offset:12288
    v_mfma_f32_16x16x32_bf16 v[120:123], v[100:103], v[56:59], v[120:123]
    ds_read_b128 v[52:55], v2 offset:13312
    v_mfma_f32_16x16x32_bf16 v[124:127], v[56:59], v[56:59], v[124:127]
    ds_read_b128 v[96:99], v2 offset:8192
    s_waitcnt lgkmcnt(11)
    v_mfma_f32_16x16x32_bf16 v[116:119], v[104:107], v[60:63], v[116:119]
    ds_read_b128 v[100:103], v2 offset:9216
    v_mfma_f32_16x16x32_bf16 v[120:123], v[108:111], v[60:63], v[120:123]
    ds_read_b128 v[104:107], v2 offset:10240
    v_mfma_f32_16x16x32_bf16 v[124:127], v[60:63], v[60:63], v[124:127]
    ds_read_b128 v[108:111], v2 offset:11264
    ds_read_b128 v[56:59], v2 offset:14336
    s_waitcnt lgkmcnt(11)
    v_smfmac_f32_16x16x64_bf16 v[64:67], v[32:35], v[16:23], v11
    ds_read_b128 v[60:63], v2 offset:15360
    v_max3_f32 v112, v116, v117, v118
    v_smfmac_f32_16x16x64_bf16 v[68:71], v[32:35], v[24:31], v11
    v_max3_f32 v113, v119, v120, v121
    s_waitcnt lgkmcnt(8)
    v_smfmac_f32_16x16x64_bf16 v[64:67], v[36:39], v[80:87], v11
    v_max3_f32 v112, v112, v122, v123
    v_max3_f32 v126, v113, v124, v125
    v_smfmac_f32_16x16x64_bf16 v[68:71], v[36:39], v[88:95], v11
    v_max_f32 v127, v112, v126
    v_max_f32_e64 v126, v112, v126
    s_waitcnt lgkmcnt(4)
    v_smfmac_f32_16x16x64_bf16 v[64:67], v[44:47], v[48:55], v11
    s_nop 0
    v_permlane16_swap_b32 v126, v127
    v_smfmac_f32_16x16x64_bf16 v[64:67], v[40:43], v[96:103], v11
    v_max_f32 v112, v126, v127
    v_max_f32_e64 v113, v126, v127
    s_waitcnt lgkmcnt(0)
    v_smfmac_f32_16x16x64_bf16 v[68:71], v[40:43], v[104:111], v11
    s_nop 0
    v_permlane32_swap_b32 v112, v113
    v_smfmac_f32_16x16x64_bf16 v[68:71], v[44:47], v[56:63], v11
    v_max_f32 v126, v112, v113
    v_mul_f32 v126, s55, v126
    v_mov_b64 v[16:17], s[78:79]
    v_mov_b64 v[18:19], s[78:79]
    v_pk_fma_f32 v[116:117], v[116:117], s[32:33], v[126:127] op_sel_hi:[1,1,0] neg_lo:[0,0,1] neg_hi:[0,0,1]
    v_pk_fma_f32 v[118:119], v[118:119], s[32:33], v[126:127] op_sel_hi:[1,1,0] neg_lo:[0,0,1] neg_hi:[0,0,1]
    v_pk_fma_f32 v[120:121], v[120:121], s[32:33], v[126:127] op_sel_hi:[1,1,0] neg_lo:[0,0,1] neg_hi:[0,0,1]
    v_pk_fma_f32 v[122:123], v[122:123], s[32:33], v[126:127] op_sel_hi:[1,1,0] neg_lo:[0,0,1] neg_hi:[0,0,1]
    v_pk_fma_f32 v[124:125], v[124:125], s[32:33], v[126:127] op_sel_hi:[1,1,0] neg_lo:[0,0,1] neg_hi:[0,0,1]
    v_exp_f32 v116, v116
    v_exp_f32 v117, v117
    v_exp_f32_e64 v118, v118
    v_cvt_pk_bf16_f32 v112, v116, v117
    v_exp_f32 v119, v119
    v_exp_f32 v120, v120
    v_cvt_pk_bf16_f32 v113, v118, v119
    v_exp_f32 v121, v121
    v_exp_f32 v122, v122
    v_cvt_pk_bf16_f32 v114, v120, v121
    v_exp_f32 v123, v123
    v_exp_f32 v124, v124
    v_cvt_pk_bf16_f32 v115, v122, v123
    v_exp_f32 v125, v125
    v_add_f32 v64, v64, v65
    v_mfma_f32_16x16x32_bf16 v[20:23], v[16:19], v[112:115], 0
    v_cvt_pk_bf16_f32 v124, v124, v125
    v_mov_b32_e64 v125, 0
    v_mfma_f32_16x16x32_bf16 v[24:27], v[72:75], v[112:115], 0
    v_add_f32 v66, v66, v67
    v_add_f32 v68, v68, v69
    v_mfma_f32_16x16x32_bf16 v[28:31], v[76:79], v[112:115], 0
    v_cvt_pk_bf16_f32 v64, v64, v66
    v_mov_b32_e64 v65, 0
    v_mfma_f32_16x16x16_bf16 v[20:23], v[16:17], v[124:125], v[20:23]
    v_add_f32 v70, v70, v71
    v_mov_b32 v69, 0
    v_cvt_pk_bf16_f32 v68, v68, v70
    v_mfma_f32_16x16x16_bf16 v[24:27], v[64:65], v[124:125], v[24:27]
    ds_read_b128 v[80:83], v2 offset:16384
    v_mfma_f32_16x16x16_bf16 v[28:31], v[68:69], v[124:125], v[28:31]
    v_rcp_f32_e64 v20, v20
    ds_read_b128 v[84:87], v2 offset:17408
    ds_read_b128 v[88:91], v2 offset:24576
    ds_read_b128 v[92:95], v2 offset:25600
    v_pk_mul_f32 v[24:25], v[24:25], v[20:21] op_sel_hi:[1,0]
    v_pk_mul_f32 v[26:27], v[26:27], v[20:21] op_sel_hi:[1,0]
    v_cvt_pk_bf16_f32 v16, v24, v25
    v_cvt_pk_bf16_f32 v17, v26, v27
    v_pk_mul_f32 v[28:29], v[28:29], v[20:21] op_sel_hi:[1,0]
    v_pk_mul_f32 v[30:31], v[30:31], v[20:21] op_sel_hi:[1,0]
    v_cvt_pk_bf16_f32 v18, v28, v29
    v_cvt_pk_bf16_f32 v19, v30, v31
    s_mov_b64 exec, s[56:57]
    ds_write_b128 v7, v[16:19] offset:21248
    s_mov_b64 exec, -1
    v_mov_b64 v[112:113], 0
    v_mov_b64 v[114:115], 0
    v_mov_b64 v[116:117], 0
    v_mov_b64 v[118:119], 0
    v_mov_b64 v[120:121], 0
    v_mov_b64 v[122:123], 0
    v_mov_b64 v[124:125], 0
    v_mov_b64 v[126:127], 0
    ds_read_b128 v[48:51], v2 offset:18432
    ds_read_b128 v[52:55], v2 offset:19456
    s_waitcnt lgkmcnt(2)
    s_barrier
    ds_read_b128 v[72:75], v1 offset:20736
    ds_read_b128 v[76:79], v1 offset:21760
    v_mov_b64 v[16:17], 0
    v_mov_b64 v[18:19], 0
    v_mov_b64 v[20:21], 0
    v_mov_b64 v[22:23], 0
    v_mov_b64 v[24:25], 0
    v_mov_b64 v[26:27], 0
    v_mov_b64 v[28:29], 0
    v_mov_b64 v[30:31], 0
    ds_read_b128 v[96:99], v2 offset:26624
    ds_read_b128 v[100:103], v2 offset:27648
    ds_read_b128 v[104:107], v2 offset:20480
    s_waitcnt lgkmcnt(4)
    v_smfmac_f32_16x16x64_bf16 v[112:115], v[72:75], v[192:199], v11
    ds_read_b128 v[108:111], v2 offset:21504
    s_waitcnt lgkmcnt(4)
    v_smfmac_f32_16x16x64_bf16 v[112:115], v[76:79], v[200:207], v11
    ds_read_b128 v[56:59], v2 offset:28672
    v_smfmac_f32_16x16x64_bf16 v[116:119], v[72:75], v[208:215], v11
    ds_read_b128 v[60:63], v2 offset:29696
    v_smfmac_f32_16x16x64_bf16 v[116:119], v[76:79], v[216:223], v11
    v_add_f32 v112, v112, v113
    v_add_f32 v114, v114, v115
    v_smfmac_f32_16x16x64_bf16 v[120:123], v[72:75], v[224:231], v11
    ds_read_b128 v[32:35], v2 offset:22528
    v_smfmac_f32_16x16x64_bf16 v[120:123], v[76:79], v[232:239], v11
    v_add_f32 v116, v116, v117
    v_add_f32 v118, v118, v119
    v_smfmac_f32_16x16x64_bf16 v[124:127], v[72:75], v[240:247], v11
    v_cvt_pk_bf16_f32 v112, v112, v116
    v_cvt_pk_bf16_f32 v114, v114, v118
    v_smfmac_f32_16x16x64_bf16 v[124:127], v[76:79], v[248:255], v11
    v_bfi_b32 v112, 1, s47, v112
    v_add_f32 v120, v120, v121
    v_add_f32 v122, v122, v123
    v_smfmac_f32_16x16x64_bf16 v[16:19], v[72:75], v[80:87], v11
    ds_read_b128 v[36:39], v2 offset:23552
    v_smfmac_f32_16x16x64_bf16 v[16:19], v[76:79], v[88:95], v11
    v_add_f32 v124, v124, v125
    v_add_f32 v126, v126, v127
    v_cvt_pk_bf16_f32 v113, v120, v124
    v_cvt_pk_bf16_f32 v115, v122, v126
    buffer_store_dwordx4 v[112:115], v8, s[4:7], s45 offen
    ds_read_b128 v[40:43], v2 offset:30720
    v_smfmac_f32_16x16x64_bf16 v[20:23], v[72:75], v[48:55], v11
    ds_read_b128 v[44:47], v2 offset:31744
    s_waitcnt lgkmcnt(8)
    v_smfmac_f32_16x16x64_bf16 v[20:23], v[76:79], v[96:103], v11
    v_add_f32 v16, v16, v17
    v_add_f32 v18, v18, v19
    s_waitcnt lgkmcnt(6)
    v_smfmac_f32_16x16x64_bf16 v[24:27], v[72:75], v[104:111], v11
    s_waitcnt lgkmcnt(4)
    v_smfmac_f32_16x16x64_bf16 v[24:27], v[76:79], v[56:63], v11
    v_add_f32 v20, v20, v21
    v_add_f32 v22, v22, v23
    s_waitcnt lgkmcnt(2)
    v_smfmac_f32_16x16x64_bf16 v[28:31], v[72:75], v[32:39], v11
    v_cvt_pk_bf16_f32 v16, v16, v20
    v_cvt_pk_bf16_f32 v18, v18, v22
    s_waitcnt lgkmcnt(0)
    v_smfmac_f32_16x16x64_bf16 v[28:31], v[76:79], v[40:47], v11
    v_bfi_b32 v16, 1, s47, v16
    v_add_f32 v24, v24, v25
    v_add_f32 v26, v26, v27
    s_nop 4
    v_add_f32 v28, v28, v29
    v_add_f32 v30, v30, v31
    v_cvt_pk_bf16_f32 v17, v24, v28
    v_cvt_pk_bf16_f32 v19, v26, v30
    buffer_store_dwordx4 v[16:19], v8, s[4:7], s46 offen
    ds_write_b32 v6, v64 offset:16644
    ds_write_b32 v6, v68 offset:16772
    s_waitcnt lgkmcnt(0)
    s_barrier
    ds_read_b128 v[92:95], v3 offset:2304
    ds_read_b128 v[96:99], v3 offset:4096
    ds_read_b128 v[100:103], v3 offset:4352
    ds_read_b128 v[104:107], v3 offset:6144
    ds_read_b128 v[108:111], v3 offset:6400
    ds_read_b64_tr_b16 v[72:73], v4 offset:10240
    ds_read_b64_tr_b16 v[74:75], v4 offset:10496
    ds_read_b64_tr_b16 v[76:77], v4 offset:11264
    ds_read_b64_tr_b16 v[78:79], v4 offset:11520
    s_mov_b32 s2, s44
    s_add_u32 s44, s44, 1
    s_mov_b32 s51, s48
    s_mov_b32 s48, s49
    s_mov_b32 s49, s50
    s_mov_b32 s50, s51
    s_add_u32 s1, s48, s0
    s_add_u32 s3, s1, 4096
    buffer_load_dwordx4 v[32:35], v9, s[4:7], s28 offen sc1
    buffer_load_dwordx4 v[36:39], v9, s[4:7], s29 offen sc1
    buffer_load_dwordx4 v[40:43], v9, s[4:7], s30 offen sc1
    buffer_load_dwordx4 v[44:47], v9, s[4:7], s31 offen sc1
L_sumB1:
    s_waitcnt vmcnt(3)
    v_mfma_f32_16x16x32_bf16 v[20:23], v[12:15], v[32:35], 0
    s_waitcnt vmcnt(2)
    v_mfma_f32_16x16x32_bf16 v[20:23], v[12:15], v[36:39], v[20:23]
    v_bitop3_b32 v28, v32, v36, s47 bitop3:0x81
    s_waitcnt vmcnt(1)
    v_mfma_f32_16x16x32_bf16 v[20:23], v[12:15], v[40:43], v[20:23]
    s_waitcnt vmcnt(0)
    v_mfma_f32_16x16x32_bf16 v[20:23], v[12:15], v[44:47], v[20:23]
    v_bitop3_b32 v29, v40, v44, s47 bitop3:0x81
    v_bitop3_b32 v28, v28, v29, 1 bitop3:0x80
    v_cmp_eq_u32 vcc, 0, v28
    s_nop 4
    v_add_f32_dpp v20, v20, v20 row_ror:8 row_mask:0xf bank_mask:0xf
    v_add_f32_dpp v21, v21, v21 row_ror:8 row_mask:0xf bank_mask:0xf
    v_add_f32_dpp v22, v22, v22 row_ror:8 row_mask:0xf bank_mask:0xf
    v_add_f32_dpp v23, v23, v23 row_ror:8 row_mask:0xf bank_mask:0xf
    v_cvt_pk_bf16_f32 v24, v20, v21
    v_cvt_pk_bf16_f32 v25, v22, v23
    s_cbranch_vccnz L_retryB1
    buffer_store_dwordx2 v[24:25], v10, s[4:7], s48 offen
    s_xor_b32 s47, s47, 1
    s_waitcnt lgkmcnt(0)
    s_cmp_lt_u32 s44, 63
    s_barrier
    s_cbranch_scc1 L_top1
    s_branch L_final1
L_againA1:
    s_waitcnt vmcnt(0) lgkmcnt(0)
    s_nop 7
    v_mov_b64 v[56:57], 0
    v_mov_b64 v[58:59], 0
    s_sub_u32 s96, s96, 1
    s_cbranch_scc0 L_pollA1
    s_branch L_abort
L_retryA1:
L_retry21:
    s_waitcnt lgkmcnt(0)
    buffer_load_dwordx4 v[36:39], v1, s[4:7], s3 offen offset:1024 sc1
    s_waitcnt vmcnt(0)
    v_max_u32_e64 v124, v36, v38
    v_cmp_eq_u32 vcc, -1, v124
    ds_write_b128 v1, v[36:39] offset:27904
    s_cbranch_vccz L_lateA1
    s_sub_u32 s96, s96, 1
    s_cbranch_scc0 L_retry21
    s_branch L_abort
L_againAf1:
    s_waitcnt vmcnt(0) lgkmcnt(0)
    s_nop 7
    v_mov_b64 v[56:57], 0
    v_mov_b64 v[58:59], 0
    s_sub_u32 s96, s96, 1
    s_cbranch_scc0 L_pollAf1
    s_branch L_abort
L_retryAf1:
L_retry2f1:
    s_waitcnt lgkmcnt(0)
    buffer_load_dwordx4 v[36:39], v1, s[4:7], s3 offen offset:1024 sc1
    s_waitcnt vmcnt(0)
    v_max_u32_e64 v124, v36, v38
    v_cmp_eq_u32 vcc, -1, v124
    ds_write_b128 v1, v[36:39] offset:27904
    s_cbranch_vccz L_lateAf1
    s_sub_u32 s96, s96, 1
    s_cbranch_scc0 L_retry2f1
    s_branch L_abort
L_retryB1:
    buffer_load_dwordx4 v[32:35], v9, s[4:7], s28 offen sc1
    buffer_load_dwordx4 v[36:39], v9, s[4:7], s29 offen sc1
    buffer_load_dwordx4 v[40:43], v9, s[4:7], s30 offen sc1
    buffer_load_dwordx4 v[44:47], v9, s[4:7], s31 offen sc1
    s_sub_u32 s96, s96, 1
    s_cbranch_scc0 L_sumB1
    s_branch L_abort
L_final1:
    ds_read_b128 v[80:83], v3 offset:0
    ds_read_b128 v[84:87], v3 offset:256
    ds_read_b128 v[88:91], v3 offset:2048
    v_mov_b64 v[60:61], 0
    v_mov_b64 v[62:63], 0
    v_mov_b64 v[64:65], 0
    v_mov_b64 v[66:67], 0
    v_mov_b64 v[68:69], 0
    v_mov_b64_e64 v[70:71], 0
L_pollAf1:
    buffer_load_dwordx4 v[20:23], v1, s[4:7], s1 offen offset:1024 sc1
    v_mov_b64 v[48:49], 0
    v_mov_b64 v[50:51], 0
    v_mov_b64 v[52:53], 0
    v_mov_b64 v[54:55], 0
    v_mov_b64 v[56:57], 0
    v_mov_b64 v[58:59], 0
    buffer_load_dwordx4 v[36:39], v1, s[4:7], s3 offen offset:1024 sc1
    s_waitcnt vmcnt(1)
    v_max_u32_e64 v124, v20, v22
    v_cmp_eq_u32 vcc, -1, v124
    ds_write_b128 v1, v[20:23] offset:23808
    v_smfmac_f32_16x16x64_bf16 v[56:59], v[20:23], a[144:151], v11
    s_cbranch_vccnz L_againAf1
L_gotEf1:
    v_smfmac_f32_16x16x64_bf16 v[48:51], v[20:23], a[16:23], v11
    v_smfmac_f32_16x16x64_bf16 v[60:63], v[20:23], a[152:159], v11
    s_waitcnt vmcnt(0)
    v_max_u32 v124, v36, v38
    v_cmp_eq_u32 vcc, -1, v124
    ds_write_b128 v1, v[36:39] offset:27904
    v_smfmac_f32_16x16x64_bf16 v[52:55], v[20:23], a[24:31], v11
    s_cbranch_vccnz L_retryAf1
L_lateAf1:
    s_waitcnt lgkmcnt(1)
    s_barrier
    ds_read_b128 v[24:27], v1 offset:24832
    ds_read_b128 v[28:31], v1 offset:25856
    ds_read_b128 v[16:19], v1 offset:22784
    v_smfmac_f32_16x16x64_bf16 v[56:59], v[36:39], a[208:215], v11
    v_smfmac_f32_16x16x64_bf16 v[60:63], v[36:39], a[216:223], v11
    v_smfmac_f32_16x16x64_bf16 v[64:67], v[20:23], v[144:151], v11
    v_smfmac_f32_16x16x64_bf16 v[68:71], v[20:23], v[152:159], v11
    s_waitcnt lgkmcnt(2)
    s_barrier
    v_smfmac_f32_16x16x64_bf16 v[56:59], v[24:27], a[160:167], v11
    ds_read_b128 v[40:43], v1 offset:28928
    v_smfmac_f32_16x16x64_bf16 v[60:63], v[24:27], a[168:175], v11
    ds_read_b128 v[44:47], v1 offset:29952
    v_smfmac_f32_16x16x64_bf16 v[64:67], v[24:27], v[160:167], v11
    ds_read_b128 v[32:35], v1 offset:26880
    v_smfmac_f32_16x16x64_bf16 v[68:71], v[24:27], v[168:175], v11
    ds_read_b128 v[80:83], v2 offset:4096
    s_waitcnt lgkmcnt(5)
    v_smfmac_f32_16x16x64_bf16 v[56:59], v[28:31], a[176:183], v11
    ds_read_b128 v[84:87], v2 offset:5120
    v_smfmac_f32_16x16x64_bf16 v[60:63], v[28:31], a[184:191], v11
    ds_read_b128 v[88:91], v2 offset:6144
    v_smfmac_f32_16x16x64_bf16 v[64:67], v[28:31], v[176:183], v11
    ds_read_b128 v[92:95], v2 offset:7168
    v_smfmac_f32_16x16x64_bf16 v[68:71], v[28:31], v[184:191], v11
    ds_read_b128 v[96:99], v2 offset:8192
    s_waitcnt lgkmcnt(8)
    v_smfmac_f32_16x16x64_bf16 v[56:59], v[16:19], a[128:135], v11
    ds_read_b128 v[100:103], v2 offset:9216
    v_smfmac_f32_16x16x64_bf16 v[60:63], v[16:19], a[136:143], v11
    ds_read_b128 v[104:107], v2 offset:10240
    v_smfmac_f32_16x16x64_bf16 v[64:67], v[16:19], v[128:135], v11
    ds_read_b128 v[108:111], v2 offset:11264
    v_smfmac_f32_16x16x64_bf16 v[68:71], v[16:19], v[136:143], v11
    v_lshrrev_b32 v120, 8, v1
    v_lshlrev_b32 v120, 10, v120
    v_bfe_u32 v121, v1, 4, 4
    v_lshl_add_u32 v120, v121, 3, v120
    s_lshl_b32 s52, s14, 12
    s_add_u32 s52, s52, 66978048
    s_waitcnt lgkmcnt(6)
    v_smfmac_f32_16x16x64_bf16 v[64:67], v[36:39], v[80:87], v11
    ds_read_b128 v[80:83], v2 offset:12288
    ds_read_b128 v[84:87], v2 offset:13312
    v_smfmac_f32_16x16x64_bf16 v[56:59], v[40:43], a[224:231], v11
    s_waitcnt lgkmcnt(6)
    v_smfmac_f32_16x16x64_bf16 v[68:71], v[36:39], v[88:95], v11
    ds_read_b128 v[88:91], v2 offset:14336
    ds_read_b128 v[92:95], v2 offset:15360
    v_smfmac_f32_16x16x64_bf16 v[60:63], v[40:43], a[232:239], v11
    s_waitcnt lgkmcnt(6)
    v_smfmac_f32_16x16x64_bf16 v[64:67], v[40:43], v[96:103], v11
    ds_read_b128 v[96:99], v2 offset:0
    ds_read_b128 v[100:103], v2 offset:1024
    v_smfmac_f32_16x16x64_bf16 v[56:59], v[44:47], a[240:247], v11
    s_waitcnt lgkmcnt(6)
    v_smfmac_f32_16x16x64_bf16 v[68:71], v[40:43], v[104:111], v11
    ds_read_b128 v[104:107], v2 offset:2048
    ds_read_b128 v[108:111], v2 offset:3072
    v_smfmac_f32_16x16x64_bf16 v[60:63], v[44:47], a[248:255], v11
    s_waitcnt lgkmcnt(6)
    v_smfmac_f32_16x16x64_bf16 v[64:67], v[44:47], v[80:87], v11
    v_smfmac_f32_16x16x64_bf16 v[56:59], v[32:35], a[192:199], v11
    s_waitcnt lgkmcnt(4)
    v_smfmac_f32_16x16x64_bf16 v[68:71], v[44:47], v[88:95], v11
    v_smfmac_f32_16x16x64_bf16 v[60:63], v[32:35], a[200:207], v11
    s_waitcnt lgkmcnt(2)
    v_smfmac_f32_16x16x64_bf16 v[64:67], v[32:35], v[96:103], v11
    s_waitcnt lgkmcnt(0)
    v_smfmac_f32_16x16x64_bf16 v[68:71], v[32:35], v[104:111], v11
    v_add_f32 v56, v56, v57
    v_add_f32 v58, v58, v59
    v_cvt_pk_bf16_f32 v56, v56, v58
    v_add_f32 v60, v60, v61
    v_add_f32 v62, v62, v63
    v_cvt_pk_bf16_f32 v60, v60, v62
    s_nop 1
    v_add_f32 v64, v64, v65
    v_add_f32_e64 v66, v66, v67
    v_cvt_pk_bf16_f32 v57, v64, v66
    buffer_store_dwordx2 v[56:57], v120, s[4:7], s52 offen offset:0 sc1
    v_add_f32 v68, v68, v69
    v_add_f32 v70, v70, v71
    v_cvt_pk_bf16_f32 v61, v68, v70
    buffer_store_dwordx2 v[60:61], v120, s[4:7], s52 offen offset:128 sc1
    s_waitcnt vmcnt(0)
    s_endpgm
L_cstart2:
    v_mov_b32_e64 v14, v91
    ds_read_b128 v[80:83], v3 offset:0
    ds_read_b128 v[84:87], v3 offset:256
    ds_read_b128 v[88:91], v3 offset:2048
    ds_read_b128 v[92:95], v3 offset:2304
    ds_read_b128 v[96:99], v3 offset:4096
    ds_read_b128 v[100:103], v3 offset:4352
    ds_read_b128 v[104:107], v3 offset:6144
    ds_read_b128 v[108:111], v3 offset:6400
    ds_read_b64_tr_b16 v[72:73], v4 offset:12288
    ds_read_b64_tr_b16 v[74:75], v4 offset:12544
    ds_read_b64_tr_b16 v[76:77], v4 offset:13312
    ds_read_b64_tr_b16 v[78:79], v4 offset:13568
    v_mov_b64 v[48:49], 0
    v_mov_b64 v[50:51], 0
    v_mov_b64 v[52:53], 0
    v_mov_b64 v[54:55], 0
    v_mov_b64 v[56:57], 0
    v_mov_b64 v[58:59], 0
    v_mov_b64 v[60:61], 0
    v_mov_b64 v[62:63], 0
    v_mov_b64 v[64:65], 0
    v_mov_b64 v[66:67], 0
    v_mov_b64 v[68:69], 0
    v_mov_b64 v[70:71], 0
    v_mov_b64 v[112:113], 0
    v_mov_b64 v[114:115], 0
    v_mov_b64 v[116:117], 0
    v_mov_b64 v[118:119], 0
    s_add_u32 s58, s44, 1
    s_min_u32 s58, s58, 63
L_kvchkq2:
    v_cmp_gt_i32 vcc, s58, v14
    s_cbranch_vccz L_kvokq2
    buffer_load_dword v14, v13, s[4:7], s28 offen sc1
    s_waitcnt vmcnt(0)
    s_sub_u32 s96, s96, 1
    s_cbranch_scc0 L_kvchkq2
    s_branch L_abort
L_kvokq2:
    s_lshl_b32 s58, s58, 18
    s_add_u32 s58, s58, 16777216
    s_lshl_b32 s29, s44, 17
    s_cmp_gt_u32 s44, 56
    s_mov_b32 s52, 50331648
    s_cselect_b32 s52, 58589184, s52
    s_add_u32 s29, s29, s52
    s_waitcnt lgkmcnt(0)
    s_barrier
.p2align 6
L_top2:
    ds_read_b128 v[80:83], v3 offset:0
    ds_read_b128 v[84:87], v3 offset:256
    ds_read_b128 v[88:91], v3 offset:2048
    v_mov_b64 v[60:61], 0
    v_mov_b64 v[62:63], 0
    v_mov_b64 v[64:65], 0
    v_mov_b64 v[66:67], 0
    v_mov_b64 v[68:69], 0
    v_mov_b64 v[70:71], 0
L_pollA2:
    buffer_load_dwordx4 v[24:27], v1, s[4:7], s1 offen offset:2048 sc1
    v_mov_b64 v[48:49], 0
    v_mov_b64 v[50:51], 0
    v_mov_b64 v[52:53], 0
    v_mov_b64 v[54:55], 0
    v_mov_b64 v[56:57], 0
    v_mov_b64 v[58:59], 0
    buffer_load_dwordx4 v[40:43], v1, s[4:7], s3 offen offset:2048 sc1
    s_waitcnt vmcnt(1)
    v_max_u32_e64 v124, v24, v26
    v_cmp_eq_u32 vcc, -1, v124
    ds_write_b128 v1, v[24:27] offset:24832
    v_smfmac_f32_16x16x64_bf16 v[56:59], v[24:27], a[160:167], v11
    s_cbranch_vccnz L_againA2
L_gotE2:
    v_smfmac_f32_16x16x64_bf16 v[48:51], v[24:27], a[32:39], v11
    v_smfmac_f32_16x16x64_bf16 v[60:63], v[24:27], a[168:175], v11
    s_waitcnt vmcnt(0)
    v_max_u32 v124, v40, v42
    v_cmp_eq_u32 vcc, -1, v124
    ds_write_b128 v1, v[40:43] offset:28928
    v_smfmac_f32_16x16x64_bf16 v[52:55], v[24:27], a[40:47], v11
    s_cbranch_vccnz L_retryA2
L_lateA2:
    s_waitcnt lgkmcnt(1)
    s_barrier
    v_smfmac_f32_16x16x64_bf16 v[56:59], v[40:43], a[224:231], v11
    ds_read_b128 v[28:31], v1 offset:25856
    v_smfmac_f32_16x16x64_bf16 v[48:51], v[40:43], a[96:103], v11
    ds_read_b128 v[16:19], v1 offset:22784
    v_smfmac_f32_16x16x64_bf16 v[60:63], v[40:43], a[232:239], v11
    ds_read_b128 v[20:23], v1 offset:23808
    s_mov_b32 m0, 0
    v_smfmac_f32_16x16x64_bf16 v[52:55], v[40:43], a[104:111], v11
    buffer_load_dwordx4 v9, s[4:7], s58 offen offset:0 sc1 lds
    v_smfmac_f32_16x16x64_bf16 v[64:67], v[24:27], v[160:167], v11
    buffer_load_dwordx4 v9, s[4:7], s58 offen offset:1024 sc1 lds
    v_smfmac_f32_16x16x64_bf16 v[68:71], v[24:27], v[168:175], v11
    buffer_load_dwordx4 v9, s[4:7], s58 offen offset:2048 sc1 lds
    s_waitcnt lgkmcnt(2)
    s_barrier
    v_smfmac_f32_16x16x64_bf16 v[56:59], v[28:31], a[176:183], v11
    ds_read_b128 v[44:47], v1 offset:29952
    v_smfmac_f32_16x16x64_bf16 v[48:51], v[28:31], a[48:55], v11
    ds_read_b128 v[32:35], v1 offset:26880
    v_smfmac_f32_16x16x64_bf16 v[60:63], v[28:31], a[184:191], v11
    ds_read_b128 v[36:39], v1 offset:27904
    v_smfmac_f32_16x16x64_bf16 v[52:55], v[28:31], a[56:63], v11
    buffer_load_dwordx4 v9, s[4:7], s58 offen offset:3072 sc1 lds
    s_waitcnt lgkmcnt(4)
    v_smfmac_f32_16x16x64_bf16 v[56:59], v[16:19], a[128:135], v11
    s_mov_b32 m0, 4096
    s_add_u32 s58, s58, 4096
    v_smfmac_f32_16x16x64_bf16 v[48:51], v[16:19], a[0:7], v11
    buffer_load_dwordx4 v9, s[4:7], s58 offen offset:0 sc1 lds
    v_smfmac_f32_16x16x64_bf16 v[60:63], v[16:19], a[136:143], v11
    buffer_load_dwordx4 v9, s[4:7], s58 offen offset:1024 sc1 lds
    v_smfmac_f32_16x16x64_bf16 v[52:55], v[16:19], a[8:15], v11
    buffer_load_dwordx4 v9, s[4:7], s58 offen offset:2048 sc1 lds
    s_waitcnt lgkmcnt(3)
    v_smfmac_f32_16x16x64_bf16 v[56:59], v[20:23], a[144:151], v11
    v_smfmac_f32_16x16x64_bf16 v[48:51], v[20:23], a[16:23], v11
    v_smfmac_f32_16x16x64_bf16 v[60:63], v[20:23], a[152:159], v11
    v_smfmac_f32_16x16x64_bf16 v[52:55], v[20:23], a[24:31], v11
    s_waitcnt lgkmcnt(2)
    v_smfmac_f32_16x16x64_bf16 v[56:59], v[44:47], a[240:247], v11
    v_smfmac_f32_16x16x64_bf16 v[48:51], v[44:47], a[112:119], v11
    v_smfmac_f32_16x16x64_bf16 v[60:63], v[44:47], a[248:255], v11
    v_smfmac_f32_16x16x64_bf16 v[52:55], v[44:47], a[120:127], v11
    s_waitcnt lgkmcnt(0)
    v_smfmac_f32_16x16x64_bf16 v[56:59], v[32:35], a[192:199], v11
    v_smfmac_f32_16x16x64_bf16 v[48:51], v[32:35], a[64:71], v11
    v_smfmac_f32_16x16x64_bf16 v[56:59], v[36:39], a[208:215], v11
    v_smfmac_f32_16x16x64_bf16 v[48:51], v[36:39], a[80:87], v11
    v_smfmac_f32_16x16x64_bf16 v[60:63], v[32:35], a[200:207], v11
    v_smfmac_f32_16x16x64_bf16 v[60:63], v[36:39], a[216:223], v11
    v_add_f32_e64 v56, v56, v57
    v_smfmac_f32_16x16x64_bf16 v[52:55], v[32:35], a[72:79], v11
    v_add_f32_e64 v58, v58, v59
    v_smfmac_f32_16x16x64_bf16 v[52:55], v[36:39], a[88:95], v11
    v_add_f32 v48, v48, v49
    v_add_f32 v50, v50, v51
    v_cvt_pk_bf16_f32 v56, v56, v58
    v_cvt_pk_bf16_f32 v57, v48, v50
    ds_write_b64 v6, v[56:57] offset:16896
L_qkdone2:
    v_add_f32 v60, v60, v61
    v_add_f32 v62, v62, v63
    v_cvt_pk_bf16_f32 v60, v60, v62
    v_add_f32 v52, v52, v53
    v_add_f32 v54, v54, v55
    v_cvt_pk_bf16_f32 v61, v52, v54
    ds_write_b64 v6, v[60:61] offset:17024
    v_smfmac_f32_16x16x64_bf16 v[64:67], v[28:31], v[176:183], v11
    buffer_load_dwordx4 v9, s[4:7], s58 offen offset:3072 sc1 lds
    v_smfmac_f32_16x16x64_bf16 v[68:71], v[28:31], v[184:191], v11
    buffer_load_dword v14, v13, s[4:7], s28 offen sc1
    v_smfmac_f32_16x16x64_bf16 v[64:67], v[16:19], v[128:135], v11
    buffer_store_dwordx4 v[112:115], v10, s[4:7], s29 offen offset:0 sc1
    v_smfmac_f32_16x16x64_bf16 v[68:71], v[16:19], v[136:143], v11
    buffer_store_dwordx4 v[116:119], v10, s[4:7], s29 offen offset:1024 sc1
    s_waitcnt lgkmcnt(0)
    s_barrier
    ds_read_b64_tr_b16 v[48:49], v5 offset:16384
    ds_read_b64_tr_b16 v[50:51], v5 offset:16416
    ds_read_b64_tr_b16 v[52:53], v5 offset:16640
    ds_read_b64_tr_b16 v[54:55], v5 offset:16672
    ds_read_b64_tr_b16 v[56:57], v5 offset:16896
    ds_read_b64_tr_b16 v[58:59], v5 offset:16928
    ds_read_b64_tr_b16 v[60:61], v5 offset:17152
    ds_read_b64_tr_b16 v[62:63], v5 offset:17184
    v_smfmac_f32_16x16x64_bf16 v[64:67], v[20:23], v[144:151], v11
    v_smfmac_f32_16x16x64_bf16 v[68:71], v[20:23], v[152:159], v11
    ds_read_b128 v[16:19], v2 offset:0
    ds_read_b128 v[20:23], v2 offset:1024
    s_waitcnt lgkmcnt(8)
    v_mfma_f32_16x16x32_bf16 v[116:119], v[80:83], v[48:51], 0
    ds_read_b128 v[24:27], v2 offset:2048
    v_mfma_f32_16x16x32_bf16 v[120:123], v[84:87], v[48:51], 0
    ds_read_b128 v[28:31], v2 offset:3072
    v_mfma_f32_16x16x32_bf16 v[124:127], v[48:51], v[48:51], 0
    ds_read_b128 v[80:83], v2 offset:4096
    s_waitcnt lgkmcnt(9)
    v_mfma_f32_16x16x32_bf16 v[116:119], v[88:91], v[52:55], v[116:119]
    ds_read_b128 v[84:87], v2 offset:5120
    v_mfma_f32_16x16x32_bf16 v[120:123], v[92:95], v[52:55], v[120:123]
    ds_read_b128 v[88:91], v2 offset:6144
    v_mfma_f32_16x16x32_bf16 v[124:127], v[52:55], v[52:55], v[124:127]
    ds_read_b128 v[92:95], v2 offset:7168
    s_waitcnt lgkmcnt(10)
    v_mfma_f32_16x16x32_bf16 v[116:119], v[96:99], v[56:59], v[116:119]
    ds_read_b128 v[48:51], v2 offset:12288
    v_mfma_f32_16x16x32_bf16 v[120:123], v[100:103], v[56:59], v[120:123]
    ds_read_b128 v[52:55], v2 offset:13312
    v_mfma_f32_16x16x32_bf16 v[124:127], v[56:59], v[56:59], v[124:127]
    ds_read_b128 v[96:99], v2 offset:8192
    s_waitcnt lgkmcnt(11)
    v_mfma_f32_16x16x32_bf16 v[116:119], v[104:107], v[60:63], v[116:119]
    ds_read_b128 v[100:103], v2 offset:9216
    v_mfma_f32_16x16x32_bf16 v[120:123], v[108:111], v[60:63], v[120:123]
    ds_read_b128 v[104:107], v2 offset:10240
    v_mfma_f32_16x16x32_bf16 v[124:127], v[60:63], v[60:63], v[124:127]
    ds_read_b128 v[108:111], v2 offset:11264
    ds_read_b128 v[56:59], v2 offset:14336
    s_waitcnt lgkmcnt(11)
    v_smfmac_f32_16x16x64_bf16 v[64:67], v[32:35], v[16:23], v11
    ds_read_b128 v[60:63], v2 offset:15360
    v_max3_f32 v112, v116, v117, v118
    v_smfmac_f32_16x16x64_bf16 v[68:71], v[32:35], v[24:31], v11
    v_max3_f32 v113, v119, v120, v121
    s_waitcnt lgkmcnt(8)
    v_smfmac_f32_16x16x64_bf16 v[64:67], v[36:39], v[80:87], v11
    v_max3_f32 v112, v112, v122, v123
    v_max3_f32 v126, v113, v124, v125
    v_smfmac_f32_16x16x64_bf16 v[68:71], v[36:39], v[88:95], v11
    v_max_f32 v127, v112, v126
    v_max_f32_e64 v126, v112, v126
    s_waitcnt lgkmcnt(4)
    v_smfmac_f32_16x16x64_bf16 v[64:67], v[44:47], v[48:55], v11
    s_nop 0
    v_permlane16_swap_b32 v126, v127
    v_smfmac_f32_16x16x64_bf16 v[64:67], v[40:43], v[96:103], v11
    v_max_f32 v112, v126, v127
    v_max_f32_e64 v113, v126, v127
    s_waitcnt lgkmcnt(0)
    v_smfmac_f32_16x16x64_bf16 v[68:71], v[40:43], v[104:111], v11
    s_nop 0
    v_permlane32_swap_b32 v112, v113
    v_smfmac_f32_16x16x64_bf16 v[68:71], v[44:47], v[56:63], v11
    v_max_f32 v126, v112, v113
    v_mul_f32 v126, s55, v126
    v_mov_b64 v[16:17], s[78:79]
    v_mov_b64 v[18:19], s[78:79]
    v_pk_fma_f32 v[116:117], v[116:117], s[32:33], v[126:127] op_sel_hi:[1,1,0] neg_lo:[0,0,1] neg_hi:[0,0,1]
    v_pk_fma_f32 v[118:119], v[118:119], s[32:33], v[126:127] op_sel_hi:[1,1,0] neg_lo:[0,0,1] neg_hi:[0,0,1]
    v_pk_fma_f32 v[120:121], v[120:121], s[32:33], v[126:127] op_sel_hi:[1,1,0] neg_lo:[0,0,1] neg_hi:[0,0,1]
    v_pk_fma_f32 v[122:123], v[122:123], s[32:33], v[126:127] op_sel_hi:[1,1,0] neg_lo:[0,0,1] neg_hi:[0,0,1]
    v_pk_fma_f32 v[124:125], v[124:125], s[32:33], v[126:127] op_sel_hi:[1,1,0] neg_lo:[0,0,1] neg_hi:[0,0,1]
    v_exp_f32 v116, v116
    v_exp_f32 v117, v117
    v_exp_f32_e64 v118, v118
    v_cvt_pk_bf16_f32 v112, v116, v117
    v_exp_f32 v119, v119
    v_exp_f32 v120, v120
    v_cvt_pk_bf16_f32 v113, v118, v119
    v_exp_f32 v121, v121
    v_exp_f32 v122, v122
    v_cvt_pk_bf16_f32 v114, v120, v121
    v_exp_f32 v123, v123
    v_exp_f32 v124, v124
    v_cvt_pk_bf16_f32 v115, v122, v123
    v_exp_f32 v125, v125
    v_add_f32 v64, v64, v65
    v_mfma_f32_16x16x32_bf16 v[20:23], v[16:19], v[112:115], 0
    v_cvt_pk_bf16_f32 v124, v124, v125
    v_mov_b32_e64 v125, 0
    v_mfma_f32_16x16x32_bf16 v[24:27], v[72:75], v[112:115], 0
    v_add_f32 v66, v66, v67
    v_add_f32 v68, v68, v69
    v_mfma_f32_16x16x32_bf16 v[28:31], v[76:79], v[112:115], 0
    v_cvt_pk_bf16_f32 v64, v64, v66
    v_mov_b32_e64 v65, 0
    v_mfma_f32_16x16x16_bf16 v[20:23], v[16:17], v[124:125], v[20:23]
    v_add_f32 v70, v70, v71
    v_mov_b32 v69, 0
    v_cvt_pk_bf16_f32 v68, v68, v70
    v_mfma_f32_16x16x16_bf16 v[24:27], v[64:65], v[124:125], v[24:27]
    ds_read_b128 v[80:83], v2 offset:16384
    v_mfma_f32_16x16x16_bf16 v[28:31], v[68:69], v[124:125], v[28:31]
    v_rcp_f32_e64 v20, v20
    ds_read_b128 v[84:87], v2 offset:17408
    ds_read_b128 v[88:91], v2 offset:24576
    ds_read_b128 v[92:95], v2 offset:25600
    v_pk_mul_f32 v[24:25], v[24:25], v[20:21] op_sel_hi:[1,0]
    v_pk_mul_f32 v[26:27], v[26:27], v[20:21] op_sel_hi:[1,0]
    v_cvt_pk_bf16_f32 v16, v24, v25
    v_cvt_pk_bf16_f32 v17, v26, v27
    v_pk_mul_f32 v[28:29], v[28:29], v[20:21] op_sel_hi:[1,0]
    v_pk_mul_f32 v[30:31], v[30:31], v[20:21] op_sel_hi:[1,0]
    v_cvt_pk_bf16_f32 v18, v28, v29
    v_cvt_pk_bf16_f32 v19, v30, v31
    s_mov_b64 exec, s[56:57]
    ds_write_b128 v7, v[16:19] offset:21760
    s_mov_b64 exec, -1
    v_mov_b64 v[112:113], 0
    v_mov_b64 v[114:115], 0
    v_mov_b64 v[116:117], 0
    v_mov_b64 v[118:119], 0
    v_mov_b64 v[120:121], 0
    v_mov_b64 v[122:123], 0
    v_mov_b64 v[124:125], 0
    v_mov_b64 v[126:127], 0
    ds_read_b128 v[48:51], v2 offset:18432
    ds_read_b128 v[52:55], v2 offset:19456
    s_waitcnt lgkmcnt(2)
    s_barrier
    ds_read_b128 v[72:75], v1 offset:20736
    ds_read_b128 v[76:79], v1 offset:21760
    v_mov_b64 v[16:17], 0
    v_mov_b64 v[18:19], 0
    v_mov_b64 v[20:21], 0
    v_mov_b64 v[22:23], 0
    v_mov_b64 v[24:25], 0
    v_mov_b64 v[26:27], 0
    v_mov_b64 v[28:29], 0
    v_mov_b64 v[30:31], 0
    ds_read_b128 v[96:99], v2 offset:26624
    ds_read_b128 v[100:103], v2 offset:27648
    ds_read_b128 v[104:107], v2 offset:20480
    s_waitcnt lgkmcnt(4)
    v_smfmac_f32_16x16x64_bf16 v[112:115], v[72:75], v[192:199], v11
    ds_read_b128 v[108:111], v2 offset:21504
    s_waitcnt lgkmcnt(4)
    v_smfmac_f32_16x16x64_bf16 v[112:115], v[76:79], v[200:207], v11
    ds_read_b128 v[56:59], v2 offset:28672
    v_smfmac_f32_16x16x64_bf16 v[116:119], v[72:75], v[208:215], v11
    ds_read_b128 v[60:63], v2 offset:29696
    v_smfmac_f32_16x16x64_bf16 v[116:119], v[76:79], v[216:223], v11
    v_add_f32 v112, v112, v113
    v_add_f32 v114, v114, v115
    v_smfmac_f32_16x16x64_bf16 v[120:123], v[72:75], v[224:231], v11
    ds_read_b128 v[32:35], v2 offset:22528
    v_smfmac_f32_16x16x64_bf16 v[120:123], v[76:79], v[232:239], v11
    v_add_f32 v116, v116, v117
    v_add_f32 v118, v118, v119
    v_smfmac_f32_16x16x64_bf16 v[124:127], v[72:75], v[240:247], v11
    v_cvt_pk_bf16_f32 v112, v112, v116
    v_cvt_pk_bf16_f32 v114, v114, v118
    v_smfmac_f32_16x16x64_bf16 v[124:127], v[76:79], v[248:255], v11
    v_bfi_b32 v112, 1, s47, v112
    v_add_f32 v120, v120, v121
    v_add_f32 v122, v122, v123
    v_smfmac_f32_16x16x64_bf16 v[16:19], v[72:75], v[80:87], v11
    ds_read_b128 v[36:39], v2 offset:23552
    v_smfmac_f32_16x16x64_bf16 v[16:19], v[76:79], v[88:95], v11
    v_add_f32 v124, v124, v125
    v_add_f32 v126, v126, v127
    v_cvt_pk_bf16_f32 v113, v120, v124
    v_cvt_pk_bf16_f32 v115, v122, v126
    buffer_store_dwordx4 v[112:115], v8, s[4:7], s45 offen
    ds_read_b128 v[40:43], v2 offset:30720
    v_smfmac_f32_16x16x64_bf16 v[20:23], v[72:75], v[48:55], v11
    ds_read_b128 v[44:47], v2 offset:31744
    s_waitcnt lgkmcnt(8)
    v_smfmac_f32_16x16x64_bf16 v[20:23], v[76:79], v[96:103], v11
    v_add_f32 v16, v16, v17
    v_add_f32 v18, v18, v19
    s_waitcnt lgkmcnt(6)
    v_smfmac_f32_16x16x64_bf16 v[24:27], v[72:75], v[104:111], v11
    s_waitcnt lgkmcnt(4)
    v_smfmac_f32_16x16x64_bf16 v[24:27], v[76:79], v[56:63], v11
    v_add_f32 v20, v20, v21
    v_add_f32 v22, v22, v23
    s_waitcnt lgkmcnt(2)
    v_smfmac_f32_16x16x64_bf16 v[28:31], v[72:75], v[32:39], v11
    v_cvt_pk_bf16_f32 v16, v16, v20
    v_cvt_pk_bf16_f32 v18, v18, v22
    s_waitcnt lgkmcnt(0)
    v_smfmac_f32_16x16x64_bf16 v[28:31], v[76:79], v[40:47], v11
    v_bfi_b32 v16, 1, s47, v16
    v_add_f32 v24, v24, v25
    v_add_f32 v26, v26, v27
    s_nop 4
    v_add_f32 v28, v28, v29
    v_add_f32 v30, v30, v31
    v_cvt_pk_bf16_f32 v17, v24, v28
    v_cvt_pk_bf16_f32 v19, v26, v30
    buffer_store_dwordx4 v[16:19], v8, s[4:7], s46 offen
    ds_write_b32 v6, v64 offset:16900
    ds_write_b32 v6, v68 offset:17028
    s_mov_b32 s2, s44
    s_add_u32 s44, s44, 1
    s_mov_b32 s51, s48
    s_mov_b32 s48, s49
    s_mov_b32 s49, s50
    s_mov_b32 s50, s51
    s_add_u32 s1, s48, s0
    s_add_u32 s3, s1, 4096
    s_waitcnt vmcnt(2) lgkmcnt(0)
    s_barrier
    ds_read_b128 v[92:95], v3 offset:2304
    ds_read_b128 v[96:99], v3 offset:4096
    ds_read_b128 v[100:103], v3 offset:4352
    ds_read_b128 v[104:107], v3 offset:6144
    ds_read_b128 v[108:111], v3 offset:6400
    ds_read_b64_tr_b16 v[72:73], v4 offset:12288
    ds_read_b64_tr_b16 v[74:75], v4 offset:12544
    ds_read_b64_tr_b16 v[76:77], v4 offset:13312
    ds_read_b64_tr_b16 v[78:79], v4 offset:13568
    ds_read_b128 v[112:115], v1 offset:16384
    ds_read_b128 v[116:119], v1 offset:17440
    s_add_u32 s58, s44, 1
    s_min_u32 s58, s58, 63
L_kvchks2:
    v_cmp_gt_i32 vcc, s58, v14
    s_cbranch_vccz L_kvoks2
    buffer_load_dword v14, v13, s[4:7], s28 offen sc1
    s_waitcnt vmcnt(0)
    s_sub_u32 s96, s96, 1
    s_cbranch_scc0 L_kvchks2
    s_branch L_abort
L_kvoks2:
    s_lshl_b32 s58, s58, 18
    s_add_u32 s58, s58, 16777216
    s_lshl_b32 s29, s44, 17
    s_cmp_gt_u32 s44, 56
    s_mov_b32 s52, 50331648
    s_cselect_b32 s52, 58589184, s52
    s_add_u32 s29, s29, s52
    s_xor_b32 s47, s47, 1
    s_waitcnt lgkmcnt(0)
    s_cmp_lt_u32 s44, 63
    s_barrier
    s_cbranch_scc1 L_top2
    s_branch L_final2
L_againA2:
    s_waitcnt vmcnt(0) lgkmcnt(0)
    s_nop 7
    v_mov_b64 v[56:57], 0
    v_mov_b64_e64 v[58:59], 0
    s_sub_u32 s96, s96, 1
    s_cbranch_scc0 L_pollA2
    s_branch L_abort
L_retryA2:
L_retry22:
    s_waitcnt lgkmcnt(0)
    buffer_load_dwordx4 v[40:43], v1, s[4:7], s3 offen offset:2048 sc1
    s_waitcnt vmcnt(0)
    v_max_u32_e64 v124, v40, v42
    v_cmp_eq_u32 vcc, -1, v124
    ds_write_b128 v1, v[40:43] offset:28928
    s_cbranch_vccz L_lateA2
    s_sub_u32 s96, s96, 1
    s_cbranch_scc0 L_retry22
    s_branch L_abort
L_againAf2:
    s_waitcnt vmcnt(0) lgkmcnt(0)
    s_nop 7
    v_mov_b64 v[56:57], 0
    v_mov_b64 v[58:59], 0
    s_sub_u32 s96, s96, 1
    s_cbranch_scc0 L_pollAf2
    s_branch L_abort
L_retryAf2:
L_retry2f2:
    s_waitcnt lgkmcnt(0)
    buffer_load_dwordx4 v[40:43], v1, s[4:7], s3 offen offset:2048 sc1
    s_waitcnt vmcnt(0)
    v_max_u32_e64 v124, v40, v42
    v_cmp_eq_u32 vcc, -1, v124
    ds_write_b128 v1, v[40:43] offset:28928
    s_cbranch_vccz L_lateAf2
    s_sub_u32 s96, s96, 1
    s_cbranch_scc0 L_retry2f2
    s_branch L_abort
L_final2:
    ds_read_b128 v[80:83], v3 offset:0
    ds_read_b128 v[84:87], v3 offset:256
    ds_read_b128 v[88:91], v3 offset:2048
    v_mov_b64 v[60:61], 0
    v_mov_b64 v[62:63], 0
    v_mov_b64 v[64:65], 0
    v_mov_b64 v[66:67], 0
    v_mov_b64 v[68:69], 0
    v_mov_b64 v[70:71], 0
L_pollAf2:
    buffer_load_dwordx4 v[24:27], v1, s[4:7], s1 offen offset:2048 sc1
    v_mov_b64 v[48:49], 0
    v_mov_b64 v[50:51], 0
    v_mov_b64 v[52:53], 0
    v_mov_b64 v[54:55], 0
    v_mov_b64 v[56:57], 0
    v_mov_b64 v[58:59], 0
    buffer_load_dwordx4 v[40:43], v1, s[4:7], s3 offen offset:2048 sc1
    s_waitcnt vmcnt(1)
    v_max_u32_e64 v124, v24, v26
    v_cmp_eq_u32 vcc, -1, v124
    ds_write_b128 v1, v[24:27] offset:24832
    v_smfmac_f32_16x16x64_bf16 v[56:59], v[24:27], a[160:167], v11
    s_cbranch_vccnz L_againAf2
L_gotEf2:
    v_smfmac_f32_16x16x64_bf16 v[48:51], v[24:27], a[32:39], v11
    v_smfmac_f32_16x16x64_bf16 v[60:63], v[24:27], a[168:175], v11
    s_waitcnt vmcnt(0)
    v_max_u32 v124, v40, v42
    v_cmp_eq_u32 vcc, -1, v124
    ds_write_b128 v1, v[40:43] offset:28928
    v_smfmac_f32_16x16x64_bf16 v[52:55], v[24:27], a[40:47], v11
    s_cbranch_vccnz L_retryAf2
L_lateAf2:
    s_waitcnt lgkmcnt(1)
    s_barrier
    ds_read_b128 v[28:31], v1 offset:25856
    ds_read_b128 v[16:19], v1 offset:22784
    ds_read_b128 v[20:23], v1 offset:23808
    s_mov_b32 s52, 66846720
    buffer_store_dwordx4 v[112:115], v10, s[4:7], s52 offen offset:0 sc1
    buffer_store_dwordx4 v[116:119], v10, s[4:7], s52 offen offset:1024 sc1
    v_smfmac_f32_16x16x64_bf16 v[56:59], v[40:43], a[224:231], v11
    v_smfmac_f32_16x16x64_bf16 v[60:63], v[40:43], a[232:239], v11
    v_smfmac_f32_16x16x64_bf16 v[64:67], v[24:27], v[160:167], v11
    v_smfmac_f32_16x16x64_bf16 v[68:71], v[24:27], v[168:175], v11
    s_waitcnt lgkmcnt(2)
    s_barrier
    v_smfmac_f32_16x16x64_bf16 v[56:59], v[28:31], a[176:183], v11
    ds_read_b128 v[44:47], v1 offset:29952
    v_smfmac_f32_16x16x64_bf16 v[60:63], v[28:31], a[184:191], v11
    ds_read_b128 v[32:35], v1 offset:26880
    v_smfmac_f32_16x16x64_bf16 v[64:67], v[28:31], v[176:183], v11
    ds_read_b128 v[36:39], v1 offset:27904
    v_smfmac_f32_16x16x64_bf16 v[68:71], v[28:31], v[184:191], v11
    ds_read_b128 v[80:83], v2 offset:8192
    s_waitcnt lgkmcnt(5)
    v_smfmac_f32_16x16x64_bf16 v[56:59], v[16:19], a[128:135], v11
    ds_read_b128 v[84:87], v2 offset:9216
    v_smfmac_f32_16x16x64_bf16 v[60:63], v[16:19], a[136:143], v11
    ds_read_b128 v[88:91], v2 offset:10240
    v_smfmac_f32_16x16x64_bf16 v[64:67], v[16:19], v[128:135], v11
    ds_read_b128 v[92:95], v2 offset:11264
    v_smfmac_f32_16x16x64_bf16 v[68:71], v[16:19], v[136:143], v11
    ds_read_b128 v[96:99], v2 offset:12288
    s_waitcnt lgkmcnt(8)
    v_smfmac_f32_16x16x64_bf16 v[56:59], v[20:23], a[144:151], v11
    ds_read_b128 v[100:103], v2 offset:13312
    v_smfmac_f32_16x16x64_bf16 v[60:63], v[20:23], a[152:159], v11
    ds_read_b128 v[104:107], v2 offset:14336
    v_smfmac_f32_16x16x64_bf16 v[64:67], v[20:23], v[144:151], v11
    ds_read_b128 v[108:111], v2 offset:15360
    v_smfmac_f32_16x16x64_bf16 v[68:71], v[20:23], v[152:159], v11
    v_lshrrev_b32 v120, 8, v1
    v_lshlrev_b32 v120, 10, v120
    v_bfe_u32 v121, v1, 4, 4
    v_lshl_add_u32 v120, v121, 3, v120
    s_lshl_b32 s52, s14, 12
    s_add_u32 s52, s52, 66978304
    s_waitcnt lgkmcnt(6)
    v_smfmac_f32_16x16x64_bf16 v[64:67], v[40:43], v[80:87], v11
    ds_read_b128 v[80:83], v2 offset:0
    ds_read_b128 v[84:87], v2 offset:1024
    v_smfmac_f32_16x16x64_bf16 v[56:59], v[44:47], a[240:247], v11
    s_waitcnt lgkmcnt(6)
    v_smfmac_f32_16x16x64_bf16 v[68:71], v[40:43], v[88:95], v11
    ds_read_b128 v[88:91], v2 offset:2048
    ds_read_b128 v[92:95], v2 offset:3072
    v_smfmac_f32_16x16x64_bf16 v[60:63], v[44:47], a[248:255], v11
    s_waitcnt lgkmcnt(6)
    v_smfmac_f32_16x16x64_bf16 v[64:67], v[44:47], v[96:103], v11
    ds_read_b128 v[96:99], v2 offset:4096
    ds_read_b128 v[100:103], v2 offset:5120
    v_smfmac_f32_16x16x64_bf16 v[56:59], v[32:35], a[192:199], v11
    s_waitcnt lgkmcnt(6)
    v_smfmac_f32_16x16x64_bf16 v[68:71], v[44:47], v[104:111], v11
    ds_read_b128 v[104:107], v2 offset:6144
    ds_read_b128 v[108:111], v2 offset:7168
    v_smfmac_f32_16x16x64_bf16 v[60:63], v[32:35], a[200:207], v11
    s_waitcnt lgkmcnt(6)
    v_smfmac_f32_16x16x64_bf16 v[64:67], v[32:35], v[80:87], v11
    v_smfmac_f32_16x16x64_bf16 v[56:59], v[36:39], a[208:215], v11
    s_waitcnt lgkmcnt(4)
    v_smfmac_f32_16x16x64_bf16 v[68:71], v[32:35], v[88:95], v11
    v_smfmac_f32_16x16x64_bf16 v[60:63], v[36:39], a[216:223], v11
    s_waitcnt lgkmcnt(2)
    v_smfmac_f32_16x16x64_bf16 v[64:67], v[36:39], v[96:103], v11
    s_waitcnt lgkmcnt(0)
    v_smfmac_f32_16x16x64_bf16 v[68:71], v[36:39], v[104:111], v11
    v_add_f32 v56, v56, v57
    v_add_f32 v58, v58, v59
    v_cvt_pk_bf16_f32 v56, v56, v58
    v_add_f32 v60, v60, v61
    v_add_f32 v62, v62, v63
    v_cvt_pk_bf16_f32 v60, v60, v62
    s_nop 1
    v_add_f32 v64, v64, v65
    v_add_f32_e64 v66, v66, v67
    v_cvt_pk_bf16_f32 v57, v64, v66
    buffer_store_dwordx2 v[56:57], v120, s[4:7], s52 offen offset:0 sc1
    v_add_f32 v68, v68, v69
    v_add_f32 v70, v70, v71
    v_cvt_pk_bf16_f32 v61, v68, v70
    buffer_store_dwordx2 v[60:61], v120, s[4:7], s52 offen offset:128 sc1
    s_waitcnt vmcnt(0)
    s_endpgm
L_cstart3:
    v_mov_b32_e64 v14, v91
    ds_read_b128 v[80:83], v3 offset:0
    ds_read_b128 v[84:87], v3 offset:256
    ds_read_b128 v[88:91], v3 offset:2048
    ds_read_b128 v[92:95], v3 offset:2304
    ds_read_b128 v[96:99], v3 offset:4096
    ds_read_b128 v[100:103], v3 offset:4352
    ds_read_b128 v[104:107], v3 offset:6144
    ds_read_b128 v[108:111], v3 offset:6400
    ds_read_b64_tr_b16 v[72:73], v4 offset:14336
    ds_read_b64_tr_b16 v[74:75], v4 offset:14592
    ds_read_b64_tr_b16 v[76:77], v4 offset:15360
    ds_read_b64_tr_b16 v[78:79], v4 offset:15616
    v_mov_b64 v[48:49], 0
    v_mov_b64 v[50:51], 0
    v_mov_b64 v[52:53], 0
    v_mov_b64 v[54:55], 0
    v_mov_b64 v[56:57], 0
    v_mov_b64 v[58:59], 0
    v_mov_b64 v[60:61], 0
    v_mov_b64 v[62:63], 0
    v_mov_b64 v[64:65], 0
    v_mov_b64 v[66:67], 0
    v_mov_b64 v[68:69], 0
    v_mov_b64 v[70:71], 0
    v_mov_b64 v[112:113], 0
    v_mov_b64 v[114:115], 0
    v_mov_b64 v[116:117], 0
    v_mov_b64 v[118:119], 0
    s_add_u32 s58, s44, 1
    s_min_u32 s58, s58, 63
L_kvchkq3:
    v_cmp_gt_i32 vcc, s58, v14
    s_cbranch_vccz L_kvokq3
    buffer_load_dword v14, v13, s[4:7], s28 offen sc1
    s_waitcnt vmcnt(0)
    s_sub_u32 s96, s96, 1
    s_cbranch_scc0 L_kvchkq3
    s_branch L_abort
L_kvokq3:
    s_lshl_b32 s58, s58, 18
    s_add_u32 s58, s58, 33554432
    s_lshl_b32 s29, s44, 17
    s_cmp_gt_u32 s44, 56
    s_mov_b32 s52, 50333696
    s_cselect_b32 s52, 58591232, s52
    s_add_u32 s29, s29, s52
    s_sub_u32 s52, s44, 2
    s_max_i32 s52, s52, -1
    v_mov_b32 v12, s52
    s_waitcnt lgkmcnt(0)
    s_barrier
.p2align 6
L_top3:
    ds_read_b128 v[80:83], v3 offset:0
    ds_read_b128 v[84:87], v3 offset:256
    ds_read_b128 v[88:91], v3 offset:2048
    v_mov_b64 v[60:61], 0
    v_mov_b64 v[62:63], 0
    v_mov_b64 v[64:65], 0
    v_mov_b64 v[66:67], 0
    v_mov_b64 v[68:69], 0
    v_mov_b64 v[70:71], 0
L_pollA3:
    buffer_load_dwordx4 v[28:31], v1, s[4:7], s1 offen offset:3072 sc1
    v_mov_b64 v[48:49], 0
    v_mov_b64 v[50:51], 0
    v_mov_b64 v[52:53], 0
    v_mov_b64 v[54:55], 0
    v_mov_b64 v[56:57], 0
    v_mov_b64 v[58:59], 0
    buffer_load_dwordx4 v[44:47], v1, s[4:7], s3 offen offset:3072 sc1
    s_waitcnt vmcnt(1)
    v_max_u32_e64 v124, v28, v30
    v_cmp_eq_u32 vcc, -1, v124
    ds_write_b128 v1, v[28:31] offset:25856
    v_smfmac_f32_16x16x64_bf16 v[56:59], v[28:31], a[176:183], v11
    s_cbranch_vccnz L_againA3
L_gotE3:
    v_smfmac_f32_16x16x64_bf16 v[48:51], v[28:31], a[48:55], v11
    v_smfmac_f32_16x16x64_bf16 v[60:63], v[28:31], a[184:191], v11
    s_waitcnt vmcnt(0)
    v_max_u32 v124, v44, v46
    v_cmp_eq_u32 vcc, -1, v124
    ds_write_b128 v1, v[44:47] offset:29952
    v_smfmac_f32_16x16x64_bf16 v[52:55], v[28:31], a[56:63], v11
    s_cbranch_vccnz L_retryA3
L_lateA3:
    s_waitcnt lgkmcnt(1)
    s_barrier
    v_smfmac_f32_16x16x64_bf16 v[56:59], v[44:47], a[240:247], v11
    ds_read_b128 v[16:19], v1 offset:22784
    v_smfmac_f32_16x16x64_bf16 v[48:51], v[44:47], a[112:119], v11
    ds_read_b128 v[20:23], v1 offset:23808
    v_smfmac_f32_16x16x64_bf16 v[60:63], v[44:47], a[248:255], v11
    ds_read_b128 v[24:27], v1 offset:24832
    buffer_store_dword v12, v13, s[4:7], s30 offen sc1
    v_smfmac_f32_16x16x64_bf16 v[52:55], v[44:47], a[120:127], v11
    s_mov_b32 m0, 8192
    v_smfmac_f32_16x16x64_bf16 v[64:67], v[28:31], v[176:183], v11
    buffer_load_dwordx4 v9, s[4:7], s58 offen offset:0 sc1 lds
    v_smfmac_f32_16x16x64_bf16 v[68:71], v[28:31], v[184:191], v11
    buffer_load_dwordx4 v9, s[4:7], s58 offen offset:1024 sc1 lds
    s_waitcnt lgkmcnt(2)
    s_barrier
    v_smfmac_f32_16x16x64_bf16 v[56:59], v[16:19], a[128:135], v11
    ds_read_b128 v[32:35], v1 offset:26880
    v_smfmac_f32_16x16x64_bf16 v[48:51], v[16:19], a[0:7], v11
    ds_read_b128 v[36:39], v1 offset:27904
    v_smfmac_f32_16x16x64_bf16 v[60:63], v[16:19], a[136:143], v11
    ds_read_b128 v[40:43], v1 offset:28928
    v_smfmac_f32_16x16x64_bf16 v[52:55], v[16:19], a[8:15], v11
    buffer_load_dwordx4 v9, s[4:7], s58 offen offset:2048 sc1 lds
    s_waitcnt lgkmcnt(4)
    v_smfmac_f32_16x16x64_bf16 v[56:59], v[20:23], a[144:151], v11
    buffer_load_dwordx4 v9, s[4:7], s58 offen offset:3072 sc1 lds
    v_smfmac_f32_16x16x64_bf16 v[48:51], v[20:23], a[16:23], v11
    s_mov_b32 m0, 12288
    s_add_u32 s58, s58, 4096
    v_smfmac_f32_16x16x64_bf16 v[60:63], v[20:23], a[152:159], v11
    buffer_load_dwordx4 v9, s[4:7], s58 offen offset:0 sc1 lds
    v_smfmac_f32_16x16x64_bf16 v[52:55], v[20:23], a[24:31], v11
    buffer_load_dwordx4 v9, s[4:7], s58 offen offset:1024 sc1 lds
    s_waitcnt lgkmcnt(3)
    v_smfmac_f32_16x16x64_bf16 v[56:59], v[24:27], a[160:167], v11
    buffer_load_dwordx4 v9, s[4:7], s58 offen offset:2048 sc1 lds
    v_smfmac_f32_16x16x64_bf16 v[48:51], v[24:27], a[32:39], v11
    v_smfmac_f32_16x16x64_bf16 v[60:63], v[24:27], a[168:175], v11
    v_smfmac_f32_16x16x64_bf16 v[52:55], v[24:27], a[40:47], v11
    s_waitcnt lgkmcnt(2)
    v_smfmac_f32_16x16x64_bf16 v[56:59], v[32:35], a[192:199], v11
    v_smfmac_f32_16x16x64_bf16 v[48:51], v[32:35], a[64:71], v11
    v_smfmac_f32_16x16x64_bf16 v[60:63], v[32:35], a[200:207], v11
    v_smfmac_f32_16x16x64_bf16 v[52:55], v[32:35], a[72:79], v11
    s_waitcnt lgkmcnt(0)
    v_smfmac_f32_16x16x64_bf16 v[56:59], v[36:39], a[208:215], v11
    v_smfmac_f32_16x16x64_bf16 v[48:51], v[36:39], a[80:87], v11
    v_smfmac_f32_16x16x64_bf16 v[56:59], v[40:43], a[224:231], v11
    v_smfmac_f32_16x16x64_bf16 v[48:51], v[40:43], a[96:103], v11
    v_smfmac_f32_16x16x64_bf16 v[60:63], v[36:39], a[216:223], v11
    v_smfmac_f32_16x16x64_bf16 v[60:63], v[40:43], a[232:239], v11
    v_add_f32 v56, v56, v57
    v_smfmac_f32_16x16x64_bf16 v[52:55], v[36:39], a[88:95], v11
    v_add_f32_e64 v58, v58, v59
    v_smfmac_f32_16x16x64_bf16 v[52:55], v[40:43], a[104:111], v11
    v_add_f32 v48, v48, v49
    v_add_f32 v50, v50, v51
    v_cvt_pk_bf16_f32 v56, v56, v58
    v_cvt_pk_bf16_f32 v57, v48, v50
    ds_write_b64 v6, v[56:57] offset:17152
L_qkdone3:
    v_add_f32 v60, v60, v61
    v_add_f32 v62, v62, v63
    v_cvt_pk_bf16_f32 v60, v60, v62
    v_add_f32 v52, v52, v53
    v_add_f32 v54, v54, v55
    v_cvt_pk_bf16_f32 v61, v52, v54
    ds_write_b64 v6, v[60:61] offset:17280
    v_smfmac_f32_16x16x64_bf16 v[64:67], v[16:19], v[128:135], v11
    buffer_load_dwordx4 v9, s[4:7], s58 offen offset:3072 sc1 lds
    v_smfmac_f32_16x16x64_bf16 v[68:71], v[16:19], v[136:143], v11
    buffer_load_dword v14, v13, s[4:7], s28 offen sc1
    v_smfmac_f32_16x16x64_bf16 v[64:67], v[20:23], v[144:151], v11
    buffer_store_dwordx4 v[112:115], v10, s[4:7], s29 offen offset:0 sc1
    v_smfmac_f32_16x16x64_bf16 v[68:71], v[20:23], v[152:159], v11
    buffer_store_dwordx4 v[116:119], v10, s[4:7], s29 offen offset:1024 sc1
    s_waitcnt lgkmcnt(0)
    s_barrier
    ds_read_b64_tr_b16 v[48:49], v5 offset:16384
    ds_read_b64_tr_b16 v[50:51], v5 offset:16416
    ds_read_b64_tr_b16 v[52:53], v5 offset:16640
    ds_read_b64_tr_b16 v[54:55], v5 offset:16672
    ds_read_b64_tr_b16 v[56:57], v5 offset:16896
    ds_read_b64_tr_b16 v[58:59], v5 offset:16928
    ds_read_b64_tr_b16 v[60:61], v5 offset:17152
    ds_read_b64_tr_b16 v[62:63], v5 offset:17184
    v_smfmac_f32_16x16x64_bf16 v[64:67], v[24:27], v[160:167], v11
    v_smfmac_f32_16x16x64_bf16 v[68:71], v[24:27], v[168:175], v11
    ds_read_b128 v[16:19], v2 offset:0
    ds_read_b128 v[20:23], v2 offset:1024
    s_waitcnt lgkmcnt(8)
    v_mfma_f32_16x16x32_bf16 v[116:119], v[80:83], v[48:51], 0
    ds_read_b128 v[24:27], v2 offset:2048
    v_mfma_f32_16x16x32_bf16 v[120:123], v[84:87], v[48:51], 0
    ds_read_b128 v[28:31], v2 offset:3072
    v_mfma_f32_16x16x32_bf16 v[124:127], v[48:51], v[48:51], 0
    ds_read_b128 v[80:83], v2 offset:4096
    s_waitcnt lgkmcnt(9)
    v_mfma_f32_16x16x32_bf16 v[116:119], v[88:91], v[52:55], v[116:119]
    ds_read_b128 v[84:87], v2 offset:5120
    v_mfma_f32_16x16x32_bf16 v[120:123], v[92:95], v[52:55], v[120:123]
    ds_read_b128 v[88:91], v2 offset:6144
    v_mfma_f32_16x16x32_bf16 v[124:127], v[52:55], v[52:55], v[124:127]
    ds_read_b128 v[92:95], v2 offset:7168
    s_waitcnt lgkmcnt(10)
    v_mfma_f32_16x16x32_bf16 v[116:119], v[96:99], v[56:59], v[116:119]
    ds_read_b128 v[48:51], v2 offset:12288
    v_mfma_f32_16x16x32_bf16 v[120:123], v[100:103], v[56:59], v[120:123]
    ds_read_b128 v[52:55], v2 offset:13312
    v_mfma_f32_16x16x32_bf16 v[124:127], v[56:59], v[56:59], v[124:127]
    ds_read_b128 v[96:99], v2 offset:8192
    s_waitcnt lgkmcnt(11)
    v_mfma_f32_16x16x32_bf16 v[116:119], v[104:107], v[60:63], v[116:119]
    ds_read_b128 v[100:103], v2 offset:9216
    v_mfma_f32_16x16x32_bf16 v[120:123], v[108:111], v[60:63], v[120:123]
    ds_read_b128 v[104:107], v2 offset:10240
    v_mfma_f32_16x16x32_bf16 v[124:127], v[60:63], v[60:63], v[124:127]
    ds_read_b128 v[108:111], v2 offset:11264
    ds_read_b128 v[56:59], v2 offset:14336
    s_waitcnt lgkmcnt(11)
    v_smfmac_f32_16x16x64_bf16 v[64:67], v[32:35], v[16:23], v11
    ds_read_b128 v[60:63], v2 offset:15360
    v_max3_f32 v112, v116, v117, v118
    v_smfmac_f32_16x16x64_bf16 v[68:71], v[32:35], v[24:31], v11
    v_max3_f32 v113, v119, v120, v121
    s_waitcnt lgkmcnt(8)
    v_smfmac_f32_16x16x64_bf16 v[64:67], v[36:39], v[80:87], v11
    v_max3_f32 v112, v112, v122, v123
    v_max3_f32 v126, v113, v124, v125
    v_smfmac_f32_16x16x64_bf16 v[68:71], v[36:39], v[88:95], v11
    v_max_f32 v127, v112, v126
    v_max_f32_e64 v126, v112, v126
    s_waitcnt lgkmcnt(4)
    v_smfmac_f32_16x16x64_bf16 v[64:67], v[44:47], v[48:55], v11
    s_nop 0
    v_permlane16_swap_b32 v126, v127
    v_smfmac_f32_16x16x64_bf16 v[64:67], v[40:43], v[96:103], v11
    v_max_f32 v112, v126, v127
    v_max_f32_e64 v113, v126, v127
    s_waitcnt lgkmcnt(0)
    v_smfmac_f32_16x16x64_bf16 v[68:71], v[40:43], v[104:111], v11
    s_nop 0
    v_permlane32_swap_b32 v112, v113
    v_smfmac_f32_16x16x64_bf16 v[68:71], v[44:47], v[56:63], v11
    v_max_f32 v126, v112, v113
    v_mul_f32 v126, s55, v126
    v_mov_b32 v12, s44
    v_mov_b64 v[16:17], s[78:79]
    v_mov_b64_e64 v[18:19], s[78:79]
    v_pk_fma_f32 v[116:117], v[116:117], s[32:33], v[126:127] op_sel_hi:[1,1,0] neg_lo:[0,0,1] neg_hi:[0,0,1]
    v_pk_fma_f32 v[118:119], v[118:119], s[32:33], v[126:127] op_sel_hi:[1,1,0] neg_lo:[0,0,1] neg_hi:[0,0,1]
    v_pk_fma_f32 v[120:121], v[120:121], s[32:33], v[126:127] op_sel_hi:[1,1,0] neg_lo:[0,0,1] neg_hi:[0,0,1]
    v_pk_fma_f32 v[122:123], v[122:123], s[32:33], v[126:127] op_sel_hi:[1,1,0] neg_lo:[0,0,1] neg_hi:[0,0,1]
    v_pk_fma_f32 v[124:125], v[124:125], s[32:33], v[126:127] op_sel_hi:[1,1,0] neg_lo:[0,0,1] neg_hi:[0,0,1]
    v_exp_f32 v116, v116
    v_exp_f32 v117, v117
    v_exp_f32_e64 v118, v118
    v_cvt_pk_bf16_f32 v112, v116, v117
    v_exp_f32 v119, v119
    v_exp_f32 v120, v120
    v_cvt_pk_bf16_f32 v113, v118, v119
    v_exp_f32 v121, v121
    v_exp_f32 v122, v122
    v_cvt_pk_bf16_f32 v114, v120, v121
    v_exp_f32 v123, v123
    v_exp_f32 v124, v124
    v_cvt_pk_bf16_f32 v115, v122, v123
    v_exp_f32 v125, v125
    v_add_f32 v64, v64, v65
    v_mfma_f32_16x16x32_bf16 v[20:23], v[16:19], v[112:115], 0
    v_cvt_pk_bf16_f32 v124, v124, v125
    v_mov_b32_e64 v125, 0
    v_mfma_f32_16x16x32_bf16 v[24:27], v[72:75], v[112:115], 0
    v_add_f32 v66, v66, v67
    v_add_f32 v68, v68, v69
    v_mfma_f32_16x16x32_bf16 v[28:31], v[76:79], v[112:115], 0
    v_cvt_pk_bf16_f32 v64, v64, v66
    v_mov_b32_e64 v65, 0
    v_mfma_f32_16x16x16_bf16 v[20:23], v[16:17], v[124:125], v[20:23]
    v_add_f32 v70, v70, v71
    v_mov_b32 v69, 0
    v_cvt_pk_bf16_f32 v68, v68, v70
    v_mfma_f32_16x16x16_bf16 v[24:27], v[64:65], v[124:125], v[24:27]
    ds_read_b128 v[80:83], v2 offset:16384
    v_mfma_f32_16x16x16_bf16 v[28:31], v[68:69], v[124:125], v[28:31]
    v_rcp_f32_e64 v20, v20
    ds_read_b128 v[84:87], v2 offset:17408
    ds_read_b128 v[88:91], v2 offset:24576
    ds_read_b128 v[92:95], v2 offset:25600
    buffer_store_dword v12, v0, s[4:7], s59 offen
    v_pk_mul_f32 v[24:25], v[24:25], v[20:21] op_sel_hi:[1,0]
    v_pk_mul_f32 v[26:27], v[26:27], v[20:21] op_sel_hi:[1,0]
    v_cvt_pk_bf16_f32 v16, v24, v25
    v_cvt_pk_bf16_f32 v17, v26, v27
    v_pk_mul_f32 v[28:29], v[28:29], v[20:21] op_sel_hi:[1,0]
    v_pk_mul_f32 v[30:31], v[30:31], v[20:21] op_sel_hi:[1,0]
    v_cvt_pk_bf16_f32 v18, v28, v29
    v_cvt_pk_bf16_f32 v19, v30, v31
    s_mov_b64 exec, s[56:57]
    ds_write_b128 v7, v[16:19] offset:22272
    s_mov_b64 exec, -1
    v_mov_b64 v[112:113], 0
    v_mov_b64 v[114:115], 0
    v_mov_b64 v[116:117], 0
    v_mov_b64 v[118:119], 0
    v_mov_b64 v[120:121], 0
    v_mov_b64 v[122:123], 0
    v_mov_b64 v[124:125], 0
    v_mov_b64 v[126:127], 0
    ds_read_b128 v[48:51], v2 offset:18432
    ds_read_b128 v[52:55], v2 offset:19456
    s_waitcnt lgkmcnt(2)
    s_barrier
    ds_read_b128 v[72:75], v1 offset:20736
    ds_read_b128 v[76:79], v1 offset:21760
    v_mov_b64 v[16:17], 0
    v_mov_b64 v[18:19], 0
    v_mov_b64 v[20:21], 0
    v_mov_b64 v[22:23], 0
    v_mov_b64 v[24:25], 0
    v_mov_b64 v[26:27], 0
    v_mov_b64 v[28:29], 0
    v_mov_b64 v[30:31], 0
    ds_read_b128 v[96:99], v2 offset:26624
    ds_read_b128 v[100:103], v2 offset:27648
    ds_read_b128 v[104:107], v2 offset:20480
    s_waitcnt lgkmcnt(4)
    v_smfmac_f32_16x16x64_bf16 v[112:115], v[72:75], v[192:199], v11
    ds_read_b128 v[108:111], v2 offset:21504
    s_waitcnt lgkmcnt(4)
    v_smfmac_f32_16x16x64_bf16 v[112:115], v[76:79], v[200:207], v11
    ds_read_b128 v[56:59], v2 offset:28672
    v_smfmac_f32_16x16x64_bf16 v[116:119], v[72:75], v[208:215], v11
    ds_read_b128 v[60:63], v2 offset:29696
    v_smfmac_f32_16x16x64_bf16 v[116:119], v[76:79], v[216:223], v11
    v_add_f32 v112, v112, v113
    v_add_f32 v114, v114, v115
    v_smfmac_f32_16x16x64_bf16 v[120:123], v[72:75], v[224:231], v11
    ds_read_b128 v[32:35], v2 offset:22528
    v_smfmac_f32_16x16x64_bf16 v[120:123], v[76:79], v[232:239], v11
    v_add_f32 v116, v116, v117
    v_add_f32 v118, v118, v119
    v_smfmac_f32_16x16x64_bf16 v[124:127], v[72:75], v[240:247], v11
    v_cvt_pk_bf16_f32 v112, v112, v116
    v_cvt_pk_bf16_f32 v114, v114, v118
    v_smfmac_f32_16x16x64_bf16 v[124:127], v[76:79], v[248:255], v11
    v_bfi_b32 v112, 1, s47, v112
    v_add_f32 v120, v120, v121
    v_add_f32 v122, v122, v123
    v_smfmac_f32_16x16x64_bf16 v[16:19], v[72:75], v[80:87], v11
    ds_read_b128 v[36:39], v2 offset:23552
    v_smfmac_f32_16x16x64_bf16 v[16:19], v[76:79], v[88:95], v11
    v_add_f32 v124, v124, v125
    v_add_f32 v126, v126, v127
    v_cvt_pk_bf16_f32 v113, v120, v124
    v_cvt_pk_bf16_f32 v115, v122, v126
    buffer_store_dwordx4 v[112:115], v8, s[4:7], s45 offen
    ds_read_b128 v[40:43], v2 offset:30720
    v_smfmac_f32_16x16x64_bf16 v[20:23], v[72:75], v[48:55], v11
    ds_read_b128 v[44:47], v2 offset:31744
    s_waitcnt lgkmcnt(8)
    v_smfmac_f32_16x16x64_bf16 v[20:23], v[76:79], v[96:103], v11
    v_add_f32 v16, v16, v17
    v_add_f32 v18, v18, v19
    s_waitcnt lgkmcnt(6)
    v_smfmac_f32_16x16x64_bf16 v[24:27], v[72:75], v[104:111], v11
    s_waitcnt lgkmcnt(4)
    v_smfmac_f32_16x16x64_bf16 v[24:27], v[76:79], v[56:63], v11
    v_add_f32 v20, v20, v21
    v_add_f32 v22, v22, v23
    s_waitcnt lgkmcnt(2)
    v_smfmac_f32_16x16x64_bf16 v[28:31], v[72:75], v[32:39], v11
    v_cvt_pk_bf16_f32 v16, v16, v20
    v_cvt_pk_bf16_f32 v18, v18, v22
    s_waitcnt lgkmcnt(0)
    v_smfmac_f32_16x16x64_bf16 v[28:31], v[76:79], v[40:47], v11
    v_bfi_b32 v16, 1, s47, v16
    v_add_f32 v24, v24, v25
    v_add_f32 v26, v26, v27
    s_nop 4
    v_add_f32 v28, v28, v29
    v_add_f32 v30, v30, v31
    v_cvt_pk_bf16_f32 v17, v24, v28
    v_cvt_pk_bf16_f32 v19, v26, v30
    buffer_store_dwordx4 v[16:19], v8, s[4:7], s46 offen
    ds_write_b32 v6, v64 offset:17156
    ds_write_b32 v6, v68 offset:17284
    s_mov_b32 s2, s44
    s_add_u32 s44, s44, 1
    s_mov_b32 s51, s48
    s_mov_b32 s48, s49
    s_mov_b32 s49, s50
    s_mov_b32 s50, s51
    s_add_u32 s1, s48, s0
    s_add_u32 s3, s1, 4096
    s_waitcnt vmcnt(2) lgkmcnt(0)
    s_barrier
    ds_read_b128 v[92:95], v3 offset:2304
    ds_read_b128 v[96:99], v3 offset:4096
    ds_read_b128 v[100:103], v3 offset:4352
    ds_read_b128 v[104:107], v3 offset:6144
    ds_read_b128 v[108:111], v3 offset:6400
    ds_read_b64_tr_b16 v[72:73], v4 offset:14336
    ds_read_b64_tr_b16 v[74:75], v4 offset:14592
    ds_read_b64_tr_b16 v[76:77], v4 offset:15360
    ds_read_b64_tr_b16 v[78:79], v4 offset:15616
    ds_read_b128 v[112:115], v1 offset:18560
    ds_read_b128 v[116:119], v1 offset:19616
    s_add_u32 s58, s44, 1
    s_min_u32 s58, s58, 63
L_kvchks3:
    v_cmp_gt_i32 vcc, s58, v14
    s_cbranch_vccz L_kvoks3
    buffer_load_dword v14, v13, s[4:7], s28 offen sc1
    s_waitcnt vmcnt(0)
    s_sub_u32 s96, s96, 1
    s_cbranch_scc0 L_kvchks3
    s_branch L_abort
L_kvoks3:
    s_lshl_b32 s58, s58, 18
    s_add_u32 s58, s58, 33554432
    s_lshl_b32 s29, s44, 17
    s_cmp_gt_u32 s44, 56
    s_mov_b32 s52, 50333696
    s_cselect_b32 s52, 58591232, s52
    s_add_u32 s29, s29, s52
    s_sub_u32 s52, s44, 2
    s_max_i32 s52, s52, -1
    v_mov_b32 v12, s52
    s_xor_b32 s47, s47, 1
    s_waitcnt lgkmcnt(0)
    s_cmp_lt_u32 s44, 63
    s_barrier
    s_cbranch_scc1 L_top3
    s_branch L_final3
L_againA3:
    s_waitcnt vmcnt(0) lgkmcnt(0)
    s_nop 7
    v_mov_b64 v[56:57], 0
    v_mov_b64 v[58:59], 0
    s_sub_u32 s96, s96, 1
    s_cbranch_scc0 L_pollA3
    s_branch L_abort
L_retryA3:
L_retry23:
    s_waitcnt lgkmcnt(0)
    buffer_load_dwordx4 v[44:47], v1, s[4:7], s3 offen offset:3072 sc1
    s_waitcnt vmcnt(0)
    v_max_u32_e64 v124, v44, v46
    v_cmp_eq_u32 vcc, -1, v124
    ds_write_b128 v1, v[44:47] offset:29952
    s_cbranch_vccz L_lateA3
    s_sub_u32 s96, s96, 1
    s_cbranch_scc0 L_retry23
    s_branch L_abort
L_againAf3:
    s_waitcnt vmcnt(0) lgkmcnt(0)
    s_nop 7
    v_mov_b64 v[56:57], 0
    v_mov_b64 v[58:59], 0
    s_sub_u32 s96, s96, 1
    s_cbranch_scc0 L_pollAf3
    s_branch L_abort
L_retryAf3:
L_retry2f3:
    s_waitcnt lgkmcnt(0)
    buffer_load_dwordx4 v[44:47], v1, s[4:7], s3 offen offset:3072 sc1
    s_waitcnt vmcnt(0)
    v_max_u32_e64 v124, v44, v46
    v_cmp_eq_u32 vcc, -1, v124
    ds_write_b128 v1, v[44:47] offset:29952
    s_cbranch_vccz L_lateAf3
    s_sub_u32 s96, s96, 1
    s_cbranch_scc0 L_retry2f3
    s_branch L_abort
L_final3:
    ds_read_b128 v[80:83], v3 offset:0
    ds_read_b128 v[84:87], v3 offset:256
    ds_read_b128 v[88:91], v3 offset:2048
    v_mov_b64 v[60:61], 0
    v_mov_b64 v[62:63], 0
    v_mov_b64 v[64:65], 0
    v_mov_b64 v[66:67], 0
    v_mov_b64 v[68:69], 0
    v_mov_b64 v[70:71], 0
L_pollAf3:
    buffer_load_dwordx4 v[28:31], v1, s[4:7], s1 offen offset:3072 sc1
    v_mov_b64 v[48:49], 0
    v_mov_b64 v[50:51], 0
    v_mov_b64 v[52:53], 0
    v_mov_b64 v[54:55], 0
    v_mov_b64 v[56:57], 0
    v_mov_b64 v[58:59], 0
    buffer_load_dwordx4 v[44:47], v1, s[4:7], s3 offen offset:3072 sc1
    s_waitcnt vmcnt(1)
    v_max_u32_e64 v124, v28, v30
    v_cmp_eq_u32 vcc, -1, v124
    ds_write_b128 v1, v[28:31] offset:25856
    v_smfmac_f32_16x16x64_bf16 v[56:59], v[28:31], a[176:183], v11
    s_cbranch_vccnz L_againAf3
L_gotEf3:
    v_smfmac_f32_16x16x64_bf16 v[48:51], v[28:31], a[48:55], v11
    v_smfmac_f32_16x16x64_bf16 v[60:63], v[28:31], a[184:191], v11
    s_waitcnt vmcnt(0)
    v_max_u32 v124, v44, v46
    v_cmp_eq_u32 vcc, -1, v124
    ds_write_b128 v1, v[44:47] offset:29952
    v_smfmac_f32_16x16x64_bf16 v[52:55], v[28:31], a[56:63], v11
    s_cbranch_vccnz L_retryAf3
L_lateAf3:
    s_waitcnt lgkmcnt(1)
    s_barrier
    ds_read_b128 v[16:19], v1 offset:22784
    ds_read_b128 v[20:23], v1 offset:23808
    ds_read_b128 v[24:27], v1 offset:24832
    buffer_store_dword v12, v13, s[4:7], s30 offen sc1
    s_mov_b32 s52, 66848768
    buffer_store_dwordx4 v[112:115], v10, s[4:7], s52 offen offset:0 sc1
    buffer_store_dwordx4 v[116:119], v10, s[4:7], s52 offen offset:1024 sc1
    v_smfmac_f32_16x16x64_bf16 v[56:59], v[44:47], a[240:247], v11
    v_smfmac_f32_16x16x64_bf16 v[60:63], v[44:47], a[248:255], v11
    v_smfmac_f32_16x16x64_bf16 v[64:67], v[28:31], v[176:183], v11
    v_smfmac_f32_16x16x64_bf16 v[68:71], v[28:31], v[184:191], v11
    s_waitcnt lgkmcnt(2)
    s_barrier
    v_smfmac_f32_16x16x64_bf16 v[56:59], v[16:19], a[128:135], v11
    ds_read_b128 v[32:35], v1 offset:26880
    v_smfmac_f32_16x16x64_bf16 v[60:63], v[16:19], a[136:143], v11
    ds_read_b128 v[36:39], v1 offset:27904
    v_smfmac_f32_16x16x64_bf16 v[64:67], v[16:19], v[128:135], v11
    ds_read_b128 v[40:43], v1 offset:28928
    v_smfmac_f32_16x16x64_bf16 v[68:71], v[16:19], v[136:143], v11
    ds_read_b128 v[80:83], v2 offset:12288
    s_waitcnt lgkmcnt(5)
    v_smfmac_f32_16x16x64_bf16 v[56:59], v[20:23], a[144:151], v11
    ds_read_b128 v[84:87], v2 offset:13312
    v_smfmac_f32_16x16x64_bf16 v[60:63], v[20:23], a[152:159], v11
    ds_read_b128 v[88:91], v2 offset:14336
    v_smfmac_f32_16x16x64_bf16 v[64:67], v[20:23], v[144:151], v11
    ds_read_b128 v[92:95], v2 offset:15360
    v_smfmac_f32_16x16x64_bf16 v[68:71], v[20:23], v[152:159], v11
    ds_read_b128 v[96:99], v2 offset:0
    s_waitcnt lgkmcnt(8)
    v_smfmac_f32_16x16x64_bf16 v[56:59], v[24:27], a[160:167], v11
    ds_read_b128 v[100:103], v2 offset:1024
    v_smfmac_f32_16x16x64_bf16 v[60:63], v[24:27], a[168:175], v11
    ds_read_b128 v[104:107], v2 offset:2048
    v_smfmac_f32_16x16x64_bf16 v[64:67], v[24:27], v[160:167], v11
    ds_read_b128 v[108:111], v2 offset:3072
    v_smfmac_f32_16x16x64_bf16 v[68:71], v[24:27], v[168:175], v11
    v_lshrrev_b32 v120, 8, v1
    v_lshlrev_b32 v120, 10, v120
    v_bfe_u32 v121, v1, 4, 4
    v_lshl_add_u32 v120, v121, 3, v120
    s_lshl_b32 s52, s14, 12
    s_add_u32 s52, s52, 66978560
    s_waitcnt lgkmcnt(6)
    v_smfmac_f32_16x16x64_bf16 v[64:67], v[44:47], v[80:87], v11
    ds_read_b128 v[80:83], v2 offset:4096
    ds_read_b128 v[84:87], v2 offset:5120
    v_smfmac_f32_16x16x64_bf16 v[56:59], v[32:35], a[192:199], v11
    s_waitcnt lgkmcnt(6)
    v_smfmac_f32_16x16x64_bf16 v[68:71], v[44:47], v[88:95], v11
    ds_read_b128 v[88:91], v2 offset:6144
    ds_read_b128 v[92:95], v2 offset:7168
    v_smfmac_f32_16x16x64_bf16 v[60:63], v[32:35], a[200:207], v11
    s_waitcnt lgkmcnt(6)
    v_smfmac_f32_16x16x64_bf16 v[64:67], v[32:35], v[96:103], v11
    ds_read_b128 v[96:99], v2 offset:8192
    ds_read_b128 v[100:103], v2 offset:9216
    v_smfmac_f32_16x16x64_bf16 v[56:59], v[36:39], a[208:215], v11
    s_waitcnt lgkmcnt(6)
    v_smfmac_f32_16x16x64_bf16 v[68:71], v[32:35], v[104:111], v11
    ds_read_b128 v[104:107], v2 offset:10240
    ds_read_b128 v[108:111], v2 offset:11264
    v_smfmac_f32_16x16x64_bf16 v[60:63], v[36:39], a[216:223], v11
    s_waitcnt lgkmcnt(6)
    v_smfmac_f32_16x16x64_bf16 v[64:67], v[36:39], v[80:87], v11
    v_smfmac_f32_16x16x64_bf16 v[56:59], v[40:43], a[224:231], v11
    s_waitcnt lgkmcnt(4)
    v_smfmac_f32_16x16x64_bf16 v[68:71], v[36:39], v[88:95], v11
    v_smfmac_f32_16x16x64_bf16 v[60:63], v[40:43], a[232:239], v11
    s_waitcnt lgkmcnt(2)
    v_smfmac_f32_16x16x64_bf16 v[64:67], v[40:43], v[96:103], v11
    s_waitcnt lgkmcnt(0)
    v_smfmac_f32_16x16x64_bf16 v[68:71], v[40:43], v[104:111], v11
    v_add_f32 v56, v56, v57
    v_add_f32 v58, v58, v59
    v_cvt_pk_bf16_f32 v56, v56, v58
    v_add_f32 v60, v60, v61
    v_add_f32 v62, v62, v63
    v_cvt_pk_bf16_f32 v60, v60, v62
    s_nop 1
    v_add_f32 v64, v64, v65
    v_add_f32_e64 v66, v66, v67
    v_cvt_pk_bf16_f32 v57, v64, v66
    buffer_store_dwordx2 v[56:57], v120, s[4:7], s52 offen offset:0 sc1
    v_add_f32 v68, v68, v69
    v_add_f32 v70, v70, v71
    v_cvt_pk_bf16_f32 v61, v68, v70
    buffer_store_dwordx2 v[60:61], v120, s[4:7], s52 offen offset:128 sc1
    s_waitcnt vmcnt(0)
    s_endpgm
L_cstart0X:
    ds_read_b128 v[80:83], v3 offset:0
    ds_read_b128 v[84:87], v3 offset:256
    ds_read_b128 v[88:91], v3 offset:2048
    ds_read_b128 v[92:95], v3 offset:2304
    ds_read_b128 v[96:99], v3 offset:4096
    ds_read_b128 v[100:103], v3 offset:4352
    ds_read_b128 v[104:107], v3 offset:6144
    ds_read_b128 v[108:111], v3 offset:6400
    ds_read_b64_tr_b16 v[72:73], v4 offset:8192
    ds_read_b64_tr_b16 v[74:75], v4 offset:8448
    ds_read_b64_tr_b16 v[76:77], v4 offset:9216
    ds_read_b64_tr_b16 v[78:79], v4 offset:9472
    v_mov_b64 v[48:49], 0
    v_mov_b64 v[50:51], 0
    v_mov_b64 v[52:53], 0
    v_mov_b64 v[54:55], 0
    v_mov_b64 v[56:57], 0
    v_mov_b64 v[58:59], 0
    v_mov_b64 v[60:61], 0
    v_mov_b64 v[62:63], 0
    v_mov_b64 v[64:65], 0
    v_mov_b64 v[66:67], 0
    v_mov_b64 v[68:69], 0
    v_mov_b64 v[70:71], 0
    s_waitcnt lgkmcnt(0)
    s_barrier
.p2align 6
L_top0X:
    ds_read_b128 v[80:83], v3 offset:0
    ds_read_b128 v[84:87], v3 offset:256
    ds_read_b128 v[88:91], v3 offset:2048
    v_mov_b64 v[60:61], 0
    v_mov_b64 v[62:63], 0
    v_mov_b64 v[64:65], 0
    v_mov_b64 v[66:67], 0
    v_mov_b64 v[68:69], 0
    v_mov_b64 v[70:71], 0
L_pollA0X:
    buffer_load_dwordx4 v[16:19], v1, s[4:7], s1 offen offset:0 sc1
    v_mov_b64 v[48:49], 0
    v_mov_b64 v[50:51], 0
    v_mov_b64 v[52:53], 0
    v_mov_b64 v[54:55], 0
    v_mov_b64 v[56:57], 0
    v_mov_b64 v[58:59], 0
    buffer_load_dwordx4 v[32:35], v1, s[4:7], s3 offen offset:0 sc1
    s_waitcnt vmcnt(1)
    v_max_u32_e64 v124, v16, v18
    v_cmp_eq_u32 vcc, -1, v124
    ds_write_b128 v1, v[16:19] offset:22784
    v_smfmac_f32_16x16x64_bf16 v[56:59], v[16:19], a[128:135], v11
    s_cbranch_vccnz L_againA0X
L_gotE0X:
    v_smfmac_f32_16x16x64_bf16 v[48:51], v[16:19], a[0:7], v11
    v_smfmac_f32_16x16x64_bf16 v[60:63], v[16:19], a[136:143], v11
    s_waitcnt vmcnt(0)
    v_max_u32 v124, v32, v34
    v_cmp_eq_u32 vcc, -1, v124
    ds_write_b128 v1, v[32:35] offset:26880
    v_smfmac_f32_16x16x64_bf16 v[52:55], v[16:19], a[8:15], v11
    s_cbranch_vccnz L_retryA0X
L_lateA0X:
    s_waitcnt lgkmcnt(1)
    s_barrier
    v_smfmac_f32_16x16x64_bf16 v[56:59], v[32:35], a[192:199], v11
    ds_read_b128 v[20:23], v1 offset:23808
    v_smfmac_f32_16x16x64_bf16 v[48:51], v[32:35], a[64:71], v11
    ds_read_b128 v[24:27], v1 offset:24832
    v_smfmac_f32_16x16x64_bf16 v[60:63], v[32:35], a[200:207], v11
    ds_read_b128 v[28:31], v1 offset:25856
    v_smfmac_f32_16x16x64_bf16 v[52:55], v[32:35], a[72:79], v11
    v_smfmac_f32_16x16x64_bf16 v[64:67], v[16:19], v[128:135], v11
    v_smfmac_f32_16x16x64_bf16 v[68:71], v[16:19], v[136:143], v11
    s_waitcnt lgkmcnt(2)
    s_barrier
    v_smfmac_f32_16x16x64_bf16 v[56:59], v[20:23], a[144:151], v11
    ds_read_b128 v[36:39], v1 offset:27904
    v_smfmac_f32_16x16x64_bf16 v[48:51], v[20:23], a[16:23], v11
    ds_read_b128 v[40:43], v1 offset:28928
    v_smfmac_f32_16x16x64_bf16 v[60:63], v[20:23], a[152:159], v11
    ds_read_b128 v[44:47], v1 offset:29952
    v_smfmac_f32_16x16x64_bf16 v[52:55], v[20:23], a[24:31], v11
    s_waitcnt lgkmcnt(4)
    v_smfmac_f32_16x16x64_bf16 v[56:59], v[24:27], a[160:167], v11
    v_smfmac_f32_16x16x64_bf16 v[48:51], v[24:27], a[32:39], v11
    v_smfmac_f32_16x16x64_bf16 v[60:63], v[24:27], a[168:175], v11
    v_smfmac_f32_16x16x64_bf16 v[52:55], v[24:27], a[40:47], v11
    s_waitcnt lgkmcnt(3)
    v_smfmac_f32_16x16x64_bf16 v[56:59], v[28:31], a[176:183], v11
    v_smfmac_f32_16x16x64_bf16 v[48:51], v[28:31], a[48:55], v11
    v_smfmac_f32_16x16x64_bf16 v[60:63], v[28:31], a[184:191], v11
    v_smfmac_f32_16x16x64_bf16 v[52:55], v[28:31], a[56:63], v11
    s_waitcnt lgkmcnt(2)
    v_smfmac_f32_16x16x64_bf16 v[56:59], v[36:39], a[208:215], v11
    v_smfmac_f32_16x16x64_bf16 v[48:51], v[36:39], a[80:87], v11
    v_smfmac_f32_16x16x64_bf16 v[60:63], v[36:39], a[216:223], v11
    v_smfmac_f32_16x16x64_bf16 v[52:55], v[36:39], a[88:95], v11
    s_waitcnt lgkmcnt(0)
    v_smfmac_f32_16x16x64_bf16 v[56:59], v[40:43], a[224:231], v11
    v_smfmac_f32_16x16x64_bf16 v[48:51], v[40:43], a[96:103], v11
    v_smfmac_f32_16x16x64_bf16 v[56:59], v[44:47], a[240:247], v11
    v_smfmac_f32_16x16x64_bf16 v[48:51], v[44:47], a[112:119], v11
    v_smfmac_f32_16x16x64_bf16 v[60:63], v[40:43], a[232:239], v11
    v_smfmac_f32_16x16x64_bf16 v[60:63], v[44:47], a[248:255], v11
    v_add_f32 v56, v56, v57
    v_smfmac_f32_16x16x64_bf16 v[52:55], v[40:43], a[104:111], v11
    v_add_f32_e64 v58, v58, v59
    v_smfmac_f32_16x16x64_bf16 v[52:55], v[44:47], a[120:127], v11
    v_add_f32 v48, v48, v49
    v_add_f32 v50, v50, v51
    v_cvt_pk_bf16_f32 v56, v56, v58
    v_cvt_pk_bf16_f32 v57, v48, v50
    ds_write_b64 v6, v[56:57] offset:16384
L_qkdone0X:
    v_add_f32 v60, v60, v61
    v_add_f32 v62, v62, v63
    v_cvt_pk_bf16_f32 v60, v60, v62
    v_add_f32 v52, v52, v53
    v_add_f32 v54, v54, v55
    v_cvt_pk_bf16_f32 v61, v52, v54
    ds_write_b64 v6, v[60:61] offset:16512
    v_mov_b64_e64 v[112:113], -1
    buffer_store_dwordx2 v[112:113], v10, s[4:7], s50 offen sc1
    v_smfmac_f32_16x16x64_bf16 v[64:67], v[20:23], v[144:151], v11
    v_smfmac_f32_16x16x64_bf16 v[68:71], v[20:23], v[152:159], v11
    v_smfmac_f32_16x16x64_bf16 v[64:67], v[24:27], v[160:167], v11
    v_smfmac_f32_16x16x64_bf16 v[68:71], v[24:27], v[168:175], v11
    s_waitcnt lgkmcnt(0)
    s_barrier
    ds_read_b64_tr_b16 v[48:49], v5 offset:16384
    ds_read_b64_tr_b16 v[50:51], v5 offset:16416
    ds_read_b64_tr_b16 v[52:53], v5 offset:16640
    ds_read_b64_tr_b16 v[54:55], v5 offset:16672
    ds_read_b64_tr_b16 v[56:57], v5 offset:16896
    ds_read_b64_tr_b16 v[58:59], v5 offset:16928
    ds_read_b64_tr_b16 v[60:61], v5 offset:17152
    ds_read_b64_tr_b16 v[62:63], v5 offset:17184
    v_smfmac_f32_16x16x64_bf16 v[64:67], v[28:31], v[176:183], v11
    v_smfmac_f32_16x16x64_bf16 v[68:71], v[28:31], v[184:191], v11
    ds_read_b128 v[16:19], v2 offset:0
    ds_read_b128 v[20:23], v2 offset:1024
    s_waitcnt lgkmcnt(8)
    v_mfma_f32_16x16x32_bf16 v[116:119], v[80:83], v[48:51], 0
    ds_read_b128 v[24:27], v2 offset:2048
    v_mfma_f32_16x16x32_bf16 v[120:123], v[84:87], v[48:51], 0
    ds_read_b128 v[28:31], v2 offset:3072
    v_mfma_f32_16x16x32_bf16 v[124:127], v[48:51], v[48:51], 0
    ds_read_b128 v[80:83], v2 offset:4096
    s_waitcnt lgkmcnt(9)
    v_mfma_f32_16x16x32_bf16 v[116:119], v[88:91], v[52:55], v[116:119]
    ds_read_b128 v[84:87], v2 offset:5120
    v_mfma_f32_16x16x32_bf16 v[120:123], v[92:95], v[52:55], v[120:123]
    ds_read_b128 v[88:91], v2 offset:6144
    v_mfma_f32_16x16x32_bf16 v[124:127], v[52:55], v[52:55], v[124:127]
    ds_read_b128 v[92:95], v2 offset:7168
    s_waitcnt lgkmcnt(10)
    v_mfma_f32_16x16x32_bf16 v[116:119], v[96:99], v[56:59], v[116:119]
    ds_read_b128 v[48:51], v2 offset:12288
    v_mfma_f32_16x16x32_bf16 v[120:123], v[100:103], v[56:59], v[120:123]
    ds_read_b128 v[52:55], v2 offset:13312
    v_mfma_f32_16x16x32_bf16 v[124:127], v[56:59], v[56:59], v[124:127]
    ds_read_b128 v[96:99], v2 offset:8192
    s_waitcnt lgkmcnt(11)
    v_mfma_f32_16x16x32_bf16 v[116:119], v[104:107], v[60:63], v[116:119]
    ds_read_b128 v[100:103], v2 offset:9216
    v_mfma_f32_16x16x32_bf16 v[120:123], v[108:111], v[60:63], v[120:123]
    ds_read_b128 v[104:107], v2 offset:10240
    v_mfma_f32_16x16x32_bf16 v[124:127], v[60:63], v[60:63], v[124:127]
    ds_read_b128 v[108:111], v2 offset:11264
    ds_read_b128 v[56:59], v2 offset:14336
    s_waitcnt lgkmcnt(11)
    v_smfmac_f32_16x16x64_bf16 v[64:67], v[32:35], v[16:23], v11
    ds_read_b128 v[60:63], v2 offset:15360
    v_max3_f32 v112, v116, v117, v118
    v_smfmac_f32_16x16x64_bf16 v[68:71], v[32:35], v[24:31], v11
    v_max3_f32 v113, v119, v120, v121
    s_waitcnt lgkmcnt(8)
    v_smfmac_f32_16x16x64_bf16 v[64:67], v[36:39], v[80:87], v11
    v_max3_f32 v112, v112, v122, v123
    v_max3_f32 v126, v113, v124, v125
    v_smfmac_f32_16x16x64_bf16 v[68:71], v[36:39], v[88:95], v11
    v_max_f32 v127, v112, v126
    v_max_f32_e64 v126, v112, v126
    s_waitcnt lgkmcnt(4)
    v_smfmac_f32_16x16x64_bf16 v[64:67], v[44:47], v[48:55], v11
    s_nop 0
    v_permlane16_swap_b32 v126, v127
    v_smfmac_f32_16x16x64_bf16 v[64:67], v[40:43], v[96:103], v11
    v_max_f32 v112, v126, v127
    v_max_f32_e64 v113, v126, v127
    s_waitcnt lgkmcnt(0)
    v_smfmac_f32_16x16x64_bf16 v[68:71], v[40:43], v[104:111], v11
    s_nop 0
    v_permlane32_swap_b32 v112, v113
    v_smfmac_f32_16x16x64_bf16 v[68:71], v[44:47], v[56:63], v11
    v_max_f32 v126, v112, v113
    v_mul_f32 v126, s55, v126
    v_mov_b64 v[16:17], s[78:79]
    v_mov_b64 v[18:19], s[78:79]
    v_pk_fma_f32 v[116:117], v[116:117], s[32:33], v[126:127] op_sel_hi:[1,1,0] neg_lo:[0,0,1] neg_hi:[0,0,1]
    v_pk_fma_f32 v[118:119], v[118:119], s[32:33], v[126:127] op_sel_hi:[1,1,0] neg_lo:[0,0,1] neg_hi:[0,0,1]
    v_pk_fma_f32 v[120:121], v[120:121], s[32:33], v[126:127] op_sel_hi:[1,1,0] neg_lo:[0,0,1] neg_hi:[0,0,1]
    v_pk_fma_f32 v[122:123], v[122:123], s[32:33], v[126:127] op_sel_hi:[1,1,0] neg_lo:[0,0,1] neg_hi:[0,0,1]
    v_pk_fma_f32 v[124:125], v[124:125], s[32:33], v[126:127] op_sel_hi:[1,1,0] neg_lo:[0,0,1] neg_hi:[0,0,1]
    v_exp_f32 v116, v116
    v_exp_f32 v117, v117
    v_exp_f32_e64 v118, v118
    v_cvt_pk_bf16_f32 v112, v116, v117
    v_exp_f32 v119, v119
    v_exp_f32 v120, v120
    v_cvt_pk_bf16_f32 v113, v118, v119
    v_exp_f32 v121, v121
    v_exp_f32 v122, v122
    v_cvt_pk_bf16_f32 v114, v120, v121
    v_exp_f32 v123, v123
    v_exp_f32 v124, v124
    v_cvt_pk_bf16_f32 v115, v122, v123
    v_exp_f32 v125, v125
    v_add_f32 v64, v64, v65
    v_mfma_f32_16x16x32_bf16 v[20:23], v[16:19], v[112:115], 0
    v_cvt_pk_bf16_f32 v124, v124, v125
    v_mov_b32_e64 v125, 0
    v_mfma_f32_16x16x32_bf16 v[24:27], v[72:75], v[112:115], 0
    v_add_f32 v66, v66, v67
    v_add_f32 v68, v68, v69
    v_mfma_f32_16x16x32_bf16 v[28:31], v[76:79], v[112:115], 0
    v_cvt_pk_bf16_f32 v64, v64, v66
    v_mov_b32_e64 v65, 0
    v_mfma_f32_16x16x16_bf16 v[20:23], v[16:17], v[124:125], v[20:23]
    v_add_f32 v70, v70, v71
    v_mov_b32 v69, 0
    v_cvt_pk_bf16_f32 v68, v68, v70
    v_mfma_f32_16x16x16_bf16 v[24:27], v[64:65], v[124:125], v[24:27]
    ds_read_b128 v[80:83], v2 offset:16384
    v_mfma_f32_16x16x16_bf16 v[28:31], v[68:69], v[124:125], v[28:31]
    v_rcp_f32_e64 v20, v20
    ds_read_b128 v[84:87], v2 offset:17408
    ds_read_b128 v[88:91], v2 offset:24576
    ds_read_b128 v[92:95], v2 offset:25600
    v_pk_mul_f32 v[24:25], v[24:25], v[20:21] op_sel_hi:[1,0]
    v_pk_mul_f32 v[26:27], v[26:27], v[20:21] op_sel_hi:[1,0]
    v_cvt_pk_bf16_f32 v16, v24, v25
    v_cvt_pk_bf16_f32 v17, v26, v27
    v_pk_mul_f32 v[28:29], v[28:29], v[20:21] op_sel_hi:[1,0]
    v_pk_mul_f32 v[30:31], v[30:31], v[20:21] op_sel_hi:[1,0]
    v_cvt_pk_bf16_f32 v18, v28, v29
    v_cvt_pk_bf16_f32 v19, v30, v31
    s_mov_b64 exec, s[56:57]
    ds_write_b128 v7, v[16:19] offset:20736
    s_mov_b64 exec, -1
    v_mov_b64 v[112:113], 0
    v_mov_b64 v[114:115], 0
    v_mov_b64 v[116:117], 0
    v_mov_b64 v[118:119], 0
    v_mov_b64 v[120:121], 0
    v_mov_b64 v[122:123], 0
    v_mov_b64 v[124:125], 0
    v_mov_b64 v[126:127], 0
    ds_read_b128 v[48:51], v2 offset:18432
    ds_read_b128 v[52:55], v2 offset:19456
    s_waitcnt lgkmcnt(2)
    s_barrier
    ds_read_b128 v[72:75], v1 offset:20736
    ds_read_b128 v[76:79], v1 offset:21760
    buffer_load_dword v65, v0, s[4:7], s59 offen sc1
    v_mov_b64 v[16:17], 0
    v_mov_b64 v[18:19], 0
    v_mov_b64 v[20:21], 0
    v_mov_b64 v[22:23], 0
    buffer_load_dword v66, v0, s[4:7], s59 offen sc1
    v_mov_b64 v[24:25], 0
    v_mov_b64 v[26:27], 0
    v_mov_b64 v[28:29], 0
    v_mov_b64 v[30:31], 0
    buffer_load_dword v67, v0, s[4:7], s59 offen sc1
    ds_read_b128 v[96:99], v2 offset:26624
    ds_read_b128 v[100:103], v2 offset:27648
    ds_read_b128 v[104:107], v2 offset:20480
    s_waitcnt lgkmcnt(4)
    v_smfmac_f32_16x16x64_bf16 v[112:115], v[72:75], v[192:199], v11
    ds_read_b128 v[108:111], v2 offset:21504
    buffer_load_dword v69, v0, s[4:7], s59 offen sc1
    s_waitcnt lgkmcnt(4)
    v_smfmac_f32_16x16x64_bf16 v[112:115], v[76:79], v[200:207], v11
    ds_read_b128 v[56:59], v2 offset:28672
    v_smfmac_f32_16x16x64_bf16 v[116:119], v[72:75], v[208:215], v11
    ds_read_b128 v[60:63], v2 offset:29696
    v_smfmac_f32_16x16x64_bf16 v[116:119], v[76:79], v[216:223], v11
    v_add_f32 v112, v112, v113
    v_add_f32 v114, v114, v115
    buffer_load_dword v70, v0, s[4:7], s59 offen sc1
    v_smfmac_f32_16x16x64_bf16 v[120:123], v[72:75], v[224:231], v11
    ds_read_b128 v[32:35], v2 offset:22528
    v_smfmac_f32_16x16x64_bf16 v[120:123], v[76:79], v[232:239], v11
    v_add_f32 v116, v116, v117
    v_add_f32 v118, v118, v119
    v_smfmac_f32_16x16x64_bf16 v[124:127], v[72:75], v[240:247], v11
    v_cvt_pk_bf16_f32 v112, v112, v116
    v_cvt_pk_bf16_f32 v114, v114, v118
    v_smfmac_f32_16x16x64_bf16 v[124:127], v[76:79], v[248:255], v11
    v_bfi_b32 v112, 1, s47, v112
    v_add_f32 v120, v120, v121
    v_add_f32 v122, v122, v123
    v_smfmac_f32_16x16x64_bf16 v[16:19], v[72:75], v[80:87], v11
    ds_read_b128 v[36:39], v2 offset:23552
    v_smfmac_f32_16x16x64_bf16 v[16:19], v[76:79], v[88:95], v11
    v_add_f32 v124, v124, v125
    v_add_f32 v126, v126, v127
    v_cvt_pk_bf16_f32 v113, v120, v124
    v_cvt_pk_bf16_f32 v115, v122, v126
    buffer_store_dwordx4 v[112:115], v8, s[4:7], s45 offen sc1
    ds_read_b128 v[40:43], v2 offset:30720
    v_smfmac_f32_16x16x64_bf16 v[20:23], v[72:75], v[48:55], v11
    ds_read_b128 v[44:47], v2 offset:31744
    s_waitcnt lgkmcnt(8)
    v_smfmac_f32_16x16x64_bf16 v[20:23], v[76:79], v[96:103], v11
    v_add_f32 v16, v16, v17
    v_add_f32 v18, v18, v19
    s_waitcnt lgkmcnt(6)
    v_smfmac_f32_16x16x64_bf16 v[24:27], v[72:75], v[104:111], v11
    s_waitcnt lgkmcnt(4)
    v_smfmac_f32_16x16x64_bf16 v[24:27], v[76:79], v[56:63], v11
    v_add_f32 v20, v20, v21
    v_add_f32 v22, v22, v23
    s_waitcnt lgkmcnt(2)
    v_smfmac_f32_16x16x64_bf16 v[28:31], v[72:75], v[32:39], v11
    v_cvt_pk_bf16_f32 v16, v16, v20
    v_cvt_pk_bf16_f32 v18, v18, v22
    s_waitcnt lgkmcnt(0)
    v_smfmac_f32_16x16x64_bf16 v[28:31], v[76:79], v[40:47], v11
    v_bfi_b32 v16, 1, s47, v16
    v_add_f32 v24, v24, v25
    v_add_f32 v26, v26, v27
    s_nop 4
    v_add_f32 v28, v28, v29
    v_add_f32 v30, v30, v31
    v_cvt_pk_bf16_f32 v17, v24, v28
    v_cvt_pk_bf16_f32 v19, v26, v30
    buffer_store_dwordx4 v[16:19], v8, s[4:7], s46 offen sc1
    ds_write_b32 v6, v64 offset:16388
    ds_write_b32 v6, v68 offset:16516
    buffer_load_dword v71, v0, s[4:7], s59 offen sc1
    s_mov_b32 s2, s44
    s_waitcnt vmcnt(7)
    v_cmp_gt_i32 vcc, s2, v65
    s_cbranch_vccnz L_hint0X
L_hintokX:
    s_waitcnt lgkmcnt(0)
    s_barrier
    buffer_load_dwordx4 v[32:35], v9, s[4:7], s28 offen sc1
    buffer_load_dwordx4 v[36:39], v9, s[4:7], s29 offen sc1
    buffer_load_dwordx4 v[40:43], v9, s[4:7], s30 offen sc1
    buffer_load_dwordx4 v[44:47], v9, s[4:7], s31 offen sc1
    ds_read_b128 v[92:95], v3 offset:2304
    ds_read_b128 v[96:99], v3 offset:4096
    ds_read_b128 v[100:103], v3 offset:4352
    ds_read_b128 v[104:107], v3 offset:6144
    ds_read_b128 v[108:111], v3 offset:6400
    ds_read_b64_tr_b16 v[72:73], v4 offset:8192
    ds_read_b64_tr_b16 v[74:75], v4 offset:8448
    ds_read_b64_tr_b16 v[76:77], v4 offset:9216
    ds_read_b64_tr_b16 v[78:79], v4 offset:9472
    s_add_u32 s44, s44, 1
    s_mov_b32 s51, s48
    s_mov_b32 s48, s49
    s_mov_b32 s49, s50
    s_mov_b32 s50, s51
    s_add_u32 s1, s48, s0
    s_add_u32 s3, s1, 4096
L_sumB0X:
    s_waitcnt vmcnt(3)
    v_mfma_f32_16x16x32_bf16 v[20:23], v[12:15], v[32:35], 0
    s_waitcnt vmcnt(2)
    v_mfma_f32_16x16x32_bf16 v[20:23], v[12:15], v[36:39], v[20:23]
    v_bitop3_b32 v28, v32, v36, s47 bitop3:0x81
    s_waitcnt vmcnt(1)
    v_mfma_f32_16x16x32_bf16 v[20:23], v[12:15], v[40:43], v[20:23]
    s_waitcnt vmcnt(0)
    v_mfma_f32_16x16x32_bf16 v[20:23], v[12:15], v[44:47], v[20:23]
    v_bitop3_b32 v29, v40, v44, s47 bitop3:0x81
    v_bitop3_b32 v28, v28, v29, 1 bitop3:0x80
    v_cmp_eq_u32 vcc, 0, v28
    s_nop 4
    v_add_f32_dpp v20, v20, v20 row_ror:8 row_mask:0xf bank_mask:0xf
    v_add_f32_dpp v21, v21, v21 row_ror:8 row_mask:0xf bank_mask:0xf
    v_add_f32_dpp v22, v22, v22 row_ror:8 row_mask:0xf bank_mask:0xf
    v_add_f32_dpp v23, v23, v23 row_ror:8 row_mask:0xf bank_mask:0xf
    v_cvt_pk_bf16_f32 v24, v20, v21
    v_cvt_pk_bf16_f32 v25, v22, v23
    s_cbranch_vccnz L_retryB0X
    buffer_store_dwordx2 v[24:25], v10, s[4:7], s48 offen sc1
    s_xor_b32 s47, s47, 1
    s_waitcnt lgkmcnt(0)
    s_cmp_lt_u32 s44, 63
    s_barrier
    s_cbranch_scc1 L_top0X
    s_branch L_final0X
L_hint0X:
    buffer_load_dword v65, v0, s[4:7], s59 offen sc1
    s_waitcnt vmcnt(7)
    v_cmp_gt_i32 vcc, s2, v66
    s_cbranch_vccz L_hintokX
    buffer_load_dword v66, v0, s[4:7], s59 offen sc1
    s_waitcnt vmcnt(7)
    v_cmp_gt_i32 vcc, s2, v67
    s_cbranch_vccz L_hintokX
    buffer_load_dword v67, v0, s[4:7], s59 offen sc1
    s_waitcnt vmcnt(7)
    v_cmp_gt_i32 vcc, s2, v69
    s_cbranch_vccz L_hintokX
    buffer_load_dword v69, v0, s[4:7], s59 offen sc1
    s_waitcnt vmcnt(7)
    v_cmp_gt_i32 vcc, s2, v70
    s_cbranch_vccz L_hintokX
    buffer_load_dword v70, v0, s[4:7], s59 offen sc1
    s_waitcnt vmcnt(5)
    v_cmp_gt_i32 vcc, s2, v71
    s_cbranch_vccz L_hintokX
    buffer_load_dword v71, v0, s[4:7], s59 offen sc1
    s_mov_b32 s52, 300
L_hintlX:
    s_waitcnt vmcnt(5)
    v_cmp_gt_i32 vcc, s2, v65
    s_cbranch_vccz L_hintokX
    buffer_load_dword v65, v0, s[4:7], s59 offen sc1
    s_waitcnt vmcnt(5)
    v_cmp_gt_i32 vcc, s2, v66
    s_cbranch_vccz L_hintokX
    buffer_load_dword v66, v0, s[4:7], s59 offen sc1
    s_waitcnt vmcnt(5)
    v_cmp_gt_i32 vcc, s2, v67
    s_cbranch_vccz L_hintokX
    buffer_load_dword v67, v0, s[4:7], s59 offen sc1
    s_waitcnt vmcnt(5)
    v_cmp_gt_i32 vcc, s2, v69
    s_cbranch_vccz L_hintokX
    buffer_load_dword v69, v0, s[4:7], s59 offen sc1
    s_waitcnt vmcnt(5)
    v_cmp_gt_i32 vcc, s2, v70
    s_cbranch_vccz L_hintokX
    buffer_load_dword v70, v0, s[4:7], s59 offen sc1
    s_waitcnt vmcnt(5)
    v_cmp_gt_i32 vcc, s2, v71
    s_cbranch_vccz L_hintokX
    buffer_load_dword v71, v0, s[4:7], s59 offen sc1
    s_sub_u32 s52, s52, 1
    s_cbranch_scc0 L_hintlX
    s_branch L_hintokX
L_againA0X:
    s_waitcnt vmcnt(0) lgkmcnt(0)
    s_nop 7
    v_mov_b64 v[56:57], 0
    v_mov_b64_e64 v[58:59], 0
    s_sub_u32 s96, s96, 1
    s_cbranch_scc0 L_pollA0X
    s_branch L_abort
L_retryA0X:
L_retry20X:
    s_waitcnt lgkmcnt(0)
    buffer_load_dwordx4 v[32:35], v1, s[4:7], s3 offen offset:0 sc1
    s_waitcnt vmcnt(0)
    v_max_u32_e64 v124, v32, v34
    v_cmp_eq_u32 vcc, -1, v124
    ds_write_b128 v1, v[32:35] offset:26880
    s_cbranch_vccz L_lateA0X
    s_sub_u32 s96, s96, 1
    s_cbranch_scc0 L_retry20X
    s_branch L_abort
L_againAf0X:
    s_waitcnt vmcnt(0) lgkmcnt(0)
    s_nop 7
    v_mov_b64 v[56:57], 0
    v_mov_b64 v[58:59], 0
    s_sub_u32 s96, s96, 1
    s_cbranch_scc0 L_pollAf0X
    s_branch L_abort
L_retryAf0X:
L_retry2f0X:
    s_waitcnt lgkmcnt(0)
    buffer_load_dwordx4 v[32:35], v1, s[4:7], s3 offen offset:0 sc1
    s_waitcnt vmcnt(0)
    v_max_u32_e64 v124, v32, v34
    v_cmp_eq_u32 vcc, -1, v124
    ds_write_b128 v1, v[32:35] offset:26880
    s_cbranch_vccz L_lateAf0X
    s_sub_u32 s96, s96, 1
    s_cbranch_scc0 L_retry2f0X
    s_branch L_abort
L_retryB0X:
    buffer_load_dwordx4 v[32:35], v9, s[4:7], s28 offen sc1
    buffer_load_dwordx4 v[36:39], v9, s[4:7], s29 offen sc1
    buffer_load_dwordx4 v[40:43], v9, s[4:7], s30 offen sc1
    buffer_load_dwordx4 v[44:47], v9, s[4:7], s31 offen sc1
    s_sub_u32 s96, s96, 1
    s_cbranch_scc0 L_sumB0X
    s_branch L_abort
L_final0X:
    ds_read_b128 v[80:83], v3 offset:0
    ds_read_b128 v[84:87], v3 offset:256
    ds_read_b128 v[88:91], v3 offset:2048
    v_mov_b64 v[60:61], 0
    v_mov_b64 v[62:63], 0
    v_mov_b64 v[64:65], 0
    v_mov_b64 v[66:67], 0
    v_mov_b64 v[68:69], 0
    v_mov_b64_e64 v[70:71], 0
L_pollAf0X:
    buffer_load_dwordx4 v[16:19], v1, s[4:7], s1 offen offset:0 sc1
    v_mov_b64 v[48:49], 0
    v_mov_b64 v[50:51], 0
    v_mov_b64 v[52:53], 0
    v_mov_b64 v[54:55], 0
    v_mov_b64 v[56:57], 0
    v_mov_b64 v[58:59], 0
    buffer_load_dwordx4 v[32:35], v1, s[4:7], s3 offen offset:0 sc1
    s_waitcnt vmcnt(1)
    v_max_u32_e64 v124, v16, v18
    v_cmp_eq_u32 vcc, -1, v124
    ds_write_b128 v1, v[16:19] offset:22784
    v_smfmac_f32_16x16x64_bf16 v[56:59], v[16:19], a[128:135], v11
    s_cbranch_vccnz L_againAf0X
L_gotEf0X:
    v_smfmac_f32_16x16x64_bf16 v[48:51], v[16:19], a[0:7], v11
    v_smfmac_f32_16x16x64_bf16 v[60:63], v[16:19], a[136:143], v11
    s_waitcnt vmcnt(0)
    v_max_u32 v124, v32, v34
    v_cmp_eq_u32 vcc, -1, v124
    ds_write_b128 v1, v[32:35] offset:26880
    v_smfmac_f32_16x16x64_bf16 v[52:55], v[16:19], a[8:15], v11
    s_cbranch_vccnz L_retryAf0X
L_lateAf0X:
    s_waitcnt lgkmcnt(1)
    s_barrier
    ds_read_b128 v[20:23], v1 offset:23808
    ds_read_b128 v[24:27], v1 offset:24832
    ds_read_b128 v[28:31], v1 offset:25856
    v_smfmac_f32_16x16x64_bf16 v[56:59], v[32:35], a[192:199], v11
    v_smfmac_f32_16x16x64_bf16 v[60:63], v[32:35], a[200:207], v11
    v_smfmac_f32_16x16x64_bf16 v[64:67], v[16:19], v[128:135], v11
    v_smfmac_f32_16x16x64_bf16 v[68:71], v[16:19], v[136:143], v11
    s_waitcnt lgkmcnt(2)
    s_barrier
    v_smfmac_f32_16x16x64_bf16 v[56:59], v[20:23], a[144:151], v11
    ds_read_b128 v[36:39], v1 offset:27904
    v_smfmac_f32_16x16x64_bf16 v[60:63], v[20:23], a[152:159], v11
    ds_read_b128 v[40:43], v1 offset:28928
    v_smfmac_f32_16x16x64_bf16 v[64:67], v[20:23], v[144:151], v11
    ds_read_b128 v[44:47], v1 offset:29952
    v_smfmac_f32_16x16x64_bf16 v[68:71], v[20:23], v[152:159], v11
    ds_read_b128 v[80:83], v2 offset:0
    s_waitcnt lgkmcnt(5)
    v_smfmac_f32_16x16x64_bf16 v[56:59], v[24:27], a[160:167], v11
    ds_read_b128 v[84:87], v2 offset:1024
    v_smfmac_f32_16x16x64_bf16 v[60:63], v[24:27], a[168:175], v11
    ds_read_b128 v[88:91], v2 offset:2048
    v_smfmac_f32_16x16x64_bf16 v[64:67], v[24:27], v[160:167], v11
    ds_read_b128 v[92:95], v2 offset:3072
    v_smfmac_f32_16x16x64_bf16 v[68:71], v[24:27], v[168:175], v11
    ds_read_b128 v[96:99], v2 offset:4096
    s_waitcnt lgkmcnt(8)
    v_smfmac_f32_16x16x64_bf16 v[56:59], v[28:31], a[176:183], v11
    ds_read_b128 v[100:103], v2 offset:5120
    v_smfmac_f32_16x16x64_bf16 v[60:63], v[28:31], a[184:191], v11
    ds_read_b128 v[104:107], v2 offset:6144
    v_smfmac_f32_16x16x64_bf16 v[64:67], v[28:31], v[176:183], v11
    ds_read_b128 v[108:111], v2 offset:7168
    v_smfmac_f32_16x16x64_bf16 v[68:71], v[28:31], v[184:191], v11
    v_lshrrev_b32 v120, 8, v1
    v_lshlrev_b32 v120, 10, v120
    v_bfe_u32 v121, v1, 4, 4
    v_lshl_add_u32 v120, v121, 3, v120
    s_lshl_b32 s52, s14, 12
    s_add_u32 s52, s52, 66977792
    s_waitcnt lgkmcnt(6)
    v_smfmac_f32_16x16x64_bf16 v[64:67], v[32:35], v[80:87], v11
    ds_read_b128 v[80:83], v2 offset:8192
    ds_read_b128 v[84:87], v2 offset:9216
    v_smfmac_f32_16x16x64_bf16 v[56:59], v[36:39], a[208:215], v11
    s_waitcnt lgkmcnt(6)
    v_smfmac_f32_16x16x64_bf16 v[68:71], v[32:35], v[88:95], v11
    ds_read_b128 v[88:91], v2 offset:10240
    ds_read_b128 v[92:95], v2 offset:11264
    v_smfmac_f32_16x16x64_bf16 v[60:63], v[36:39], a[216:223], v11
    s_waitcnt lgkmcnt(6)
    v_smfmac_f32_16x16x64_bf16 v[64:67], v[36:39], v[96:103], v11
    ds_read_b128 v[96:99], v2 offset:12288
    ds_read_b128 v[100:103], v2 offset:13312
    v_smfmac_f32_16x16x64_bf16 v[56:59], v[40:43], a[224:231], v11
    s_waitcnt lgkmcnt(6)
    v_smfmac_f32_16x16x64_bf16 v[68:71], v[36:39], v[104:111], v11
    ds_read_b128 v[104:107], v2 offset:14336
    ds_read_b128 v[108:111], v2 offset:15360
    v_smfmac_f32_16x16x64_bf16 v[60:63], v[40:43], a[232:239], v11
    s_waitcnt lgkmcnt(6)
    v_smfmac_f32_16x16x64_bf16 v[64:67], v[40:43], v[80:87], v11
    v_smfmac_f32_16x16x64_bf16 v[56:59], v[44:47], a[240:247], v11
    s_waitcnt lgkmcnt(4)
    v_smfmac_f32_16x16x64_bf16 v[68:71], v[40:43], v[88:95], v11
    v_smfmac_f32_16x16x64_bf16 v[60:63], v[44:47], a[248:255], v11
    s_waitcnt lgkmcnt(2)
    v_smfmac_f32_16x16x64_bf16 v[64:67], v[44:47], v[96:103], v11
    s_waitcnt lgkmcnt(0)
    v_smfmac_f32_16x16x64_bf16 v[68:71], v[44:47], v[104:111], v11
    v_add_f32 v56, v56, v57
    v_add_f32 v58, v58, v59
    v_cvt_pk_bf16_f32 v56, v56, v58
    v_add_f32 v60, v60, v61
    v_add_f32 v62, v62, v63
    v_cvt_pk_bf16_f32 v60, v60, v62
    s_nop 1
    v_add_f32 v64, v64, v65
    v_add_f32_e64 v66, v66, v67
    v_cvt_pk_bf16_f32 v57, v64, v66
    buffer_store_dwordx2 v[56:57], v120, s[4:7], s52 offen offset:0 sc1
    v_add_f32 v68, v68, v69
    v_add_f32 v70, v70, v71
    v_cvt_pk_bf16_f32 v61, v68, v70
    buffer_store_dwordx2 v[60:61], v120, s[4:7], s52 offen offset:128 sc1
    s_waitcnt vmcnt(0)
    s_endpgm
L_cstart1X:
    ds_read_b128 v[80:83], v3 offset:0
    ds_read_b128 v[84:87], v3 offset:256
    ds_read_b128 v[88:91], v3 offset:2048
    ds_read_b128 v[92:95], v3 offset:2304
    ds_read_b128 v[96:99], v3 offset:4096
    ds_read_b128 v[100:103], v3 offset:4352
    ds_read_b128 v[104:107], v3 offset:6144
    ds_read_b128 v[108:111], v3 offset:6400
    ds_read_b64_tr_b16 v[72:73], v4 offset:10240
    ds_read_b64_tr_b16 v[74:75], v4 offset:10496
    ds_read_b64_tr_b16 v[76:77], v4 offset:11264
    ds_read_b64_tr_b16 v[78:79], v4 offset:11520
    v_mov_b64 v[48:49], 0
    v_mov_b64 v[50:51], 0
    v_mov_b64 v[52:53], 0
    v_mov_b64 v[54:55], 0
    v_mov_b64 v[56:57], 0
    v_mov_b64 v[58:59], 0
    v_mov_b64 v[60:61], 0
    v_mov_b64 v[62:63], 0
    v_mov_b64 v[64:65], 0
    v_mov_b64 v[66:67], 0
    v_mov_b64 v[68:69], 0
    v_mov_b64 v[70:71], 0
    s_waitcnt lgkmcnt(0)
    s_barrier
.p2align 6
L_top1X:
    ds_read_b128 v[80:83], v3 offset:0
    ds_read_b128 v[84:87], v3 offset:256
    ds_read_b128 v[88:91], v3 offset:2048
    v_mov_b64 v[60:61], 0
    v_mov_b64 v[62:63], 0
    v_mov_b64 v[64:65], 0
    v_mov_b64 v[66:67], 0
    v_mov_b64 v[68:69], 0
    v_mov_b64 v[70:71], 0
L_pollA1X:
    buffer_load_dwordx4 v[20:23], v1, s[4:7], s1 offen offset:1024 sc1
    v_mov_b64 v[48:49], 0
    v_mov_b64 v[50:51], 0
    v_mov_b64 v[52:53], 0
    v_mov_b64 v[54:55], 0
    v_mov_b64 v[56:57], 0
    v_mov_b64 v[58:59], 0
    buffer_load_dwordx4 v[36:39], v1, s[4:7], s3 offen offset:1024 sc1
    s_waitcnt vmcnt(1)
    v_max_u32_e64 v124, v20, v22
    v_cmp_eq_u32 vcc, -1, v124
    ds_write_b128 v1, v[20:23] offset:23808
    v_smfmac_f32_16x16x64_bf16 v[56:59], v[20:23], a[144:151], v11
    s_cbranch_vccnz L_againA1X
L_gotE1X:
    v_smfmac_f32_16x16x64_bf16 v[48:51], v[20:23], a[16:23], v11
    v_smfmac_f32_16x16x64_bf16 v[60:63], v[20:23], a[152:159], v11
    s_waitcnt vmcnt(0)
    v_max_u32 v124, v36, v38
    v_cmp_eq_u32 vcc, -1, v124
    ds_write_b128 v1, v[36:39] offset:27904
    v_smfmac_f32_16x16x64_bf16 v[52:55], v[20:23], a[24:31], v11
    s_cbranch_vccnz L_retryA1X
L_lateA1X:
    s_waitcnt lgkmcnt(1)
    s_barrier
    v_smfmac_f32_16x16x64_bf16 v[56:59], v[36:39], a[208:215], v11
    ds_read_b128 v[24:27], v1 offset:24832
    v_smfmac_f32_16x16x64_bf16 v[48:51], v[36:39], a[80:87], v11
    ds_read_b128 v[28:31], v1 offset:25856
    v_smfmac_f32_16x16x64_bf16 v[60:63], v[36:39], a[216:223], v11
    ds_read_b128 v[16:19], v1 offset:22784
    v_smfmac_f32_16x16x64_bf16 v[52:55], v[36:39], a[88:95], v11
    v_smfmac_f32_16x16x64_bf16 v[64:67], v[20:23], v[144:151], v11
    v_smfmac_f32_16x16x64_bf16 v[68:71], v[20:23], v[152:159], v11
    s_waitcnt lgkmcnt(2)
    s_barrier
    v_smfmac_f32_16x16x64_bf16 v[56:59], v[24:27], a[160:167], v11
    ds_read_b128 v[40:43], v1 offset:28928
    v_smfmac_f32_16x16x64_bf16 v[48:51], v[24:27], a[32:39], v11
    ds_read_b128 v[44:47], v1 offset:29952
    v_smfmac_f32_16x16x64_bf16 v[60:63], v[24:27], a[168:175], v11
    ds_read_b128 v[32:35], v1 offset:26880
    v_smfmac_f32_16x16x64_bf16 v[52:55], v[24:27], a[40:47], v11
    s_waitcnt lgkmcnt(4)
    v_smfmac_f32_16x16x64_bf16 v[56:59], v[28:31], a[176:183], v11
    v_smfmac_f32_16x16x64_bf16 v[48:51], v[28:31], a[48:55], v11
    v_smfmac_f32_16x16x64_bf16 v[60:63], v[28:31], a[184:191], v11
    v_smfmac_f32_16x16x64_bf16 v[52:55], v[28:31], a[56:63], v11
    s_waitcnt lgkmcnt(3)
    v_smfmac_f32_16x16x64_bf16 v[56:59], v[16:19], a[128:135], v11
    v_smfmac_f32_16x16x64_bf16 v[48:51], v[16:19], a[0:7], v11
    v_smfmac_f32_16x16x64_bf16 v[60:63], v[16:19], a[136:143], v11
    v_smfmac_f32_16x16x64_bf16 v[52:55], v[16:19], a[8:15], v11
    s_waitcnt lgkmcnt(2)
    v_smfmac_f32_16x16x64_bf16 v[56:59], v[40:43], a[224:231], v11
    v_smfmac_f32_16x16x64_bf16 v[48:51], v[40:43], a[96:103], v11
    v_smfmac_f32_16x16x64_bf16 v[60:63], v[40:43], a[232:239], v11
    v_smfmac_f32_16x16x64_bf16 v[52:55], v[40:43], a[104:111], v11
    s_waitcnt lgkmcnt(0)
    v_smfmac_f32_16x16x64_bf16 v[56:59], v[44:47], a[240:247], v11
    v_smfmac_f32_16x16x64_bf16 v[48:51], v[44:47], a[112:119], v11
    v_smfmac_f32_16x16x64_bf16 v[56:59], v[32:35], a[192:199], v11
    v_smfmac_f32_16x16x64_bf16 v[48:51], v[32:35], a[64:71], v11
    v_smfmac_f32_16x16x64_bf16 v[60:63], v[44:47], a[248:255], v11
    v_smfmac_f32_16x16x64_bf16 v[60:63], v[32:35], a[200:207], v11
    v_add_f32 v56, v56, v57
    v_smfmac_f32_16x16x64_bf16 v[52:55], v[44:47], a[120:127], v11
    v_add_f32_e64 v58, v58, v59
    v_smfmac_f32_16x16x64_bf16 v[52:55], v[32:35], a[72:79], v11
    v_add_f32 v48, v48, v49
    v_add_f32 v50, v50, v51
    v_cvt_pk_bf16_f32 v56, v56, v58
    v_cvt_pk_bf16_f32 v57, v48, v50
    ds_write_b64 v6, v[56:57] offset:16640
L_qkdone1X:
    v_add_f32 v60, v60, v61
    v_add_f32 v62, v62, v63
    v_cvt_pk_bf16_f32 v60, v60, v62
    v_add_f32 v52, v52, v53
    v_add_f32 v54, v54, v55
    v_cvt_pk_bf16_f32 v61, v52, v54
    ds_write_b64 v6, v[60:61] offset:16768
    v_mov_b64_e64 v[112:113], -1
    buffer_store_dwordx2 v[112:113], v10, s[4:7], s50 offen sc1
    v_smfmac_f32_16x16x64_bf16 v[64:67], v[24:27], v[160:167], v11
    v_smfmac_f32_16x16x64_bf16 v[68:71], v[24:27], v[168:175], v11
    v_smfmac_f32_16x16x64_bf16 v[64:67], v[28:31], v[176:183], v11
    v_smfmac_f32_16x16x64_bf16 v[68:71], v[28:31], v[184:191], v11
    s_waitcnt lgkmcnt(0)
    s_barrier
    ds_read_b64_tr_b16 v[48:49], v5 offset:16384
    ds_read_b64_tr_b16 v[50:51], v5 offset:16416
    ds_read_b64_tr_b16 v[52:53], v5 offset:16640
    ds_read_b64_tr_b16 v[54:55], v5 offset:16672
    ds_read_b64_tr_b16 v[56:57], v5 offset:16896
    ds_read_b64_tr_b16 v[58:59], v5 offset:16928
    ds_read_b64_tr_b16 v[60:61], v5 offset:17152
    ds_read_b64_tr_b16 v[62:63], v5 offset:17184
    v_smfmac_f32_16x16x64_bf16 v[64:67], v[16:19], v[128:135], v11
    v_smfmac_f32_16x16x64_bf16 v[68:71], v[16:19], v[136:143], v11
    ds_read_b128 v[16:19], v2 offset:0
    ds_read_b128 v[20:23], v2 offset:1024
    s_waitcnt lgkmcnt(8)
    v_mfma_f32_16x16x32_bf16 v[116:119], v[80:83], v[48:51], 0
    ds_read_b128 v[24:27], v2 offset:2048
    v_mfma_f32_16x16x32_bf16 v[120:123], v[84:87], v[48:51], 0
    ds_read_b128 v[28:31], v2 offset:3072
    v_mfma_f32_16x16x32_bf16 v[124:127], v[48:51], v[48:51], 0
    ds_read_b128 v[80:83], v2 offset:4096
    s_waitcnt lgkmcnt(9)
    v_mfma_f32_16x16x32_bf16 v[116:119], v[88:91], v[52:55], v[116:119]
    ds_read_b128 v[84:87], v2 offset:5120
    v_mfma_f32_16x16x32_bf16 v[120:123], v[92:95], v[52:55], v[120:123]
    ds_read_b128 v[88:91], v2 offset:6144
    v_mfma_f32_16x16x32_bf16 v[124:127], v[52:55], v[52:55], v[124:127]
    ds_read_b128 v[92:95], v2 offset:7168
    s_waitcnt lgkmcnt(10)
    v_mfma_f32_16x16x32_bf16 v[116:119], v[96:99], v[56:59], v[116:119]
    ds_read_b128 v[48:51], v2 offset:12288
    v_mfma_f32_16x16x32_bf16 v[120:123], v[100:103], v[56:59], v[120:123]
    ds_read_b128 v[52:55], v2 offset:13312
    v_mfma_f32_16x16x32_bf16 v[124:127], v[56:59], v[56:59], v[124:127]
    ds_read_b128 v[96:99], v2 offset:8192
    s_waitcnt lgkmcnt(11)
    v_mfma_f32_16x16x32_bf16 v[116:119], v[104:107], v[60:63], v[116:119]
    ds_read_b128 v[100:103], v2 offset:9216
    v_mfma_f32_16x16x32_bf16 v[120:123], v[108:111], v[60:63], v[120:123]
    ds_read_b128 v[104:107], v2 offset:10240
    v_mfma_f32_16x16x32_bf16 v[124:127], v[60:63], v[60:63], v[124:127]
    ds_read_b128 v[108:111], v2 offset:11264
    ds_read_b128 v[56:59], v2 offset:14336
    s_waitcnt lgkmcnt(11)
    v_smfmac_f32_16x16x64_bf16 v[64:67], v[32:35], v[16:23], v11
    ds_read_b128 v[60:63], v2 offset:15360
    v_max3_f32 v112, v116, v117, v118
    v_smfmac_f32_16x16x64_bf16 v[68:71], v[32:35], v[24:31], v11
    v_max3_f32 v113, v119, v120, v121
    s_waitcnt lgkmcnt(8)
    v_smfmac_f32_16x16x64_bf16 v[64:67], v[36:39], v[80:87], v11
    v_max3_f32 v112, v112, v122, v123
    v_max3_f32 v126, v113, v124, v125
    v_smfmac_f32_16x16x64_bf16 v[68:71], v[36:39], v[88:95], v11
    v_max_f32 v127, v112, v126
    v_max_f32_e64 v126, v112, v126
    s_waitcnt lgkmcnt(4)
    v_smfmac_f32_16x16x64_bf16 v[64:67], v[44:47], v[48:55], v11
    s_nop 0
    v_permlane16_swap_b32 v126, v127
    v_smfmac_f32_16x16x64_bf16 v[64:67], v[40:43], v[96:103], v11
    v_max_f32 v112, v126, v127
    v_max_f32_e64 v113, v126, v127
    s_waitcnt lgkmcnt(0)
    v_smfmac_f32_16x16x64_bf16 v[68:71], v[40:43], v[104:111], v11
    s_nop 0
    v_permlane32_swap_b32 v112, v113
    v_smfmac_f32_16x16x64_bf16 v[68:71], v[44:47], v[56:63], v11
    v_max_f32 v126, v112, v113
    v_mul_f32 v126, s55, v126
    v_mov_b64 v[16:17], s[78:79]
    v_mov_b64 v[18:19], s[78:79]
    v_pk_fma_f32 v[116:117], v[116:117], s[32:33], v[126:127] op_sel_hi:[1,1,0] neg_lo:[0,0,1] neg_hi:[0,0,1]
    v_pk_fma_f32 v[118:119], v[118:119], s[32:33], v[126:127] op_sel_hi:[1,1,0] neg_lo:[0,0,1] neg_hi:[0,0,1]
    v_pk_fma_f32 v[120:121], v[120:121], s[32:33], v[126:127] op_sel_hi:[1,1,0] neg_lo:[0,0,1] neg_hi:[0,0,1]
    v_pk_fma_f32 v[122:123], v[122:123], s[32:33], v[126:127] op_sel_hi:[1,1,0] neg_lo:[0,0,1] neg_hi:[0,0,1]
    v_pk_fma_f32 v[124:125], v[124:125], s[32:33], v[126:127] op_sel_hi:[1,1,0] neg_lo:[0,0,1] neg_hi:[0,0,1]
    v_exp_f32 v116, v116
    v_exp_f32 v117, v117
    v_exp_f32_e64 v118, v118
    v_cvt_pk_bf16_f32 v112, v116, v117
    v_exp_f32 v119, v119
    v_exp_f32 v120, v120
    v_cvt_pk_bf16_f32 v113, v118, v119
    v_exp_f32 v121, v121
    v_exp_f32 v122, v122
    v_cvt_pk_bf16_f32 v114, v120, v121
    v_exp_f32 v123, v123
    v_exp_f32 v124, v124
    v_cvt_pk_bf16_f32 v115, v122, v123
    v_exp_f32 v125, v125
    v_add_f32 v64, v64, v65
    v_mfma_f32_16x16x32_bf16 v[20:23], v[16:19], v[112:115], 0
    v_cvt_pk_bf16_f32 v124, v124, v125
    v_mov_b32_e64 v125, 0
    v_mfma_f32_16x16x32_bf16 v[24:27], v[72:75], v[112:115], 0
    v_add_f32 v66, v66, v67
    v_add_f32 v68, v68, v69
    v_mfma_f32_16x16x32_bf16 v[28:31], v[76:79], v[112:115], 0
    v_cvt_pk_bf16_f32 v64, v64, v66
    v_mov_b32_e64 v65, 0
    v_mfma_f32_16x16x16_bf16 v[20:23], v[16:17], v[124:125], v[20:23]
    v_add_f32 v70, v70, v71
    v_mov_b32 v69, 0
    v_cvt_pk_bf16_f32 v68, v68, v70
    v_mfma_f32_16x16x16_bf16 v[24:27], v[64:65], v[124:125], v[24:27]
    ds_read_b128 v[80:83], v2 offset:16384
    v_mfma_f32_16x16x16_bf16 v[28:31], v[68:69], v[124:125], v[28:31]
    v_rcp_f32_e64 v20, v20
    ds_read_b128 v[84:87], v2 offset:17408
    ds_read_b128 v[88:91], v2 offset:24576
    ds_read_b128 v[92:95], v2 offset:25600
    v_pk_mul_f32 v[24:25], v[24:25], v[20:21] op_sel_hi:[1,0]
    v_pk_mul_f32 v[26:27], v[26:27], v[20:21] op_sel_hi:[1,0]
    v_cvt_pk_bf16_f32 v16, v24, v25
    v_cvt_pk_bf16_f32 v17, v26, v27
    v_pk_mul_f32 v[28:29], v[28:29], v[20:21] op_sel_hi:[1,0]
    v_pk_mul_f32 v[30:31], v[30:31], v[20:21] op_sel_hi:[1,0]
    v_cvt_pk_bf16_f32 v18, v28, v29
    v_cvt_pk_bf16_f32 v19, v30, v31
    s_mov_b64 exec, s[56:57]
    ds_write_b128 v7, v[16:19] offset:21248
    s_mov_b64 exec, -1
    v_mov_b64 v[112:113], 0
    v_mov_b64 v[114:115], 0
    v_mov_b64 v[116:117], 0
    v_mov_b64 v[118:119], 0
    v_mov_b64 v[120:121], 0
    v_mov_b64 v[122:123], 0
    v_mov_b64 v[124:125], 0
    v_mov_b64 v[126:127], 0
    ds_read_b128 v[48:51], v2 offset:18432
    ds_read_b128 v[52:55], v2 offset:19456
    s_waitcnt lgkmcnt(2)
    s_barrier
    ds_read_b128 v[72:75], v1 offset:20736
    ds_read_b128 v[76:79], v1 offset:21760
    v_mov_b64 v[16:17], 0
    v_mov_b64 v[18:19], 0
    v_mov_b64 v[20:21], 0
    v_mov_b64 v[22:23], 0
    v_mov_b64 v[24:25], 0
    v_mov_b64 v[26:27], 0
    v_mov_b64 v[28:29], 0
    v_mov_b64 v[30:31], 0
    ds_read_b128 v[96:99], v2 offset:26624
    ds_read_b128 v[100:103], v2 offset:27648
    ds_read_b128 v[104:107], v2 offset:20480
    s_waitcnt lgkmcnt(4)
    v_smfmac_f32_16x16x64_bf16 v[112:115], v[72:75], v[192:199], v11
    ds_read_b128 v[108:111], v2 offset:21504
    s_waitcnt lgkmcnt(4)
    v_smfmac_f32_16x16x64_bf16 v[112:115], v[76:79], v[200:207], v11
    ds_read_b128 v[56:59], v2 offset:28672
    v_smfmac_f32_16x16x64_bf16 v[116:119], v[72:75], v[208:215], v11
    ds_read_b128 v[60:63], v2 offset:29696
    v_smfmac_f32_16x16x64_bf16 v[116:119], v[76:79], v[216:223], v11
    v_add_f32 v112, v112, v113
    v_add_f32 v114, v114, v115
    v_smfmac_f32_16x16x64_bf16 v[120:123], v[72:75], v[224:231], v11
    ds_read_b128 v[32:35], v2 offset:22528
    v_smfmac_f32_16x16x64_bf16 v[120:123], v[76:79], v[232:239], v11
    v_add_f32 v116, v116, v117
    v_add_f32 v118, v118, v119
    v_smfmac_f32_16x16x64_bf16 v[124:127], v[72:75], v[240:247], v11
    v_cvt_pk_bf16_f32 v112, v112, v116
    v_cvt_pk_bf16_f32 v114, v114, v118
    v_smfmac_f32_16x16x64_bf16 v[124:127], v[76:79], v[248:255], v11
    v_bfi_b32 v112, 1, s47, v112
    v_add_f32 v120, v120, v121
    v_add_f32 v122, v122, v123
    v_smfmac_f32_16x16x64_bf16 v[16:19], v[72:75], v[80:87], v11
    ds_read_b128 v[36:39], v2 offset:23552
    v_smfmac_f32_16x16x64_bf16 v[16:19], v[76:79], v[88:95], v11
    v_add_f32 v124, v124, v125
    v_add_f32 v126, v126, v127
    v_cvt_pk_bf16_f32 v113, v120, v124
    v_cvt_pk_bf16_f32 v115, v122, v126
    buffer_store_dwordx4 v[112:115], v8, s[4:7], s45 offen sc1
    ds_read_b128 v[40:43], v2 offset:30720
    v_smfmac_f32_16x16x64_bf16 v[20:23], v[72:75], v[48:55], v11
    ds_read_b128 v[44:47], v2 offset:31744
    s_waitcnt lgkmcnt(8)
    v_smfmac_f32_16x16x64_bf16 v[20:23], v[76:79], v[96:103], v11
    v_add_f32 v16, v16, v17
    v_add_f32 v18, v18, v19
    s_waitcnt lgkmcnt(6)
    v_smfmac_f32_16x16x64_bf16 v[24:27], v[72:75], v[104:111], v11
    s_waitcnt lgkmcnt(4)
    v_smfmac_f32_16x16x64_bf16 v[24:27], v[76:79], v[56:63], v11
    v_add_f32 v20, v20, v21
    v_add_f32 v22, v22, v23
    s_waitcnt lgkmcnt(2)
    v_smfmac_f32_16x16x64_bf16 v[28:31], v[72:75], v[32:39], v11
    v_cvt_pk_bf16_f32 v16, v16, v20
    v_cvt_pk_bf16_f32 v18, v18, v22
    s_waitcnt lgkmcnt(0)
    v_smfmac_f32_16x16x64_bf16 v[28:31], v[76:79], v[40:47], v11
    v_bfi_b32 v16, 1, s47, v16
    v_add_f32 v24, v24, v25
    v_add_f32 v26, v26, v27
    s_nop 4
    v_add_f32 v28, v28, v29
    v_add_f32 v30, v30, v31
    v_cvt_pk_bf16_f32 v17, v24, v28
    v_cvt_pk_bf16_f32 v19, v26, v30
    buffer_store_dwordx4 v[16:19], v8, s[4:7], s46 offen sc1
    ds_write_b32 v6, v64 offset:16644
    ds_write_b32 v6, v68 offset:16772
    s_waitcnt lgkmcnt(0)
    s_barrier
    ds_read_b128 v[92:95], v3 offset:2304
    ds_read_b128 v[96:99], v3 offset:4096
    ds_read_b128 v[100:103], v3 offset:4352
    ds_read_b128 v[104:107], v3 offset:6144
    ds_read_b128 v[108:111], v3 offset:6400
    ds_read_b64_tr_b16 v[72:73], v4 offset:10240
    ds_read_b64_tr_b16 v[74:75], v4 offset:10496
    ds_read_b64_tr_b16 v[76:77], v4 offset:11264
    ds_read_b64_tr_b16 v[78:79], v4 offset:11520
    s_mov_b32 s2, s44
    s_add_u32 s44, s44, 1
    s_mov_b32 s51, s48
    s_mov_b32 s48, s49
    s_mov_b32 s49, s50
    s_mov_b32 s50, s51
    s_add_u32 s1, s48, s0
    s_add_u32 s3, s1, 4096
    buffer_load_dwordx4 v[32:35], v9, s[4:7], s28 offen sc1
    buffer_load_dwordx4 v[36:39], v9, s[4:7], s29 offen sc1
    buffer_load_dwordx4 v[40:43], v9, s[4:7], s30 offen sc1
    buffer_load_dwordx4 v[44:47], v9, s[4:7], s31 offen sc1
L_sumB1X:
    s_waitcnt vmcnt(3)
    v_mfma_f32_16x16x32_bf16 v[20:23], v[12:15], v[32:35], 0
    s_waitcnt vmcnt(2)
    v_mfma_f32_16x16x32_bf16 v[20:23], v[12:15], v[36:39], v[20:23]
    v_bitop3_b32 v28, v32, v36, s47 bitop3:0x81
    s_waitcnt vmcnt(1)
    v_mfma_f32_16x16x32_bf16 v[20:23], v[12:15], v[40:43], v[20:23]
    s_waitcnt vmcnt(0)
    v_mfma_f32_16x16x32_bf16 v[20:23], v[12:15], v[44:47], v[20:23]
    v_bitop3_b32 v29, v40, v44, s47 bitop3:0x81
    v_bitop3_b32 v28, v28, v29, 1 bitop3:0x80
    v_cmp_eq_u32 vcc, 0, v28
    s_nop 4
    v_add_f32_dpp v20, v20, v20 row_ror:8 row_mask:0xf bank_mask:0xf
    v_add_f32_dpp v21, v21, v21 row_ror:8 row_mask:0xf bank_mask:0xf
    v_add_f32_dpp v22, v22, v22 row_ror:8 row_mask:0xf bank_mask:0xf
    v_add_f32_dpp v23, v23, v23 row_ror:8 row_mask:0xf bank_mask:0xf
    v_cvt_pk_bf16_f32 v24, v20, v21
    v_cvt_pk_bf16_f32 v25, v22, v23
    s_cbranch_vccnz L_retryB1X
    buffer_store_dwordx2 v[24:25], v10, s[4:7], s48 offen sc1
    s_xor_b32 s47, s47, 1
    s_waitcnt lgkmcnt(0)
    s_cmp_lt_u32 s44, 63
    s_barrier
    s_cbranch_scc1 L_top1X
    s_branch L_final1X
L_againA1X:
    s_waitcnt vmcnt(0) lgkmcnt(0)
    s_nop 7
    v_mov_b64 v[56:57], 0
    v_mov_b64 v[58:59], 0
    s_sub_u32 s96, s96, 1
    s_cbranch_scc0 L_pollA1X
    s_branch L_abort
L_retryA1X:
L_retry21X:
    s_waitcnt lgkmcnt(0)
    buffer_load_dwordx4 v[36:39], v1, s[4:7], s3 offen offset:1024 sc1
    s_waitcnt vmcnt(0)
    v_max_u32_e64 v124, v36, v38
    v_cmp_eq_u32 vcc, -1, v124
    ds_write_b128 v1, v[36:39] offset:27904
    s_cbranch_vccz L_lateA1X
    s_sub_u32 s96, s96, 1
    s_cbranch_scc0 L_retry21X
    s_branch L_abort
L_againAf1X:
    s_waitcnt vmcnt(0) lgkmcnt(0)
    s_nop 7
    v_mov_b64 v[56:57], 0
    v_mov_b64 v[58:59], 0
    s_sub_u32 s96, s96, 1
    s_cbranch_scc0 L_pollAf1X
    s_branch L_abort
L_retryAf1X:
L_retry2f1X:
    s_waitcnt lgkmcnt(0)
    buffer_load_dwordx4 v[36:39], v1, s[4:7], s3 offen offset:1024 sc1
    s_waitcnt vmcnt(0)
    v_max_u32_e64 v124, v36, v38
    v_cmp_eq_u32 vcc, -1, v124
    ds_write_b128 v1, v[36:39] offset:27904
    s_cbranch_vccz L_lateAf1X
    s_sub_u32 s96, s96, 1
    s_cbranch_scc0 L_retry2f1X
    s_branch L_abort
L_retryB1X:
    buffer_load_dwordx4 v[32:35], v9, s[4:7], s28 offen sc1
    buffer_load_dwordx4 v[36:39], v9, s[4:7], s29 offen sc1
    buffer_load_dwordx4 v[40:43], v9, s[4:7], s30 offen sc1
    buffer_load_dwordx4 v[44:47], v9, s[4:7], s31 offen sc1
    s_sub_u32 s96, s96, 1
    s_cbranch_scc0 L_sumB1X
    s_branch L_abort
L_final1X:
    ds_read_b128 v[80:83], v3 offset:0
    ds_read_b128 v[84:87], v3 offset:256
    ds_read_b128 v[88:91], v3 offset:2048
    v_mov_b64 v[60:61], 0
    v_mov_b64 v[62:63], 0
    v_mov_b64 v[64:65], 0
    v_mov_b64 v[66:67], 0
    v_mov_b64 v[68:69], 0
    v_mov_b64_e64 v[70:71], 0
L_pollAf1X:
    buffer_load_dwordx4 v[20:23], v1, s[4:7], s1 offen offset:1024 sc1
    v_mov_b64 v[48:49], 0
    v_mov_b64 v[50:51], 0
    v_mov_b64 v[52:53], 0
    v_mov_b64 v[54:55], 0
    v_mov_b64 v[56:57], 0
    v_mov_b64 v[58:59], 0
    buffer_load_dwordx4 v[36:39], v1, s[4:7], s3 offen offset:1024 sc1
    s_waitcnt vmcnt(1)
    v_max_u32_e64 v124, v20, v22
    v_cmp_eq_u32 vcc, -1, v124
    ds_write_b128 v1, v[20:23] offset:23808
    v_smfmac_f32_16x16x64_bf16 v[56:59], v[20:23], a[144:151], v11
    s_cbranch_vccnz L_againAf1X
L_gotEf1X:
    v_smfmac_f32_16x16x64_bf16 v[48:51], v[20:23], a[16:23], v11
    v_smfmac_f32_16x16x64_bf16 v[60:63], v[20:23], a[152:159], v11
    s_waitcnt vmcnt(0)
    v_max_u32 v124, v36, v38
    v_cmp_eq_u32 vcc, -1, v124
    ds_write_b128 v1, v[36:39] offset:27904
    v_smfmac_f32_16x16x64_bf16 v[52:55], v[20:23], a[24:31], v11
    s_cbranch_vccnz L_retryAf1X
L_lateAf1X:
    s_waitcnt lgkmcnt(1)
    s_barrier
    ds_read_b128 v[24:27], v1 offset:24832
    ds_read_b128 v[28:31], v1 offset:25856
    ds_read_b128 v[16:19], v1 offset:22784
    v_smfmac_f32_16x16x64_bf16 v[56:59], v[36:39], a[208:215], v11
    v_smfmac_f32_16x16x64_bf16 v[60:63], v[36:39], a[216:223], v11
    v_smfmac_f32_16x16x64_bf16 v[64:67], v[20:23], v[144:151], v11
    v_smfmac_f32_16x16x64_bf16 v[68:71], v[20:23], v[152:159], v11
    s_waitcnt lgkmcnt(2)
    s_barrier
    v_smfmac_f32_16x16x64_bf16 v[56:59], v[24:27], a[160:167], v11
    ds_read_b128 v[40:43], v1 offset:28928
    v_smfmac_f32_16x16x64_bf16 v[60:63], v[24:27], a[168:175], v11
    ds_read_b128 v[44:47], v1 offset:29952
    v_smfmac_f32_16x16x64_bf16 v[64:67], v[24:27], v[160:167], v11
    ds_read_b128 v[32:35], v1 offset:26880
    v_smfmac_f32_16x16x64_bf16 v[68:71], v[24:27], v[168:175], v11
    ds_read_b128 v[80:83], v2 offset:4096
    s_waitcnt lgkmcnt(5)
    v_smfmac_f32_16x16x64_bf16 v[56:59], v[28:31], a[176:183], v11
    ds_read_b128 v[84:87], v2 offset:5120
    v_smfmac_f32_16x16x64_bf16 v[60:63], v[28:31], a[184:191], v11
    ds_read_b128 v[88:91], v2 offset:6144
    v_smfmac_f32_16x16x64_bf16 v[64:67], v[28:31], v[176:183], v11
    ds_read_b128 v[92:95], v2 offset:7168
    v_smfmac_f32_16x16x64_bf16 v[68:71], v[28:31], v[184:191], v11
    ds_read_b128 v[96:99], v2 offset:8192
    s_waitcnt lgkmcnt(8)
    v_smfmac_f32_16x16x64_bf16 v[56:59], v[16:19], a[128:135], v11
    ds_read_b128 v[100:103], v2 offset:9216
    v_smfmac_f32_16x16x64_bf16 v[60:63], v[16:19], a[136:143], v11
    ds_read_b128 v[104:107], v2 offset:10240
    v_smfmac_f32_16x16x64_bf16 v[64:67], v[16:19], v[128:135], v11
    ds_read_b128 v[108:111], v2 offset:11264
    v_smfmac_f32_16x16x64_bf16 v[68:71], v[16:19], v[136:143], v11
    v_lshrrev_b32 v120, 8, v1
    v_lshlrev_b32 v120, 10, v120
    v_bfe_u32 v121, v1, 4, 4
    v_lshl_add_u32 v120, v121, 3, v120
    s_lshl_b32 s52, s14, 12
    s_add_u32 s52, s52, 66978048
    s_waitcnt lgkmcnt(6)
    v_smfmac_f32_16x16x64_bf16 v[64:67], v[36:39], v[80:87], v11
    ds_read_b128 v[80:83], v2 offset:12288
    ds_read_b128 v[84:87], v2 offset:13312
    v_smfmac_f32_16x16x64_bf16 v[56:59], v[40:43], a[224:231], v11
    s_waitcnt lgkmcnt(6)
    v_smfmac_f32_16x16x64_bf16 v[68:71], v[36:39], v[88:95], v11
    ds_read_b128 v[88:91], v2 offset:14336
    ds_read_b128 v[92:95], v2 offset:15360
    v_smfmac_f32_16x16x64_bf16 v[60:63], v[40:43], a[232:239], v11
    s_waitcnt lgkmcnt(6)
    v_smfmac_f32_16x16x64_bf16 v[64:67], v[40:43], v[96:103], v11
    ds_read_b128 v[96:99], v2 offset:0
    ds_read_b128 v[100:103], v2 offset:1024
    v_smfmac_f32_16x16x64_bf16 v[56:59], v[44:47], a[240:247], v11
    s_waitcnt lgkmcnt(6)
    v_smfmac_f32_16x16x64_bf16 v[68:71], v[40:43], v[104:111], v11
    ds_read_b128 v[104:107], v2 offset:2048
    ds_read_b128 v[108:111], v2 offset:3072
    v_smfmac_f32_16x16x64_bf16 v[60:63], v[44:47], a[248:255], v11
    s_waitcnt lgkmcnt(6)
    v_smfmac_f32_16x16x64_bf16 v[64:67], v[44:47], v[80:87], v11
    v_smfmac_f32_16x16x64_bf16 v[56:59], v[32:35], a[192:199], v11
    s_waitcnt lgkmcnt(4)
    v_smfmac_f32_16x16x64_bf16 v[68:71], v[44:47], v[88:95], v11
    v_smfmac_f32_16x16x64_bf16 v[60:63], v[32:35], a[200:207], v11
    s_waitcnt lgkmcnt(2)
    v_smfmac_f32_16x16x64_bf16 v[64:67], v[32:35], v[96:103], v11
    s_waitcnt lgkmcnt(0)
    v_smfmac_f32_16x16x64_bf16 v[68:71], v[32:35], v[104:111], v11
    v_add_f32 v56, v56, v57
    v_add_f32 v58, v58, v59
    v_cvt_pk_bf16_f32 v56, v56, v58
    v_add_f32 v60, v60, v61
    v_add_f32 v62, v62, v63
    v_cvt_pk_bf16_f32 v60, v60, v62
    s_nop 1
    v_add_f32 v64, v64, v65
    v_add_f32_e64 v66, v66, v67
    v_cvt_pk_bf16_f32 v57, v64, v66
    buffer_store_dwordx2 v[56:57], v120, s[4:7], s52 offen offset:0 sc1
    v_add_f32 v68, v68, v69
    v_add_f32 v70, v70, v71
    v_cvt_pk_bf16_f32 v61, v68, v70
    buffer_store_dwordx2 v[60:61], v120, s[4:7], s52 offen offset:128 sc1
    s_waitcnt vmcnt(0)
    s_endpgm
L_cstart2X:
    v_mov_b32_e64 v14, v91
    ds_read_b128 v[80:83], v3 offset:0
    ds_read_b128 v[84:87], v3 offset:256
    ds_read_b128 v[88:91], v3 offset:2048
    ds_read_b128 v[92:95], v3 offset:2304
    ds_read_b128 v[96:99], v3 offset:4096
    ds_read_b128 v[100:103], v3 offset:4352
    ds_read_b128 v[104:107], v3 offset:6144
    ds_read_b128 v[108:111], v3 offset:6400
    ds_read_b64_tr_b16 v[72:73], v4 offset:12288
    ds_read_b64_tr_b16 v[74:75], v4 offset:12544
    ds_read_b64_tr_b16 v[76:77], v4 offset:13312
    ds_read_b64_tr_b16 v[78:79], v4 offset:13568
    v_mov_b64 v[48:49], 0
    v_mov_b64 v[50:51], 0
    v_mov_b64 v[52:53], 0
    v_mov_b64 v[54:55], 0
    v_mov_b64 v[56:57], 0
    v_mov_b64 v[58:59], 0
    v_mov_b64 v[60:61], 0
    v_mov_b64 v[62:63], 0
    v_mov_b64 v[64:65], 0
    v_mov_b64 v[66:67], 0
    v_mov_b64 v[68:69], 0
    v_mov_b64 v[70:71], 0
    v_mov_b64 v[112:113], 0
    v_mov_b64 v[114:115], 0
    v_mov_b64 v[116:117], 0
    v_mov_b64 v[118:119], 0
    s_add_u32 s58, s44, 1
    s_min_u32 s58, s58, 63
L_kvchkq2X:
    v_cmp_gt_i32 vcc, s58, v14
    s_cbranch_vccz L_kvokq2X
    buffer_load_dword v14, v13, s[4:7], s28 offen sc1
    s_waitcnt vmcnt(0)
    s_sub_u32 s96, s96, 1
    s_cbranch_scc0 L_kvchkq2X
    s_branch L_abort
L_kvokq2X:
    s_lshl_b32 s58, s58, 18
    s_add_u32 s58, s58, 16777216
    s_lshl_b32 s29, s44, 17
    s_cmp_gt_u32 s44, 56
    s_mov_b32 s52, 50331648
    s_cselect_b32 s52, 58589184, s52
    s_add_u32 s29, s29, s52
    s_waitcnt lgkmcnt(0)
    s_barrier
.p2align 6
L_top2X:
    ds_read_b128 v[80:83], v3 offset:0
    ds_read_b128 v[84:87], v3 offset:256
    ds_read_b128 v[88:91], v3 offset:2048
    v_mov_b64 v[60:61], 0
    v_mov_b64 v[62:63], 0
    v_mov_b64 v[64:65], 0
    v_mov_b64 v[66:67], 0
    v_mov_b64 v[68:69], 0
    v_mov_b64 v[70:71], 0
L_pollA2X:
    buffer_load_dwordx4 v[24:27], v1, s[4:7], s1 offen offset:2048 sc1
    v_mov_b64 v[48:49], 0
    v_mov_b64 v[50:51], 0
    v_mov_b64 v[52:53], 0
    v_mov_b64 v[54:55], 0
    v_mov_b64 v[56:57], 0
    v_mov_b64 v[58:59], 0
    buffer_load_dwordx4 v[40:43], v1, s[4:7], s3 offen offset:2048 sc1
    s_waitcnt vmcnt(1)
    v_max_u32_e64 v124, v24, v26
    v_cmp_eq_u32 vcc, -1, v124
    ds_write_b128 v1, v[24:27] offset:24832
    v_smfmac_f32_16x16x64_bf16 v[56:59], v[24:27], a[160:167], v11
    s_cbranch_vccnz L_againA2X
L_gotE2X:
    v_smfmac_f32_16x16x64_bf16 v[48:51], v[24:27], a[32:39], v11
    v_smfmac_f32_16x16x64_bf16 v[60:63], v[24:27], a[168:175], v11
    s_waitcnt vmcnt(0)
    v_max_u32 v124, v40, v42
    v_cmp_eq_u32 vcc, -1, v124
    ds_write_b128 v1, v[40:43] offset:28928
    v_smfmac_f32_16x16x64_bf16 v[52:55], v[24:27], a[40:47], v11
    s_cbranch_vccnz L_retryA2X
L_lateA2X:
    s_waitcnt lgkmcnt(1)
    s_barrier
    v_smfmac_f32_16x16x64_bf16 v[56:59], v[40:43], a[224:231], v11
    ds_read_b128 v[28:31], v1 offset:25856
    v_smfmac_f32_16x16x64_bf16 v[48:51], v[40:43], a[96:103], v11
    ds_read_b128 v[16:19], v1 offset:22784
    v_smfmac_f32_16x16x64_bf16 v[60:63], v[40:43], a[232:239], v11
    ds_read_b128 v[20:23], v1 offset:23808
    s_mov_b32 m0, 0
    v_smfmac_f32_16x16x64_bf16 v[52:55], v[40:43], a[104:111], v11
    buffer_load_dwordx4 v9, s[4:7], s58 offen offset:0 sc1 lds
    v_smfmac_f32_16x16x64_bf16 v[64:67], v[24:27], v[160:167], v11
    buffer_load_dwordx4 v9, s[4:7], s58 offen offset:1024 sc1 lds
    v_smfmac_f32_16x16x64_bf16 v[68:71], v[24:27], v[168:175], v11
    buffer_load_dwordx4 v9, s[4:7], s58 offen offset:2048 sc1 lds
    s_waitcnt lgkmcnt(2)
    s_barrier
    v_smfmac_f32_16x16x64_bf16 v[56:59], v[28:31], a[176:183], v11
    ds_read_b128 v[44:47], v1 offset:29952
    v_smfmac_f32_16x16x64_bf16 v[48:51], v[28:31], a[48:55], v11
    ds_read_b128 v[32:35], v1 offset:26880
    v_smfmac_f32_16x16x64_bf16 v[60:63], v[28:31], a[184:191], v11
    ds_read_b128 v[36:39], v1 offset:27904
    v_smfmac_f32_16x16x64_bf16 v[52:55], v[28:31], a[56:63], v11
    buffer_load_dwordx4 v9, s[4:7], s58 offen offset:3072 sc1 lds
    s_waitcnt lgkmcnt(4)
    v_smfmac_f32_16x16x64_bf16 v[56:59], v[16:19], a[128:135], v11
    s_mov_b32 m0, 4096
    s_add_u32 s58, s58, 4096
    v_smfmac_f32_16x16x64_bf16 v[48:51], v[16:19], a[0:7], v11
    buffer_load_dwordx4 v9, s[4:7], s58 offen offset:0 sc1 lds
    v_smfmac_f32_16x16x64_bf16 v[60:63], v[16:19], a[136:143], v11
    buffer_load_dwordx4 v9, s[4:7], s58 offen offset:1024 sc1 lds
    v_smfmac_f32_16x16x64_bf16 v[52:55], v[16:19], a[8:15], v11
    buffer_load_dwordx4 v9, s[4:7], s58 offen offset:2048 sc1 lds
    s_waitcnt lgkmcnt(3)
    v_smfmac_f32_16x16x64_bf16 v[56:59], v[20:23], a[144:151], v11
    v_smfmac_f32_16x16x64_bf16 v[48:51], v[20:23], a[16:23], v11
    v_smfmac_f32_16x16x64_bf16 v[60:63], v[20:23], a[152:159], v11
    v_smfmac_f32_16x16x64_bf16 v[52:55], v[20:23], a[24:31], v11
    s_waitcnt lgkmcnt(2)
    v_smfmac_f32_16x16x64_bf16 v[56:59], v[44:47], a[240:247], v11
    v_smfmac_f32_16x16x64_bf16 v[48:51], v[44:47], a[112:119], v11
    v_smfmac_f32_16x16x64_bf16 v[60:63], v[44:47], a[248:255], v11
    v_smfmac_f32_16x16x64_bf16 v[52:55], v[44:47], a[120:127], v11
    s_waitcnt lgkmcnt(0)
    v_smfmac_f32_16x16x64_bf16 v[56:59], v[32:35], a[192:199], v11
    v_smfmac_f32_16x16x64_bf16 v[48:51], v[32:35], a[64:71], v11
    v_smfmac_f32_16x16x64_bf16 v[56:59], v[36:39], a[208:215], v11
    v_smfmac_f32_16x16x64_bf16 v[48:51], v[36:39], a[80:87], v11
    v_smfmac_f32_16x16x64_bf16 v[60:63], v[32:35], a[200:207], v11
    v_smfmac_f32_16x16x64_bf16 v[60:63], v[36:39], a[216:223], v11
    v_add_f32_e64 v56, v56, v57
    v_smfmac_f32_16x16x64_bf16 v[52:55], v[32:35], a[72:79], v11
    v_add_f32_e64 v58, v58, v59
    v_smfmac_f32_16x16x64_bf16 v[52:55], v[36:39], a[88:95], v11
    v_add_f32 v48, v48, v49
    v_add_f32 v50, v50, v51
    v_cvt_pk_bf16_f32 v56, v56, v58
    v_cvt_pk_bf16_f32 v57, v48, v50
    ds_write_b64 v6, v[56:57] offset:16896
L_qkdone2X:
    v_add_f32 v60, v60, v61
    v_add_f32 v62, v62, v63
    v_cvt_pk_bf16_f32 v60, v60, v62
    v_add_f32 v52, v52, v53
    v_add_f32 v54, v54, v55
    v_cvt_pk_bf16_f32 v61, v52, v54
    ds_write_b64 v6, v[60:61] offset:17024
    v_smfmac_f32_16x16x64_bf16 v[64:67], v[28:31], v[176:183], v11
    buffer_load_dwordx4 v9, s[4:7], s58 offen offset:3072 sc1 lds
    v_smfmac_f32_16x16x64_bf16 v[68:71], v[28:31], v[184:191], v11
    buffer_load_dword v14, v13, s[4:7], s28 offen sc1
    v_smfmac_f32_16x16x64_bf16 v[64:67], v[16:19], v[128:135], v11
    buffer_store_dwordx4 v[112:115], v10, s[4:7], s29 offen offset:0 sc1
    v_smfmac_f32_16x16x64_bf16 v[68:71], v[16:19], v[136:143], v11
    buffer_store_dwordx4 v[116:119], v10, s[4:7], s29 offen offset:1024 sc1
    s_waitcnt lgkmcnt(0)
    s_barrier
    ds_read_b64_tr_b16 v[48:49], v5 offset:16384
    ds_read_b64_tr_b16 v[50:51], v5 offset:16416
    ds_read_b64_tr_b16 v[52:53], v5 offset:16640
    ds_read_b64_tr_b16 v[54:55], v5 offset:16672
    ds_read_b64_tr_b16 v[56:57], v5 offset:16896
    ds_read_b64_tr_b16 v[58:59], v5 offset:16928
    ds_read_b64_tr_b16 v[60:61], v5 offset:17152
    ds_read_b64_tr_b16 v[62:63], v5 offset:17184
    v_smfmac_f32_16x16x64_bf16 v[64:67], v[20:23], v[144:151], v11
    v_smfmac_f32_16x16x64_bf16 v[68:71], v[20:23], v[152:159], v11
    ds_read_b128 v[16:19], v2 offset:0
    ds_read_b128 v[20:23], v2 offset:1024
    s_waitcnt lgkmcnt(8)
    v_mfma_f32_16x16x32_bf16 v[116:119], v[80:83], v[48:51], 0
    ds_read_b128 v[24:27], v2 offset:2048
    v_mfma_f32_16x16x32_bf16 v[120:123], v[84:87], v[48:51], 0
    ds_read_b128 v[28:31], v2 offset:3072
    v_mfma_f32_16x16x32_bf16 v[124:127], v[48:51], v[48:51], 0
    ds_read_b128 v[80:83], v2 offset:4096
    s_waitcnt lgkmcnt(9)
    v_mfma_f32_16x16x32_bf16 v[116:119], v[88:91], v[52:55], v[116:119]
    ds_read_b128 v[84:87], v2 offset:5120
    v_mfma_f32_16x16x32_bf16 v[120:123], v[92:95], v[52:55], v[120:123]
    ds_read_b128 v[88:91], v2 offset:6144
    v_mfma_f32_16x16x32_bf16 v[124:127], v[52:55], v[52:55], v[124:127]
    ds_read_b128 v[92:95], v2 offset:7168
    s_waitcnt lgkmcnt(10)
    v_mfma_f32_16x16x32_bf16 v[116:119], v[96:99], v[56:59], v[116:119]
    ds_read_b128 v[48:51], v2 offset:12288
    v_mfma_f32_16x16x32_bf16 v[120:123], v[100:103], v[56:59], v[120:123]
    ds_read_b128 v[52:55], v2 offset:13312
    v_mfma_f32_16x16x32_bf16 v[124:127], v[56:59], v[56:59], v[124:127]
    ds_read_b128 v[96:99], v2 offset:8192
    s_waitcnt lgkmcnt(11)
    v_mfma_f32_16x16x32_bf16 v[116:119], v[104:107], v[60:63], v[116:119]
    ds_read_b128 v[100:103], v2 offset:9216
    v_mfma_f32_16x16x32_bf16 v[120:123], v[108:111], v[60:63], v[120:123]
    ds_read_b128 v[104:107], v2 offset:10240
    v_mfma_f32_16x16x32_bf16 v[124:127], v[60:63], v[60:63], v[124:127]
    ds_read_b128 v[108:111], v2 offset:11264
    ds_read_b128 v[56:59], v2 offset:14336
    s_waitcnt lgkmcnt(11)
    v_smfmac_f32_16x16x64_bf16 v[64:67], v[32:35], v[16:23], v11
    ds_read_b128 v[60:63], v2 offset:15360
    v_max3_f32 v112, v116, v117, v118
    v_smfmac_f32_16x16x64_bf16 v[68:71], v[32:35], v[24:31], v11
    v_max3_f32 v113, v119, v120, v121
    s_waitcnt lgkmcnt(8)
    v_smfmac_f32_16x16x64_bf16 v[64:67], v[36:39], v[80:87], v11
    v_max3_f32 v112, v112, v122, v123
    v_max3_f32 v126, v113, v124, v125
    v_smfmac_f32_16x16x64_bf16 v[68:71], v[36:39], v[88:95], v11
    v_max_f32 v127, v112, v126
    v_max_f32_e64 v126, v112, v126
    s_waitcnt lgkmcnt(4)
    v_smfmac_f32_16x16x64_bf16 v[64:67], v[44:47], v[48:55], v11
    s_nop 0
    v_permlane16_swap_b32 v126, v127
    v_smfmac_f32_16x16x64_bf16 v[64:67], v[40:43], v[96:103], v11
    v_max_f32 v112, v126, v127
    v_max_f32_e64 v113, v126, v127
    s_waitcnt lgkmcnt(0)
    v_smfmac_f32_16x16x64_bf16 v[68:71], v[40:43], v[104:111], v11
    s_nop 0
    v_permlane32_swap_b32 v112, v113
    v_smfmac_f32_16x16x64_bf16 v[68:71], v[44:47], v[56:63], v11
    v_max_f32 v126, v112, v113
    v_mul_f32 v126, s55, v126
    v_mov_b64 v[16:17], s[78:79]
    v_mov_b64 v[18:19], s[78:79]
    v_pk_fma_f32 v[116:117], v[116:117], s[32:33], v[126:127] op_sel_hi:[1,1,0] neg_lo:[0,0,1] neg_hi:[0,0,1]
    v_pk_fma_f32 v[118:119], v[118:119], s[32:33], v[126:127] op_sel_hi:[1,1,0] neg_lo:[0,0,1] neg_hi:[0,0,1]
    v_pk_fma_f32 v[120:121], v[120:121], s[32:33], v[126:127] op_sel_hi:[1,1,0] neg_lo:[0,0,1] neg_hi:[0,0,1]
    v_pk_fma_f32 v[122:123], v[122:123], s[32:33], v[126:127] op_sel_hi:[1,1,0] neg_lo:[0,0,1] neg_hi:[0,0,1]
    v_pk_fma_f32 v[124:125], v[124:125], s[32:33], v[126:127] op_sel_hi:[1,1,0] neg_lo:[0,0,1] neg_hi:[0,0,1]
    v_exp_f32 v116, v116
    v_exp_f32 v117, v117
    v_exp_f32_e64 v118, v118
    v_cvt_pk_bf16_f32 v112, v116, v117
    v_exp_f32 v119, v119
    v_exp_f32 v120, v120
    v_cvt_pk_bf16_f32 v113, v118, v119
    v_exp_f32 v121, v121
    v_exp_f32 v122, v122
    v_cvt_pk_bf16_f32 v114, v120, v121
    v_exp_f32 v123, v123
    v_exp_f32 v124, v124
    v_cvt_pk_bf16_f32 v115, v122, v123
    v_exp_f32 v125, v125
    v_add_f32 v64, v64, v65
    v_mfma_f32_16x16x32_bf16 v[20:23], v[16:19], v[112:115], 0
    v_cvt_pk_bf16_f32 v124, v124, v125
    v_mov_b32_e64 v125, 0
    v_mfma_f32_16x16x32_bf16 v[24:27], v[72:75], v[112:115], 0
    v_add_f32 v66, v66, v67
    v_add_f32 v68, v68, v69
    v_mfma_f32_16x16x32_bf16 v[28:31], v[76:79], v[112:115], 0
    v_cvt_pk_bf16_f32 v64, v64, v66
    v_mov_b32_e64 v65, 0
    v_mfma_f32_16x16x16_bf16 v[20:23], v[16:17], v[124:125], v[20:23]
    v_add_f32 v70, v70, v71
    v_mov_b32 v69, 0
    v_cvt_pk_bf16_f32 v68, v68, v70
    v_mfma_f32_16x16x16_bf16 v[24:27], v[64:65], v[124:125], v[24:27]
    ds_read_b128 v[80:83], v2 offset:16384
    v_mfma_f32_16x16x16_bf16 v[28:31], v[68:69], v[124:125], v[28:31]
    v_rcp_f32_e64 v20, v20
    ds_read_b128 v[84:87], v2 offset:17408
    ds_read_b128 v[88:91], v2 offset:24576
    ds_read_b128 v[92:95], v2 offset:25600
    v_pk_mul_f32 v[24:25], v[24:25], v[20:21] op_sel_hi:[1,0]
    v_pk_mul_f32 v[26:27], v[26:27], v[20:21] op_sel_hi:[1,0]
    v_cvt_pk_bf16_f32 v16, v24, v25
    v_cvt_pk_bf16_f32 v17, v26, v27
    v_pk_mul_f32 v[28:29], v[28:29], v[20:21] op_sel_hi:[1,0]
    v_pk_mul_f32 v[30:31], v[30:31], v[20:21] op_sel_hi:[1,0]
    v_cvt_pk_bf16_f32 v18, v28, v29
    v_cvt_pk_bf16_f32 v19, v30, v31
    s_mov_b64 exec, s[56:57]
    ds_write_b128 v7, v[16:19] offset:21760
    s_mov_b64 exec, -1
    v_mov_b64 v[112:113], 0
    v_mov_b64 v[114:115], 0
    v_mov_b64 v[116:117], 0
    v_mov_b64 v[118:119], 0
    v_mov_b64 v[120:121], 0
    v_mov_b64 v[122:123], 0
    v_mov_b64 v[124:125], 0
    v_mov_b64 v[126:127], 0
    ds_read_b128 v[48:51], v2 offset:18432
    ds_read_b128 v[52:55], v2 offset:19456
    s_waitcnt lgkmcnt(2)
    s_barrier
    ds_read_b128 v[72:75], v1 offset:20736
    ds_read_b128 v[76:79], v1 offset:21760
    v_mov_b64 v[16:17], 0
    v_mov_b64 v[18:19], 0
    v_mov_b64 v[20:21], 0
    v_mov_b64 v[22:23], 0
    v_mov_b64 v[24:25], 0
    v_mov_b64 v[26:27], 0
    v_mov_b64 v[28:29], 0
    v_mov_b64 v[30:31], 0
    ds_read_b128 v[96:99], v2 offset:26624
    ds_read_b128 v[100:103], v2 offset:27648
    ds_read_b128 v[104:107], v2 offset:20480
    s_waitcnt lgkmcnt(4)
    v_smfmac_f32_16x16x64_bf16 v[112:115], v[72:75], v[192:199], v11
    ds_read_b128 v[108:111], v2 offset:21504
    s_waitcnt lgkmcnt(4)
    v_smfmac_f32_16x16x64_bf16 v[112:115], v[76:79], v[200:207], v11
    ds_read_b128 v[56:59], v2 offset:28672
    v_smfmac_f32_16x16x64_bf16 v[116:119], v[72:75], v[208:215], v11
    ds_read_b128 v[60:63], v2 offset:29696
    v_smfmac_f32_16x16x64_bf16 v[116:119], v[76:79], v[216:223], v11
    v_add_f32 v112, v112, v113
    v_add_f32 v114, v114, v115
    v_smfmac_f32_16x16x64_bf16 v[120:123], v[72:75], v[224:231], v11
    ds_read_b128 v[32:35], v2 offset:22528
    v_smfmac_f32_16x16x64_bf16 v[120:123], v[76:79], v[232:239], v11
    v_add_f32 v116, v116, v117
    v_add_f32 v118, v118, v119
    v_smfmac_f32_16x16x64_bf16 v[124:127], v[72:75], v[240:247], v11
    v_cvt_pk_bf16_f32 v112, v112, v116
    v_cvt_pk_bf16_f32 v114, v114, v118
    v_smfmac_f32_16x16x64_bf16 v[124:127], v[76:79], v[248:255], v11
    v_bfi_b32 v112, 1, s47, v112
    v_add_f32 v120, v120, v121
    v_add_f32 v122, v122, v123
    v_smfmac_f32_16x16x64_bf16 v[16:19], v[72:75], v[80:87], v11
    ds_read_b128 v[36:39], v2 offset:23552
    v_smfmac_f32_16x16x64_bf16 v[16:19], v[76:79], v[88:95], v11
    v_add_f32 v124, v124, v125
    v_add_f32 v126, v126, v127
    v_cvt_pk_bf16_f32 v113, v120, v124
    v_cvt_pk_bf16_f32 v115, v122, v126
    buffer_store_dwordx4 v[112:115], v8, s[4:7], s45 offen sc1
    ds_read_b128 v[40:43], v2 offset:30720
    v_smfmac_f32_16x16x64_bf16 v[20:23], v[72:75], v[48:55], v11
    ds_read_b128 v[44:47], v2 offset:31744
    s_waitcnt lgkmcnt(8)
    v_smfmac_f32_16x16x64_bf16 v[20:23], v[76:79], v[96:103], v11
    v_add_f32 v16, v16, v17
    v_add_f32 v18, v18, v19
    s_waitcnt lgkmcnt(6)
    v_smfmac_f32_16x16x64_bf16 v[24:27], v[72:75], v[104:111], v11
    s_waitcnt lgkmcnt(4)
    v_smfmac_f32_16x16x64_bf16 v[24:27], v[76:79], v[56:63], v11
    v_add_f32 v20, v20, v21
    v_add_f32 v22, v22, v23
    s_waitcnt lgkmcnt(2)
    v_smfmac_f32_16x16x64_bf16 v[28:31], v[72:75], v[32:39], v11
    v_cvt_pk_bf16_f32 v16, v16, v20
    v_cvt_pk_bf16_f32 v18, v18, v22
    s_waitcnt lgkmcnt(0)
    v_smfmac_f32_16x16x64_bf16 v[28:31], v[76:79], v[40:47], v11
    v_bfi_b32 v16, 1, s47, v16
    v_add_f32 v24, v24, v25
    v_add_f32 v26, v26, v27
    s_nop 4
    v_add_f32 v28, v28, v29
    v_add_f32 v30, v30, v31
    v_cvt_pk_bf16_f32 v17, v24, v28
    v_cvt_pk_bf16_f32 v19, v26, v30
    buffer_store_dwordx4 v[16:19], v8, s[4:7], s46 offen sc1
    ds_write_b32 v6, v64 offset:16900
    ds_write_b32 v6, v68 offset:17028
    s_mov_b32 s2, s44
    s_add_u32 s44, s44, 1
    s_mov_b32 s51, s48
    s_mov_b32 s48, s49
    s_mov_b32 s49, s50
    s_mov_b32 s50, s51
    s_add_u32 s1, s48, s0
    s_add_u32 s3, s1, 4096
    s_waitcnt vmcnt(2) lgkmcnt(0)
    s_barrier
    ds_read_b128 v[92:95], v3 offset:2304
    ds_read_b128 v[96:99], v3 offset:4096
    ds_read_b128 v[100:103], v3 offset:4352
    ds_read_b128 v[104:107], v3 offset:6144
    ds_read_b128 v[108:111], v3 offset:6400
    ds_read_b64_tr_b16 v[72:73], v4 offset:12288
    ds_read_b64_tr_b16 v[74:75], v4 offset:12544
    ds_read_b64_tr_b16 v[76:77], v4 offset:13312
    ds_read_b64_tr_b16 v[78:79], v4 offset:13568
    ds_read_b128 v[112:115], v1 offset:16384
    ds_read_b128 v[116:119], v1 offset:17440
    s_add_u32 s58, s44, 1
    s_min_u32 s58, s58, 63
L_kvchks2X:
    v_cmp_gt_i32 vcc, s58, v14
    s_cbranch_vccz L_kvoks2X
    buffer_load_dword v14, v13, s[4:7], s28 offen sc1
    s_waitcnt vmcnt(0)
    s_sub_u32 s96, s96, 1
    s_cbranch_scc0 L_kvchks2X
    s_branch L_abort
L_kvoks2X:
    s_lshl_b32 s58, s58, 18
    s_add_u32 s58, s58, 16777216
    s_lshl_b32 s29, s44, 17
    s_cmp_gt_u32 s44, 56
    s_mov_b32 s52, 50331648
    s_cselect_b32 s52, 58589184, s52
    s_add_u32 s29, s29, s52
    s_xor_b32 s47, s47, 1
    s_waitcnt lgkmcnt(0)
    s_cmp_lt_u32 s44, 63
    s_barrier
    s_cbranch_scc1 L_top2X
    s_branch L_final2X
L_againA2X:
    s_waitcnt vmcnt(0) lgkmcnt(0)
    s_nop 7
    v_mov_b64 v[56:57], 0
    v_mov_b64_e64 v[58:59], 0
    s_sub_u32 s96, s96, 1
    s_cbranch_scc0 L_pollA2X
    s_branch L_abort
L_retryA2X:
L_retry22X:
    s_waitcnt lgkmcnt(0)
    buffer_load_dwordx4 v[40:43], v1, s[4:7], s3 offen offset:2048 sc1
    s_waitcnt vmcnt(0)
    v_max_u32_e64 v124, v40, v42
    v_cmp_eq_u32 vcc, -1, v124
    ds_write_b128 v1, v[40:43] offset:28928
    s_cbranch_vccz L_lateA2X
    s_sub_u32 s96, s96, 1
    s_cbranch_scc0 L_retry22X
    s_branch L_abort
L_againAf2X:
    s_waitcnt vmcnt(0) lgkmcnt(0)
    s_nop 7
    v_mov_b64 v[56:57], 0
    v_mov_b64 v[58:59], 0
    s_sub_u32 s96, s96, 1
    s_cbranch_scc0 L_pollAf2X
    s_branch L_abort
L_retryAf2X:
L_retry2f2X:
    s_waitcnt lgkmcnt(0)
    buffer_load_dwordx4 v[40:43], v1, s[4:7], s3 offen offset:2048 sc1
    s_waitcnt vmcnt(0)
    v_max_u32_e64 v124, v40, v42
    v_cmp_eq_u32 vcc, -1, v124
    ds_write_b128 v1, v[40:43] offset:28928
    s_cbranch_vccz L_lateAf2X
    s_sub_u32 s96, s96, 1
    s_cbranch_scc0 L_retry2f2X
    s_branch L_abort
L_final2X:
    ds_read_b128 v[80:83], v3 offset:0
    ds_read_b128 v[84:87], v3 offset:256
    ds_read_b128 v[88:91], v3 offset:2048
    v_mov_b64 v[60:61], 0
    v_mov_b64 v[62:63], 0
    v_mov_b64 v[64:65], 0
    v_mov_b64 v[66:67], 0
    v_mov_b64 v[68:69], 0
    v_mov_b64 v[70:71], 0
L_pollAf2X:
    buffer_load_dwordx4 v[24:27], v1, s[4:7], s1 offen offset:2048 sc1
    v_mov_b64 v[48:49], 0
    v_mov_b64 v[50:51], 0
    v_mov_b64 v[52:53], 0
    v_mov_b64 v[54:55], 0
    v_mov_b64 v[56:57], 0
    v_mov_b64 v[58:59], 0
    buffer_load_dwordx4 v[40:43], v1, s[4:7], s3 offen offset:2048 sc1
    s_waitcnt vmcnt(1)
    v_max_u32_e64 v124, v24, v26
    v_cmp_eq_u32 vcc, -1, v124
    ds_write_b128 v1, v[24:27] offset:24832
    v_smfmac_f32_16x16x64_bf16 v[56:59], v[24:27], a[160:167], v11
    s_cbranch_vccnz L_againAf2X
L_gotEf2X:
    v_smfmac_f32_16x16x64_bf16 v[48:51], v[24:27], a[32:39], v11
    v_smfmac_f32_16x16x64_bf16 v[60:63], v[24:27], a[168:175], v11
    s_waitcnt vmcnt(0)
    v_max_u32 v124, v40, v42
    v_cmp_eq_u32 vcc, -1, v124
    ds_write_b128 v1, v[40:43] offset:28928
    v_smfmac_f32_16x16x64_bf16 v[52:55], v[24:27], a[40:47], v11
    s_cbranch_vccnz L_retryAf2X
L_lateAf2X:
    s_waitcnt lgkmcnt(1)
    s_barrier
    ds_read_b128 v[28:31], v1 offset:25856
    ds_read_b128 v[16:19], v1 offset:22784
    ds_read_b128 v[20:23], v1 offset:23808
    s_mov_b32 s52, 66846720
    buffer_store_dwordx4 v[112:115], v10, s[4:7], s52 offen offset:0 sc1
    buffer_store_dwordx4 v[116:119], v10, s[4:7], s52 offen offset:1024 sc1
    v_smfmac_f32_16x16x64_bf16 v[56:59], v[40:43], a[224:231], v11
    v_smfmac_f32_16x16x64_bf16 v[60:63], v[40:43], a[232:239], v11
    v_smfmac_f32_16x16x64_bf16 v[64:67], v[24:27], v[160:167], v11
    v_smfmac_f32_16x16x64_bf16 v[68:71], v[24:27], v[168:175], v11
    s_waitcnt lgkmcnt(2)
    s_barrier
    v_smfmac_f32_16x16x64_bf16 v[56:59], v[28:31], a[176:183], v11
    ds_read_b128 v[44:47], v1 offset:29952
    v_smfmac_f32_16x16x64_bf16 v[60:63], v[28:31], a[184:191], v11
    ds_read_b128 v[32:35], v1 offset:26880
    v_smfmac_f32_16x16x64_bf16 v[64:67], v[28:31], v[176:183], v11
    ds_read_b128 v[36:39], v1 offset:27904
    v_smfmac_f32_16x16x64_bf16 v[68:71], v[28:31], v[184:191], v11
    ds_read_b128 v[80:83], v2 offset:8192
    s_waitcnt lgkmcnt(5)
    v_smfmac_f32_16x16x64_bf16 v[56:59], v[16:19], a[128:135], v11
    ds_read_b128 v[84:87], v2 offset:9216
    v_smfmac_f32_16x16x64_bf16 v[60:63], v[16:19], a[136:143], v11
    ds_read_b128 v[88:91], v2 offset:10240
    v_smfmac_f32_16x16x64_bf16 v[64:67], v[16:19], v[128:135], v11
    ds_read_b128 v[92:95], v2 offset:11264
    v_smfmac_f32_16x16x64_bf16 v[68:71], v[16:19], v[136:143], v11
    ds_read_b128 v[96:99], v2 offset:12288
    s_waitcnt lgkmcnt(8)
    v_smfmac_f32_16x16x64_bf16 v[56:59], v[20:23], a[144:151], v11
    ds_read_b128 v[100:103], v2 offset:13312
    v_smfmac_f32_16x16x64_bf16 v[60:63], v[20:23], a[152:159], v11
    ds_read_b128 v[104:107], v2 offset:14336
    v_smfmac_f32_16x16x64_bf16 v[64:67], v[20:23], v[144:151], v11
    ds_read_b128 v[108:111], v2 offset:15360
    v_smfmac_f32_16x16x64_bf16 v[68:71], v[20:23], v[152:159], v11
    v_lshrrev_b32 v120, 8, v1
    v_lshlrev_b32 v120, 10, v120
    v_bfe_u32 v121, v1, 4, 4
    v_lshl_add_u32 v120, v121, 3, v120
    s_lshl_b32 s52, s14, 12
    s_add_u32 s52, s52, 66978304
    s_waitcnt lgkmcnt(6)
    v_smfmac_f32_16x16x64_bf16 v[64:67], v[40:43], v[80:87], v11
    ds_read_b128 v[80:83], v2 offset:0
    ds_read_b128 v[84:87], v2 offset:1024
    v_smfmac_f32_16x16x64_bf16 v[56:59], v[44:47], a[240:247], v11
    s_waitcnt lgkmcnt(6)
    v_smfmac_f32_16x16x64_bf16 v[68:71], v[40:43], v[88:95], v11
    ds_read_b128 v[88:91], v2 offset:2048
    ds_read_b128 v[92:95], v2 offset:3072
    v_smfmac_f32_16x16x64_bf16 v[60:63], v[44:47], a[248:255], v11
    s_waitcnt lgkmcnt(6)
    v_smfmac_f32_16x16x64_bf16 v[64:67], v[44:47], v[96:103], v11
    ds_read_b128 v[96:99], v2 offset:4096
    ds_read_b128 v[100:103], v2 offset:5120
    v_smfmac_f32_16x16x64_bf16 v[56:59], v[32:35], a[192:199], v11
    s_waitcnt lgkmcnt(6)
    v_smfmac_f32_16x16x64_bf16 v[68:71], v[44:47], v[104:111], v11
    ds_read_b128 v[104:107], v2 offset:6144
    ds_read_b128 v[108:111], v2 offset:7168
    v_smfmac_f32_16x16x64_bf16 v[60:63], v[32:35], a[200:207], v11
    s_waitcnt lgkmcnt(6)
    v_smfmac_f32_16x16x64_bf16 v[64:67], v[32:35], v[80:87], v11
    v_smfmac_f32_16x16x64_bf16 v[56:59], v[36:39], a[208:215], v11
    s_waitcnt lgkmcnt(4)
    v_smfmac_f32_16x16x64_bf16 v[68:71], v[32:35], v[88:95], v11
    v_smfmac_f32_16x16x64_bf16 v[60:63], v[36:39], a[216:223], v11
    s_waitcnt lgkmcnt(2)
    v_smfmac_f32_16x16x64_bf16 v[64:67], v[36:39], v[96:103], v11
    s_waitcnt lgkmcnt(0)
    v_smfmac_f32_16x16x64_bf16 v[68:71], v[36:39], v[104:111], v11
    v_add_f32 v56, v56, v57
    v_add_f32 v58, v58, v59
    v_cvt_pk_bf16_f32 v56, v56, v58
    v_add_f32 v60, v60, v61
    v_add_f32 v62, v62, v63
    v_cvt_pk_bf16_f32 v60, v60, v62
    s_nop 1
    v_add_f32 v64, v64, v65
    v_add_f32_e64 v66, v66, v67
    v_cvt_pk_bf16_f32 v57, v64, v66
    buffer_store_dwordx2 v[56:57], v120, s[4:7], s52 offen offset:0 sc1
    v_add_f32 v68, v68, v69
    v_add_f32 v70, v70, v71
    v_cvt_pk_bf16_f32 v61, v68, v70
    buffer_store_dwordx2 v[60:61], v120, s[4:7], s52 offen offset:128 sc1
    s_waitcnt vmcnt(0)
    s_endpgm
L_cstart3X:
    v_mov_b32_e64 v14, v91
    ds_read_b128 v[80:83], v3 offset:0
    ds_read_b128 v[84:87], v3 offset:256
    ds_read_b128 v[88:91], v3 offset:2048
    ds_read_b128 v[92:95], v3 offset:2304
    ds_read_b128 v[96:99], v3 offset:4096
    ds_read_b128 v[100:103], v3 offset:4352
    ds_read_b128 v[104:107], v3 offset:6144
    ds_read_b128 v[108:111], v3 offset:6400
    ds_read_b64_tr_b16 v[72:73], v4 offset:14336
    ds_read_b64_tr_b16 v[74:75], v4 offset:14592
    ds_read_b64_tr_b16 v[76:77], v4 offset:15360
    ds_read_b64_tr_b16 v[78:79], v4 offset:15616
    v_mov_b64 v[48:49], 0
    v_mov_b64 v[50:51], 0
    v_mov_b64 v[52:53], 0
    v_mov_b64 v[54:55], 0
    v_mov_b64 v[56:57], 0
    v_mov_b64 v[58:59], 0
    v_mov_b64 v[60:61], 0
    v_mov_b64 v[62:63], 0
    v_mov_b64 v[64:65], 0
    v_mov_b64 v[66:67], 0
    v_mov_b64 v[68:69], 0
    v_mov_b64 v[70:71], 0
    v_mov_b64 v[112:113], 0
    v_mov_b64 v[114:115], 0
    v_mov_b64 v[116:117], 0
    v_mov_b64 v[118:119], 0
    s_add_u32 s58, s44, 1
    s_min_u32 s58, s58, 63
L_kvchkq3X:
    v_cmp_gt_i32 vcc, s58, v14
    s_cbranch_vccz L_kvokq3X
    buffer_load_dword v14, v13, s[4:7], s28 offen sc1
    s_waitcnt vmcnt(0)
    s_sub_u32 s96, s96, 1
    s_cbranch_scc0 L_kvchkq3X
    s_branch L_abort
L_kvokq3X:
    s_lshl_b32 s58, s58, 18
    s_add_u32 s58, s58, 33554432
    s_lshl_b32 s29, s44, 17
    s_cmp_gt_u32 s44, 56
    s_mov_b32 s52, 50333696
    s_cselect_b32 s52, 58591232, s52
    s_add_u32 s29, s29, s52
    s_sub_u32 s52, s44, 2
    s_max_i32 s52, s52, -1
    v_mov_b32 v12, s52
    s_waitcnt lgkmcnt(0)
    s_barrier
.p2align 6
L_top3X:
    ds_read_b128 v[80:83], v3 offset:0
    ds_read_b128 v[84:87], v3 offset:256
    ds_read_b128 v[88:91], v3 offset:2048
    v_mov_b64 v[60:61], 0
    v_mov_b64 v[62:63], 0
    v_mov_b64 v[64:65], 0
    v_mov_b64 v[66:67], 0
    v_mov_b64 v[68:69], 0
    v_mov_b64 v[70:71], 0
L_pollA3X:
    buffer_load_dwordx4 v[28:31], v1, s[4:7], s1 offen offset:3072 sc1
    v_mov_b64 v[48:49], 0
    v_mov_b64 v[50:51], 0
    v_mov_b64 v[52:53], 0
    v_mov_b64 v[54:55], 0
    v_mov_b64 v[56:57], 0
    v_mov_b64 v[58:59], 0
    buffer_load_dwordx4 v[44:47], v1, s[4:7], s3 offen offset:3072 sc1
    s_waitcnt vmcnt(1)
    v_max_u32_e64 v124, v28, v30
    v_cmp_eq_u32 vcc, -1, v124
    ds_write_b128 v1, v[28:31] offset:25856
    v_smfmac_f32_16x16x64_bf16 v[56:59], v[28:31], a[176:183], v11
    s_cbranch_vccnz L_againA3X
L_gotE3X:
    v_smfmac_f32_16x16x64_bf16 v[48:51], v[28:31], a[48:55], v11
    v_smfmac_f32_16x16x64_bf16 v[60:63], v[28:31], a[184:191], v11
    s_waitcnt vmcnt(0)
    v_max_u32 v124, v44, v46
    v_cmp_eq_u32 vcc, -1, v124
    ds_write_b128 v1, v[44:47] offset:29952
    v_smfmac_f32_16x16x64_bf16 v[52:55], v[28:31], a[56:63], v11
    s_cbranch_vccnz L_retryA3X
L_lateA3X:
    s_waitcnt lgkmcnt(1)
    s_barrier
    v_smfmac_f32_16x16x64_bf16 v[56:59], v[44:47], a[240:247], v11
    ds_read_b128 v[16:19], v1 offset:22784
    v_smfmac_f32_16x16x64_bf16 v[48:51], v[44:47], a[112:119], v11
    ds_read_b128 v[20:23], v1 offset:23808
    v_smfmac_f32_16x16x64_bf16 v[60:63], v[44:47], a[248:255], v11
    ds_read_b128 v[24:27], v1 offset:24832
    buffer_store_dword v12, v13, s[4:7], s30 offen sc1
    v_smfmac_f32_16x16x64_bf16 v[52:55], v[44:47], a[120:127], v11
    s_mov_b32 m0, 8192
    v_smfmac_f32_16x16x64_bf16 v[64:67], v[28:31], v[176:183], v11
    buffer_load_dwordx4 v9, s[4:7], s58 offen offset:0 sc1 lds
    v_smfmac_f32_16x16x64_bf16 v[68:71], v[28:31], v[184:191], v11
    buffer_load_dwordx4 v9, s[4:7], s58 offen offset:1024 sc1 lds
    s_waitcnt lgkmcnt(2)
    s_barrier
    v_smfmac_f32_16x16x64_bf16 v[56:59], v[16:19], a[128:135], v11
    ds_read_b128 v[32:35], v1 offset:26880
    v_smfmac_f32_16x16x64_bf16 v[48:51], v[16:19], a[0:7], v11
    ds_read_b128 v[36:39], v1 offset:27904
    v_smfmac_f32_16x16x64_bf16 v[60:63], v[16:19], a[136:143], v11
    ds_read_b128 v[40:43], v1 offset:28928
    v_smfmac_f32_16x16x64_bf16 v[52:55], v[16:19], a[8:15], v11
    buffer_load_dwordx4 v9, s[4:7], s58 offen offset:2048 sc1 lds
    s_waitcnt lgkmcnt(4)
    v_smfmac_f32_16x16x64_bf16 v[56:59], v[20:23], a[144:151], v11
    buffer_load_dwordx4 v9, s[4:7], s58 offen offset:3072 sc1 lds
    v_smfmac_f32_16x16x64_bf16 v[48:51], v[20:23], a[16:23], v11
    s_mov_b32 m0, 12288
    s_add_u32 s58, s58, 4096
    v_smfmac_f32_16x16x64_bf16 v[60:63], v[20:23], a[152:159], v11
    buffer_load_dwordx4 v9, s[4:7], s58 offen offset:0 sc1 lds
    v_smfmac_f32_16x16x64_bf16 v[52:55], v[20:23], a[24:31], v11
    buffer_load_dwordx4 v9, s[4:7], s58 offen offset:1024 sc1 lds
    s_waitcnt lgkmcnt(3)
    v_smfmac_f32_16x16x64_bf16 v[56:59], v[24:27], a[160:167], v11
    buffer_load_dwordx4 v9, s[4:7], s58 offen offset:2048 sc1 lds
    v_smfmac_f32_16x16x64_bf16 v[48:51], v[24:27], a[32:39], v11
    v_smfmac_f32_16x16x64_bf16 v[60:63], v[24:27], a[168:175], v11
    v_smfmac_f32_16x16x64_bf16 v[52:55], v[24:27], a[40:47], v11
    s_waitcnt lgkmcnt(2)
    v_smfmac_f32_16x16x64_bf16 v[56:59], v[32:35], a[192:199], v11
    v_smfmac_f32_16x16x64_bf16 v[48:51], v[32:35], a[64:71], v11
    v_smfmac_f32_16x16x64_bf16 v[60:63], v[32:35], a[200:207], v11
    v_smfmac_f32_16x16x64_bf16 v[52:55], v[32:35], a[72:79], v11
    s_waitcnt lgkmcnt(0)
    v_smfmac_f32_16x16x64_bf16 v[56:59], v[36:39], a[208:215], v11
    v_smfmac_f32_16x16x64_bf16 v[48:51], v[36:39], a[80:87], v11
    v_smfmac_f32_16x16x64_bf16 v[56:59], v[40:43], a[224:231], v11
    v_smfmac_f32_16x16x64_bf16 v[48:51], v[40:43], a[96:103], v11
    v_smfmac_f32_16x16x64_bf16 v[60:63], v[36:39], a[216:223], v11
    v_smfmac_f32_16x16x64_bf16 v[60:63], v[40:43], a[232:239], v11
    v_add_f32 v56, v56, v57
    v_smfmac_f32_16x16x64_bf16 v[52:55], v[36:39], a[88:95], v11
    v_add_f32_e64 v58, v58, v59
    v_smfmac_f32_16x16x64_bf16 v[52:55], v[40:43], a[104:111], v11
    v_add_f32 v48, v48, v49
    v_add_f32 v50, v50, v51
    v_cvt_pk_bf16_f32 v56, v56, v58
    v_cvt_pk_bf16_f32 v57, v48, v50
    ds_write_b64 v6, v[56:57] offset:17152
L_qkdone3X:
    v_add_f32 v60, v60, v61
    v_add_f32 v62, v62, v63
    v_cvt_pk_bf16_f32 v60, v60, v62
    v_add_f32 v52, v52, v53
    v_add_f32 v54, v54, v55
    v_cvt_pk_bf16_f32 v61, v52, v54
    ds_write_b64 v6, v[60:61] offset:17280
    v_smfmac_f32_16x16x64_bf16 v[64:67], v[16:19], v[128:135], v11
    buffer_load_dwordx4 v9, s[4:7], s58 offen offset:3072 sc1 lds
    v_smfmac_f32_16x16x64_bf16 v[68:71], v[16:19], v[136:143], v11
    buffer_load_dword v14, v13, s[4:7], s28 offen sc1
    v_smfmac_f32_16x16x64_bf16 v[64:67], v[20:23], v[144:151], v11
    buffer_store_dwordx4 v[112:115], v10, s[4:7], s29 offen offset:0 sc1
    v_smfmac_f32_16x16x64_bf16 v[68:71], v[20:23], v[152:159], v11
    buffer_store_dwordx4 v[116:119], v10, s[4:7], s29 offen offset:1024 sc1
    s_waitcnt lgkmcnt(0)
    s_barrier
    ds_read_b64_tr_b16 v[48:49], v5 offset:16384
    ds_read_b64_tr_b16 v[50:51], v5 offset:16416
    ds_read_b64_tr_b16 v[52:53], v5 offset:16640
    ds_read_b64_tr_b16 v[54:55], v5 offset:16672
    ds_read_b64_tr_b16 v[56:57], v5 offset:16896
    ds_read_b64_tr_b16 v[58:59], v5 offset:16928
    ds_read_b64_tr_b16 v[60:61], v5 offset:17152
    ds_read_b64_tr_b16 v[62:63], v5 offset:17184
    v_smfmac_f32_16x16x64_bf16 v[64:67], v[24:27], v[160:167], v11
    v_smfmac_f32_16x16x64_bf16 v[68:71], v[24:27], v[168:175], v11
    ds_read_b128 v[16:19], v2 offset:0
    ds_read_b128 v[20:23], v2 offset:1024
    s_waitcnt lgkmcnt(8)
    v_mfma_f32_16x16x32_bf16 v[116:119], v[80:83], v[48:51], 0
    ds_read_b128 v[24:27], v2 offset:2048
    v_mfma_f32_16x16x32_bf16 v[120:123], v[84:87], v[48:51], 0
    ds_read_b128 v[28:31], v2 offset:3072
    v_mfma_f32_16x16x32_bf16 v[124:127], v[48:51], v[48:51], 0
    ds_read_b128 v[80:83], v2 offset:4096
    s_waitcnt lgkmcnt(9)
    v_mfma_f32_16x16x32_bf16 v[116:119], v[88:91], v[52:55], v[116:119]
    ds_read_b128 v[84:87], v2 offset:5120
    v_mfma_f32_16x16x32_bf16 v[120:123], v[92:95], v[52:55], v[120:123]
    ds_read_b128 v[88:91], v2 offset:6144
    v_mfma_f32_16x16x32_bf16 v[124:127], v[52:55], v[52:55], v[124:127]
    ds_read_b128 v[92:95], v2 offset:7168
    s_waitcnt lgkmcnt(10)
    v_mfma_f32_16x16x32_bf16 v[116:119], v[96:99], v[56:59], v[116:119]
    ds_read_b128 v[48:51], v2 offset:12288
    v_mfma_f32_16x16x32_bf16 v[120:123], v[100:103], v[56:59], v[120:123]
    ds_read_b128 v[52:55], v2 offset:13312
    v_mfma_f32_16x16x32_bf16 v[124:127], v[56:59], v[56:59], v[124:127]
    ds_read_b128 v[96:99], v2 offset:8192
    s_waitcnt lgkmcnt(11)
    v_mfma_f32_16x16x32_bf16 v[116:119], v[104:107], v[60:63], v[116:119]
    ds_read_b128 v[100:103], v2 offset:9216
    v_mfma_f32_16x16x32_bf16 v[120:123], v[108:111], v[60:63], v[120:123]
    ds_read_b128 v[104:107], v2 offset:10240
    v_mfma_f32_16x16x32_bf16 v[124:127], v[60:63], v[60:63], v[124:127]
    ds_read_b128 v[108:111], v2 offset:11264
    ds_read_b128 v[56:59], v2 offset:14336
    s_waitcnt lgkmcnt(11)
    v_smfmac_f32_16x16x64_bf16 v[64:67], v[32:35], v[16:23], v11
    ds_read_b128 v[60:63], v2 offset:15360
    v_max3_f32 v112, v116, v117, v118
    v_smfmac_f32_16x16x64_bf16 v[68:71], v[32:35], v[24:31], v11
    v_max3_f32 v113, v119, v120, v121
    s_waitcnt lgkmcnt(8)
    v_smfmac_f32_16x16x64_bf16 v[64:67], v[36:39], v[80:87], v11
    v_max3_f32 v112, v112, v122, v123
    v_max3_f32 v126, v113, v124, v125
    v_smfmac_f32_16x16x64_bf16 v[68:71], v[36:39], v[88:95], v11
    v_max_f32 v127, v112, v126
    v_max_f32_e64 v126, v112, v126
    s_waitcnt lgkmcnt(4)
    v_smfmac_f32_16x16x64_bf16 v[64:67], v[44:47], v[48:55], v11
    s_nop 0
    v_permlane16_swap_b32 v126, v127
    v_smfmac_f32_16x16x64_bf16 v[64:67], v[40:43], v[96:103], v11
    v_max_f32 v112, v126, v127
    v_max_f32_e64 v113, v126, v127
    s_waitcnt lgkmcnt(0)
    v_smfmac_f32_16x16x64_bf16 v[68:71], v[40:43], v[104:111], v11
    s_nop 0
    v_permlane32_swap_b32 v112, v113
    v_smfmac_f32_16x16x64_bf16 v[68:71], v[44:47], v[56:63], v11
    v_max_f32 v126, v112, v113
    v_mul_f32 v126, s55, v126
    v_mov_b32 v12, s44
    v_mov_b64 v[16:17], s[78:79]
    v_mov_b64_e64 v[18:19], s[78:79]
    v_pk_fma_f32 v[116:117], v[116:117], s[32:33], v[126:127] op_sel_hi:[1,1,0] neg_lo:[0,0,1] neg_hi:[0,0,1]
    v_pk_fma_f32 v[118:119], v[118:119], s[32:33], v[126:127] op_sel_hi:[1,1,0] neg_lo:[0,0,1] neg_hi:[0,0,1]
    v_pk_fma_f32 v[120:121], v[120:121], s[32:33], v[126:127] op_sel_hi:[1,1,0] neg_lo:[0,0,1] neg_hi:[0,0,1]
    v_pk_fma_f32 v[122:123], v[122:123], s[32:33], v[126:127] op_sel_hi:[1,1,0] neg_lo:[0,0,1] neg_hi:[0,0,1]
    v_pk_fma_f32 v[124:125], v[124:125], s[32:33], v[126:127] op_sel_hi:[1,1,0] neg_lo:[0,0,1] neg_hi:[0,0,1]
    v_exp_f32 v116, v116
    v_exp_f32 v117, v117
    v_exp_f32_e64 v118, v118
    v_cvt_pk_bf16_f32 v112, v116, v117
    v_exp_f32 v119, v119
    v_exp_f32 v120, v120
    v_cvt_pk_bf16_f32 v113, v118, v119
    v_exp_f32 v121, v121
    v_exp_f32 v122, v122
    v_cvt_pk_bf16_f32 v114, v120, v121
    v_exp_f32 v123, v123
    v_exp_f32 v124, v124
    v_cvt_pk_bf16_f32 v115, v122, v123
    v_exp_f32 v125, v125
    v_add_f32 v64, v64, v65
    v_mfma_f32_16x16x32_bf16 v[20:23], v[16:19], v[112:115], 0
    v_cvt_pk_bf16_f32 v124, v124, v125
    v_mov_b32_e64 v125, 0
    v_mfma_f32_16x16x32_bf16 v[24:27], v[72:75], v[112:115], 0
    v_add_f32 v66, v66, v67
    v_add_f32 v68, v68, v69
    v_mfma_f32_16x16x32_bf16 v[28:31], v[76:79], v[112:115], 0
    v_cvt_pk_bf16_f32 v64, v64, v66
    v_mov_b32_e64 v65, 0
    v_mfma_f32_16x16x16_bf16 v[20:23], v[16:17], v[124:125], v[20:23]
    v_add_f32 v70, v70, v71
    v_mov_b32 v69, 0
    v_cvt_pk_bf16_f32 v68, v68, v70
    v_mfma_f32_16x16x16_bf16 v[24:27], v[64:65], v[124:125], v[24:27]
    ds_read_b128 v[80:83], v2 offset:16384
    v_mfma_f32_16x16x16_bf16 v[28:31], v[68:69], v[124:125], v[28:31]
    v_rcp_f32_e64 v20, v20
    ds_read_b128 v[84:87], v2 offset:17408
    ds_read_b128 v[88:91], v2 offset:24576
    ds_read_b128 v[92:95], v2 offset:25600
    buffer_store_dword v12, v0, s[4:7], s59 offen sc1
    v_pk_mul_f32 v[24:25], v[24:25], v[20:21] op_sel_hi:[1,0]
    v_pk_mul_f32 v[26:27], v[26:27], v[20:21] op_sel_hi:[1,0]
    v_cvt_pk_bf16_f32 v16, v24, v25
    v_cvt_pk_bf16_f32 v17, v26, v27
    v_pk_mul_f32 v[28:29], v[28:29], v[20:21] op_sel_hi:[1,0]
    v_pk_mul_f32 v[30:31], v[30:31], v[20:21] op_sel_hi:[1,0]
    v_cvt_pk_bf16_f32 v18, v28, v29
    v_cvt_pk_bf16_f32 v19, v30, v31
    s_mov_b64 exec, s[56:57]
    ds_write_b128 v7, v[16:19] offset:22272
    s_mov_b64 exec, -1
    v_mov_b64 v[112:113], 0
    v_mov_b64 v[114:115], 0
    v_mov_b64 v[116:117], 0
    v_mov_b64 v[118:119], 0
    v_mov_b64 v[120:121], 0
    v_mov_b64 v[122:123], 0
    v_mov_b64 v[124:125], 0
    v_mov_b64 v[126:127], 0
    ds_read_b128 v[48:51], v2 offset:18432
    ds_read_b128 v[52:55], v2 offset:19456
    s_waitcnt lgkmcnt(2)
    s_barrier
    ds_read_b128 v[72:75], v1 offset:20736
    ds_read_b128 v[76:79], v1 offset:21760
    v_mov_b64 v[16:17], 0
    v_mov_b64 v[18:19], 0
    v_mov_b64 v[20:21], 0
    v_mov_b64 v[22:23], 0
    v_mov_b64 v[24:25], 0
    v_mov_b64 v[26:27], 0
    v_mov_b64 v[28:29], 0
    v_mov_b64 v[30:31], 0
    ds_read_b128 v[96:99], v2 offset:26624
    ds_read_b128 v[100:103], v2 offset:27648
    ds_read_b128 v[104:107], v2 offset:20480
    s_waitcnt lgkmcnt(4)
    v_smfmac_f32_16x16x64_bf16 v[112:115], v[72:75], v[192:199], v11
    ds_read_b128 v[108:111], v2 offset:21504
    s_waitcnt lgkmcnt(4)
    v_smfmac_f32_16x16x64_bf16 v[112:115], v[76:79], v[200:207], v11
    ds_read_b128 v[56:59], v2 offset:28672
    v_smfmac_f32_16x16x64_bf16 v[116:119], v[72:75], v[208:215], v11
    ds_read_b128 v[60:63], v2 offset:29696
    v_smfmac_f32_16x16x64_bf16 v[116:119], v[76:79], v[216:223], v11
    v_add_f32 v112, v112, v113
    v_add_f32 v114, v114, v115
    v_smfmac_f32_16x16x64_bf16 v[120:123], v[72:75], v[224:231], v11
    ds_read_b128 v[32:35], v2 offset:22528
    v_smfmac_f32_16x16x64_bf16 v[120:123], v[76:79], v[232:239], v11
    v_add_f32 v116, v116, v117
    v_add_f32 v118, v118, v119
    v_smfmac_f32_16x16x64_bf16 v[124:127], v[72:75], v[240:247], v11
    v_cvt_pk_bf16_f32 v112, v112, v116
    v_cvt_pk_bf16_f32 v114, v114, v118
    v_smfmac_f32_16x16x64_bf16 v[124:127], v[76:79], v[248:255], v11
    v_bfi_b32 v112, 1, s47, v112
    v_add_f32 v120, v120, v121
    v_add_f32 v122, v122, v123
    v_smfmac_f32_16x16x64_bf16 v[16:19], v[72:75], v[80:87], v11
    ds_read_b128 v[36:39], v2 offset:23552
    v_smfmac_f32_16x16x64_bf16 v[16:19], v[76:79], v[88:95], v11
    v_add_f32 v124, v124, v125
    v_add_f32 v126, v126, v127
    v_cvt_pk_bf16_f32 v113, v120, v124
    v_cvt_pk_bf16_f32 v115, v122, v126
    buffer_store_dwordx4 v[112:115], v8, s[4:7], s45 offen sc1
    ds_read_b128 v[40:43], v2 offset:30720
    v_smfmac_f32_16x16x64_bf16 v[20:23], v[72:75], v[48:55], v11
    ds_read_b128 v[44:47], v2 offset:31744
    s_waitcnt lgkmcnt(8)
    v_smfmac_f32_16x16x64_bf16 v[20:23], v[76:79], v[96:103], v11
    v_add_f32 v16, v16, v17
    v_add_f32 v18, v18, v19
    s_waitcnt lgkmcnt(6)
    v_smfmac_f32_16x16x64_bf16 v[24:27], v[72:75], v[104:111], v11
    s_waitcnt lgkmcnt(4)
    v_smfmac_f32_16x16x64_bf16 v[24:27], v[76:79], v[56:63], v11
    v_add_f32 v20, v20, v21
    v_add_f32 v22, v22, v23
    s_waitcnt lgkmcnt(2)
    v_smfmac_f32_16x16x64_bf16 v[28:31], v[72:75], v[32:39], v11
    v_cvt_pk_bf16_f32 v16, v16, v20
    v_cvt_pk_bf16_f32 v18, v18, v22
    s_waitcnt lgkmcnt(0)
    v_smfmac_f32_16x16x64_bf16 v[28:31], v[76:79], v[40:47], v11
    v_bfi_b32 v16, 1, s47, v16
    v_add_f32 v24, v24, v25
    v_add_f32 v26, v26, v27
    s_nop 4
    v_add_f32 v28, v28, v29
    v_add_f32 v30, v30, v31
    v_cvt_pk_bf16_f32 v17, v24, v28
    v_cvt_pk_bf16_f32 v19, v26, v30
    buffer_store_dwordx4 v[16:19], v8, s[4:7], s46 offen sc1
    ds_write_b32 v6, v64 offset:17156
    ds_write_b32 v6, v68 offset:17284
    s_mov_b32 s2, s44
    s_add_u32 s44, s44, 1
    s_mov_b32 s51, s48
    s_mov_b32 s48, s49
    s_mov_b32 s49, s50
    s_mov_b32 s50, s51
    s_add_u32 s1, s48, s0
    s_add_u32 s3, s1, 4096
    s_waitcnt vmcnt(2) lgkmcnt(0)
    s_barrier
    ds_read_b128 v[92:95], v3 offset:2304
    ds_read_b128 v[96:99], v3 offset:4096
    ds_read_b128 v[100:103], v3 offset:4352
    ds_read_b128 v[104:107], v3 offset:6144
    ds_read_b128 v[108:111], v3 offset:6400
    ds_read_b64_tr_b16 v[72:73], v4 offset:14336
    ds_read_b64_tr_b16 v[74:75], v4 offset:14592
    ds_read_b64_tr_b16 v[76:77], v4 offset:15360
    ds_read_b64_tr_b16 v[78:79], v4 offset:15616
    ds_read_b128 v[112:115], v1 offset:18560
    ds_read_b128 v[116:119], v1 offset:19616
    s_add_u32 s58, s44, 1
    s_min_u32 s58, s58, 63
L_kvchks3X:
    v_cmp_gt_i32 vcc, s58, v14
    s_cbranch_vccz L_kvoks3X
    buffer_load_dword v14, v13, s[4:7], s28 offen sc1
    s_waitcnt vmcnt(0)
    s_sub_u32 s96, s96, 1
    s_cbranch_scc0 L_kvchks3X
    s_branch L_abort
L_kvoks3X:
    s_lshl_b32 s58, s58, 18
    s_add_u32 s58, s58, 33554432
    s_lshl_b32 s29, s44, 17
    s_cmp_gt_u32 s44, 56
    s_mov_b32 s52, 50333696
    s_cselect_b32 s52, 58591232, s52
    s_add_u32 s29, s29, s52
    s_sub_u32 s52, s44, 2
    s_max_i32 s52, s52, -1
    v_mov_b32 v12, s52
    s_xor_b32 s47, s47, 1
    s_waitcnt lgkmcnt(0)
    s_cmp_lt_u32 s44, 63
    s_barrier
    s_cbranch_scc1 L_top3X
    s_branch L_final3X
L_againA3X:
    s_waitcnt vmcnt(0) lgkmcnt(0)
    s_nop 7
    v_mov_b64 v[56:57], 0
    v_mov_b64 v[58:59], 0
    s_sub_u32 s96, s96, 1
    s_cbranch_scc0 L_pollA3X
    s_branch L_abort
L_retryA3X:
L_retry23X:
    s_waitcnt lgkmcnt(0)
    buffer_load_dwordx4 v[44:47], v1, s[4:7], s3 offen offset:3072 sc1
    s_waitcnt vmcnt(0)
    v_max_u32_e64 v124, v44, v46
    v_cmp_eq_u32 vcc, -1, v124
    ds_write_b128 v1, v[44:47] offset:29952
    s_cbranch_vccz L_lateA3X
    s_sub_u32 s96, s96, 1
    s_cbranch_scc0 L_retry23X
    s_branch L_abort
L_againAf3X:
    s_waitcnt vmcnt(0) lgkmcnt(0)
    s_nop 7
    v_mov_b64 v[56:57], 0
    v_mov_b64 v[58:59], 0
    s_sub_u32 s96, s96, 1
    s_cbranch_scc0 L_pollAf3X
    s_branch L_abort
L_retryAf3X:
L_retry2f3X:
    s_waitcnt lgkmcnt(0)
    buffer_load_dwordx4 v[44:47], v1, s[4:7], s3 offen offset:3072 sc1
    s_waitcnt vmcnt(0)
    v_max_u32_e64 v124, v44, v46
    v_cmp_eq_u32 vcc, -1, v124
    ds_write_b128 v1, v[44:47] offset:29952
    s_cbranch_vccz L_lateAf3X
    s_sub_u32 s96, s96, 1
    s_cbranch_scc0 L_retry2f3X
    s_branch L_abort
L_final3X:
    ds_read_b128 v[80:83], v3 offset:0
    ds_read_b128 v[84:87], v3 offset:256
    ds_read_b128 v[88:91], v3 offset:2048
    v_mov_b64 v[60:61], 0
    v_mov_b64 v[62:63], 0
    v_mov_b64 v[64:65], 0
    v_mov_b64 v[66:67], 0
    v_mov_b64 v[68:69], 0
    v_mov_b64 v[70:71], 0
L_pollAf3X:
    buffer_load_dwordx4 v[28:31], v1, s[4:7], s1 offen offset:3072 sc1
    v_mov_b64 v[48:49], 0
    v_mov_b64 v[50:51], 0
    v_mov_b64 v[52:53], 0
    v_mov_b64 v[54:55], 0
    v_mov_b64 v[56:57], 0
    v_mov_b64 v[58:59], 0
    buffer_load_dwordx4 v[44:47], v1, s[4:7], s3 offen offset:3072 sc1
    s_waitcnt vmcnt(1)
    v_max_u32_e64 v124, v28, v30
    v_cmp_eq_u32 vcc, -1, v124
    ds_write_b128 v1, v[28:31] offset:25856
    v_smfmac_f32_16x16x64_bf16 v[56:59], v[28:31], a[176:183], v11
    s_cbranch_vccnz L_againAf3X
L_gotEf3X:
    v_smfmac_f32_16x16x64_bf16 v[48:51], v[28:31], a[48:55], v11
    v_smfmac_f32_16x16x64_bf16 v[60:63], v[28:31], a[184:191], v11
    s_waitcnt vmcnt(0)
    v_max_u32 v124, v44, v46
    v_cmp_eq_u32 vcc, -1, v124
    ds_write_b128 v1, v[44:47] offset:29952
    v_smfmac_f32_16x16x64_bf16 v[52:55], v[28:31], a[56:63], v11
    s_cbranch_vccnz L_retryAf3X
L_lateAf3X:
    s_waitcnt lgkmcnt(1)
    s_barrier
    ds_read_b128 v[16:19], v1 offset:22784
    ds_read_b128 v[20:23], v1 offset:23808
    ds_read_b128 v[24:27], v1 offset:24832
    buffer_store_dword v12, v13, s[4:7], s30 offen sc1
    s_mov_b32 s52, 66848768
    buffer_store_dwordx4 v[112:115], v10, s[4:7], s52 offen offset:0 sc1
    buffer_store_dwordx4 v[116:119], v10, s[4:7], s52 offen offset:1024 sc1
    v_smfmac_f32_16x16x64_bf16 v[56:59], v[44:47], a[240:247], v11
    v_smfmac_f32_16x16x64_bf16 v[60:63], v[44:47], a[248:255], v11
    v_smfmac_f32_16x16x64_bf16 v[64:67], v[28:31], v[176:183], v11
    v_smfmac_f32_16x16x64_bf16 v[68:71], v[28:31], v[184:191], v11
    s_waitcnt lgkmcnt(2)
    s_barrier
    v_smfmac_f32_16x16x64_bf16 v[56:59], v[16:19], a[128:135], v11
    ds_read_b128 v[32:35], v1 offset:26880
    v_smfmac_f32_16x16x64_bf16 v[60:63], v[16:19], a[136:143], v11
    ds_read_b128 v[36:39], v1 offset:27904
    v_smfmac_f32_16x16x64_bf16 v[64:67], v[16:19], v[128:135], v11
    ds_read_b128 v[40:43], v1 offset:28928
    v_smfmac_f32_16x16x64_bf16 v[68:71], v[16:19], v[136:143], v11
    ds_read_b128 v[80:83], v2 offset:12288
    s_waitcnt lgkmcnt(5)
    v_smfmac_f32_16x16x64_bf16 v[56:59], v[20:23], a[144:151], v11
    ds_read_b128 v[84:87], v2 offset:13312
    v_smfmac_f32_16x16x64_bf16 v[60:63], v[20:23], a[152:159], v11
    ds_read_b128 v[88:91], v2 offset:14336
    v_smfmac_f32_16x16x64_bf16 v[64:67], v[20:23], v[144:151], v11
    ds_read_b128 v[92:95], v2 offset:15360
    v_smfmac_f32_16x16x64_bf16 v[68:71], v[20:23], v[152:159], v11
    ds_read_b128 v[96:99], v2 offset:0
    s_waitcnt lgkmcnt(8)
    v_smfmac_f32_16x16x64_bf16 v[56:59], v[24:27], a[160:167], v11
    ds_read_b128 v[100:103], v2 offset:1024
    v_smfmac_f32_16x16x64_bf16 v[60:63], v[24:27], a[168:175], v11
    ds_read_b128 v[104:107], v2 offset:2048
    v_smfmac_f32_16x16x64_bf16 v[64:67], v[24:27], v[160:167], v11
    ds_read_b128 v[108:111], v2 offset:3072
    v_smfmac_f32_16x16x64_bf16 v[68:71], v[24:27], v[168:175], v11
    v_lshrrev_b32 v120, 8, v1
    v_lshlrev_b32 v120, 10, v120
    v_bfe_u32 v121, v1, 4, 4
    v_lshl_add_u32 v120, v121, 3, v120
    s_lshl_b32 s52, s14, 12
    s_add_u32 s52, s52, 66978560
    s_waitcnt lgkmcnt(6)
    v_smfmac_f32_16x16x64_bf16 v[64:67], v[44:47], v[80:87], v11
    ds_read_b128 v[80:83], v2 offset:4096
    ds_read_b128 v[84:87], v2 offset:5120
    v_smfmac_f32_16x16x64_bf16 v[56:59], v[32:35], a[192:199], v11
    s_waitcnt lgkmcnt(6)
    v_smfmac_f32_16x16x64_bf16 v[68:71], v[44:47], v[88:95], v11
    ds_read_b128 v[88:91], v2 offset:6144
    ds_read_b128 v[92:95], v2 offset:7168
    v_smfmac_f32_16x16x64_bf16 v[60:63], v[32:35], a[200:207], v11
    s_waitcnt lgkmcnt(6)
    v_smfmac_f32_16x16x64_bf16 v[64:67], v[32:35], v[96:103], v11
    ds_read_b128 v[96:99], v2 offset:8192
    ds_read_b128 v[100:103], v2 offset:9216
    v_smfmac_f32_16x16x64_bf16 v[56:59], v[36:39], a[208:215], v11
    s_waitcnt lgkmcnt(6)
    v_smfmac_f32_16x16x64_bf16 v[68:71], v[32:35], v[104:111], v11
    ds_read_b128 v[104:107], v2 offset:10240
    ds_read_b128 v[108:111], v2 offset:11264
    v_smfmac_f32_16x16x64_bf16 v[60:63], v[36:39], a[216:223], v11
    s_waitcnt lgkmcnt(6)
    v_smfmac_f32_16x16x64_bf16 v[64:67], v[36:39], v[80:87], v11
    v_smfmac_f32_16x16x64_bf16 v[56:59], v[40:43], a[224:231], v11
    s_waitcnt lgkmcnt(4)
    v_smfmac_f32_16x16x64_bf16 v[68:71], v[36:39], v[88:95], v11
    v_smfmac_f32_16x16x64_bf16 v[60:63], v[40:43], a[232:239], v11
    s_waitcnt lgkmcnt(2)
    v_smfmac_f32_16x16x64_bf16 v[64:67], v[40:43], v[96:103], v11
    s_waitcnt lgkmcnt(0)
    v_smfmac_f32_16x16x64_bf16 v[68:71], v[40:43], v[104:111], v11
    v_add_f32 v56, v56, v57
    v_add_f32 v58, v58, v59
    v_cvt_pk_bf16_f32 v56, v56, v58
    v_add_f32 v60, v60, v61
    v_add_f32 v62, v62, v63
    v_cvt_pk_bf16_f32 v60, v60, v62
    s_nop 1
    v_add_f32 v64, v64, v65
    v_add_f32_e64 v66, v66, v67
    v_cvt_pk_bf16_f32 v57, v64, v66
    buffer_store_dwordx2 v[56:57], v120, s[4:7], s52 offen offset:0 sc1
    v_add_f32 v68, v68, v69
    v_add_f32 v70, v70, v71
    v_cvt_pk_bf16_f32 v61, v68, v70
    buffer_store_dwordx2 v[60:61], v120, s[4:7], s52 offen offset:128 sc1
    s_waitcnt vmcnt(0)
    s_endpgm
.section .rodata,"a"
.p2align 6
.amdhsa_kernel sequential_preLN__memory_aug_recurrent_mem_tr__glu_gated_geglu__prompt_kernel
.amdhsa_next_free_vgpr 512
.amdhsa_next_free_sgpr 102
.amdhsa_accum_offset 256
.amdhsa_group_segment_fixed_size 0
.amdhsa_kernarg_size 112
.amdhsa_user_sgpr_count 2
.amdhsa_user_sgpr_kernarg_segment_ptr 1
.amdhsa_system_sgpr_workgroup_id_x 1
.end_amdhsa_kernel
```
